```python
import torch

def _softmax(x, axis=-1):
    return torch.softmax(x, dim=axis)
def _gelu(x):
    return torch.nn.functional.gelu(x, approximate="tanh")
def _silu(x):
    return torch.nn.functional.silu(x)
def _sigmoid(x):
    return torch.sigmoid(x)
def _layernorm(x, axis=-1, eps=1e-5):
    m = x.mean(dim=axis, keepdim=True)
    v = x.var(dim=axis, keepdim=True, unbiased=False)
    return (x - m) / torch.sqrt(v + eps)
def _scatter_add(tgt, idx, src, axis=0):
    return tgt.clone().index_add_(axis, idx, src)
def _segment_sum(src, seg, n):
    out = torch.zeros((n,) + src.shape[1:], dtype=src.dtype)
    return out.index_add_(0, seg, src)
def _pad(x, pw):
    flat = tuple(v for pair in reversed(pw) for v in pair)
    return torch.nn.functional.pad(x, flat)

kernel_name = 'gated_mix__sliding_block__dense_activation_relu__prompt'

def setup_inputs():

    _w = (lambda a: (lambda t: t.to(torch.bfloat16) if t.is_floating_point() else t)(torch.as_tensor(a)))
    def _A_setup():
        B, S, D = 1, 2048, 1024
        return {
            "x": _w((lambda *s: torch.randn(*s, dtype=torch.bfloat16) * 0.05)(B, S, D)),
            "wqkv": _w((lambda *s: torch.randn(*s, dtype=torch.bfloat16) * 0.8)(D, 3 * D)),
            "wo": _w((lambda *s: torch.randn(*s, dtype=torch.bfloat16) * 0.05)(D, D)),
        }
    _A_in = _A_setup()

    def _B_setup():
        B, S, D, Dff = 1, 2048, 1024, 3584
        return {
            "x": _w((lambda *s: torch.randn(*s, dtype=torch.bfloat16) * 0.05)(B, S, D)),
            "w1": _w((lambda *s: torch.randn(*s, dtype=torch.bfloat16) * 0.05)(D, Dff)),
            "w2": _w((lambda *s: torch.randn(*s, dtype=torch.bfloat16) * 0.05)(Dff, D)),
        }
    _B_in = _B_setup()

    return {
        "A_x": _A_in["x"],
        "A_wqkv": _A_in["wqkv"],
        "A_wo": _A_in["wo"],
        "B_x": _B_in["x"],
        "B_w1": _B_in["w1"],
        "B_w2": _B_in["w2"],
        "gate_w": _w((lambda *s: torch.randn(*s, dtype=torch.bfloat16) * 0.05)(1024) * 16.0),
    }

def reference(A_x, A_wqkv, A_wo, B_x, B_w1, B_w2, gate_w):
    def _A_ref(x, wqkv, wo):
        B, S, D = x.shape
        H = 32; Dh = D // H; W = 256
        qkv = (lambda x, *d: x.permute(*d))((x @ wqkv).reshape(B, S, 3, H, Dh), 2, 0, 3, 1, 4)
        q, k, v = qkv[0], qkv[1], qkv[2]
        scores = torch.einsum("bhqd,bhkd->bhqk", q, k) * (Dh ** -0.5)
        idx = torch.arange(S)
        mask = (idx[:, None] - idx[None, :] >= 0) & (idx[:, None] - idx[None, :] < W)
        scores = torch.where(mask[None, None], scores, -1e9)
        p = _softmax(scores, axis=-1)
        o = torch.einsum("bhqk,bhkd->bhqd", p, v)
        return (lambda x, *d: x.permute(*d))(o, 0, 2, 1, 3).reshape(B, S, D) @ wo

    def _B_ref(x, w1, w2):
        h = torch.einsum("bsd,df->bsf", x, w1)
        zero = torch.zeros_like(h)
        h = torch.maximum(h, zero)
        return torch.einsum("bsf,fd->bsd", h, w2)

    x = A_x
    g = _sigmoid((x * gate_w).sum(-1, keepdims=True))
    a = _A_ref(x, A_wqkv, A_wo)
    b = _B_ref(x, B_w1, B_w2)
    return g * a + (1 - g) * b
```

```asm
; @launch kernel=mk_kernel grid=(256,1,1) block=(256,1,1) lds=163840
.amdgcn_target "amdgcn-amd-amdhsa--gfx950"
.text
.globl mk_kernel
.p2align 8
.type mk_kernel,@function
mk_kernel:
    s_cmp_ge_u32 s2, 256
    s_cbranch_scc1 L_exit0
    s_load_dwordx16 s[16:31], s[0:1], 0
    s_load_dwordx4 s[32:35], s[0:1], 64
    s_memrealtime s[66:67]
    s_getpc_b64 s[92:93]
    s_and_b32 s92, s92, 0xffffff00
    s_and_b32 s93, s93, 0xffff
    s_mov_b32 s94, L_end-mk_kernel
    s_mov_b32 s95, 0x20000
    s_lshr_b32 s3, s2, 3
    s_lshl_b32 s3, s3, 7
    v_lshlrev_b32 v253, 12, v0
    buffer_load_dword v254, v253, s[92:95], s3 offen
    v_and_b32 v242, 63, v0
    v_lshrrev_b32 v1, 6, v0
    v_lshlrev_b32 v252, 4, v242
    v_readfirstlane_b32 s50, v1
    s_and_b32 s3, s2, 1
    s_lshl_b32 s3, s3, 2
    s_bfe_u32 s4, s2, 0x20003
    s_add_u32 s48, s3, s4
    s_bfe_u32 s3, s2, 0x20001
    s_lshl_b32 s3, s3, 3
    s_lshr_b32 s4, s2, 5
    s_mov_b32 s5, 0x10543276
    s_mov_b32 s6, 0x10543276
    s_bitcmp1_b32 s2, 1
    s_cmov_b32 s5, 0x76543012
    s_cmov_b32 s6, 0x76543210
    s_bitcmp1_b32 s2, 2
    s_cmov_b32 s5, s6
    s_lshl_b32 s4, s4, 2
    s_lshr_b32 s4, s5, s4
    s_and_b32 s4, s4, 7
    s_add_u32 s52, s3, s4
    s_and_b32 s65, s4, 1
    s_lshr_b32 s5, s2, 3
    s_and_b32 s3, s2, 1
    s_bfe_u32 s4, s2, 0x20001
    s_lshr_b32 s6, s2, 6
    s_add_u32 s7, s6, 0
    s_lshr_b32 s8, s7, 1
    s_sub_u32 s8, 7, s8
    s_bitcmp1_b32 s7, 0
    s_cselect_b32 s94, 99, s8
    s_cselect_b32 s95, s8, 99
    s_mov_b32 s91, 0
    s_mov_b32 s93, 0
    s_and_b32 s7, s5, 7
    s_cmp_ge_u32 s50, 2
    s_cbranch_scc1 L_pfw
    s_lshl_b32 s3, s3, 21
    s_lshl_b32 s8, s5, 16
    s_add_u32 s100, s3, s8
    s_add_u32 s64, s100, 256
    s_lshl_b32 s4, s4, 19
    s_add_u32 s3, s3, s4
    s_lshl_b32 s8, s5, 14
    s_add_u32 s101, s3, s8
    s_add_u32 s101, s101, 256
    s_lshl_b32 s8, s7, 16
    s_add_u32 s3, s3, s8
    s_lshl_b32 s8, s6, 8
    s_add_u32 s3, s3, s8
    s_add_u32 s88, s3, 512
    s_mov_b32 s89, 0x80000000
    s_cmp_lt_u32 s6, 2
    s_cselect_b32 s90, 0x400, 0x40000000
    s_mov_b32 s92, 0xffff
    s_cmp_eq_u32 s50, 0
    s_cselect_b32 s86, 0x400000, 0
    v_lshrrev_b32 v243, 1, v242
    v_and_b32 v244, 1, v242
    v_lshlrev_b32 v244, 7, v244
    v_lshl_add_u32 v251, v243, 11, v244
    s_branch L_pfg
L_pfw:
    s_cmp_eq_u32 s50, 3
    s_movk_i32 s8, 6144
    s_cselect_b32 s8, 7168, s8
    s_movk_i32 s9, 512
    s_cselect_b32 s9, 1792, s9
    s_cselect_b32 s10, 14, 12
    s_movk_i32 s11, 5462
    s_cselect_b32 s11, 4682, s11
    s_mov_b32 s92, 0xffffff
    s_cselect_b32 s92, 0xfffffff, s92
    s_movk_i32 s12, 1536
    s_cselect_b32 s12, 0, s12
    v_mul_u32_u24 v243, s11, v242
    v_lshrrev_b32 v243, 16, v243
    v_mul_u32_u24 v244, s10, v243
    v_sub_u32 v244, v242, v244
    v_lshrrev_b32 v245, 2, v244
    v_mul_u32_u24 v245, s12, v245
    v_lshl_add_u32 v244, v244, 7, v245
    v_mad_u32_u24 v244, v243, s8, v244
    v_cmp_gt_u32 vcc, 4, v243
    v_mov_b32 v245, 0x70000000
    s_lshl_b32 s86, s8, 10
    s_mul_i32 s4, s4, s9
    s_lshl_b32 s9, s5, 2
    s_mul_i32 s100, s9, s8
    s_add_u32 s100, s100, s4
    s_lshl_b32 s64, s8, 7
    s_add_u32 s64, s64, s100
    s_lshl_b32 s10, s3, 1
    s_add_u32 s9, s9, s10
    s_add_u32 s9, s9, 128
    s_mul_i32 s101, s9, s8
    s_add_u32 s101, s101, s4
    v_cndmask_b32 v251, v245, v244, vcc
    s_lshl_b32 s9, s5, 1
    s_add_u32 s9, s9, s3
    s_mul_i32 s9, s9, 6
    s_add_u32 s9, s9, 256
    s_mul_i32 s9, s9, s8
    s_add_u32 s88, s9, s4
    s_lshl_b32 s9, s8, 2
    s_add_u32 s89, s88, s9
    s_mul_i32 s90, s8, 384
L_pfg:
    s_mov_b32 s53, 0x10000
    s_mov_b32 s54, 0x0
    s_mov_b32 s55, 0x8000
    s_movk_i32 s57, 512
    s_lshl_b32 s3, s48, 5
    s_add_u32 s13, s3, s52
    s_lshl_b32 s15, s13, 7
    s_add_u32 s15, s15, 0x2900000
    s_mov_b32 s12, 0
    s_mul_i32 s6, s52, 224
    s_lshl_b32 s7, s52, 6
    s_movk_i32 s98, 2048
    s_mov_b32 s99, 0x20000
    v_lshlrev_b32 v250, 3, v252
    s_cmp_eq_u32 s50, 1
    s_waitcnt lgkmcnt(0)
    s_cbranch_scc0 L_nf_w1
    s_mov_b32 s96, s28
    s_and_b32 s97, s29, 0xffff
    buffer_load_dword v250, v250, s[96:99], 0 offen
    s_cmp_eq_u32 s2, 0
    s_cbranch_scc0 L_nf_w1
    s_mov_b32 s96, s32
    s_and_b32 s97, s33, 0xffff
    s_movk_i32 s98, 256
    s_or_b32 s3, s66, 1
    v_mov_b32 v255, s3
    s_mov_b64 exec, 1
    buffer_store_dword v255, off, s[96:99], 0 sc1
    s_mov_b64 exec, -1
L_nf_w1:
    s_cmp_eq_u32 s50, 3
    s_cselect_b64 s[84:85], s[24:25], s[18:19]
    s_cmp_lt_u32 s50, 2
    s_cselect_b64 s[84:85], s[16:17], s[84:85]
    s_and_b32 s85, s85, 0xffff
    s_mov_b32 s87, 0x20000
    buffer_load_dword v250, v251, s[84:87], s100 offen
    s_lshl_b32 s3, s48, 19
    s_add_u32 s36, s16, s3
    s_addc_u32 s37, s17, 0
    s_and_b32 s37, s37, 0xffff
    s_mov_b32 s38, 0x80000
    s_mov_b32 s39, 0x20000
    s_add_u32 s40, s24, s6
    s_addc_u32 s41, s25, 0
    s_and_b32 s41, s41, 0xffff
    s_sub_u32 s42, 7340032, s6
    s_mov_b32 s43, 0x20000
    s_add_u32 s8, s18, s7
    s_addc_u32 s9, s19, 0
    s_and_b32 s9, s9, 0xffff
    s_sub_u32 s10, 6291456, s7
    s_mov_b32 s11, 0x20000
    v_lshrrev_b32 v243, 3, v242
    s_lshl_b32 s3, s50, 4
    v_add_u32 v243, s3, v243
    v_lshlrev_b32 v243, 11, v243
    v_and_b32 v244, 7, v242
    v_lshrrev_b32 v245, 4, v242
    v_xor_b32 v246, v244, v245
    v_xor_b32 v247, 4, v246
    v_lshl_add_u32 v224, v246, 4, v243
    v_lshl_add_u32 v247, v247, 4, v243
    v_add_u32 v225, 0x3c00, v247
    v_add_u32 v226, 0x1f800, v224
    v_add_u32 v227, 0x23400, v247
    v_add_u32 v228, 0x40000, v224
    v_add_u32 v229, 0x43c00, v247
    v_add_u32 v230, 0x5f800, v224
    v_add_u32 v231, 0x63400, v247
    s_lshl_b32 s61, s50, 13
    s_lshl_b32 s3, s50, 3
    s_and_b32 s4, s3, 8
    v_and_b32 v243, 15, v242
    v_lshlrev_b32 v244, 1, v245
    v_xor_b32 v243, v243, v244
    v_xor_b32 v243, s4, v243
    v_cmp_gt_u32 vcc, 14, v243
    v_lshlrev_b32 v243, 4, v243
    v_add_u32 v244, s3, v245
    s_movk_i32 s5, 7168
    v_mad_u32_u24 v243, v244, s5, v243
    v_mov_b32 v244, 0x70000000
    v_cndmask_b32 v232, v244, v243, vcc
    v_add_u32 v233, 0x6c00, v232
    s_lshr_b32 s4, s4, 2
    s_movk_i32 s5, 6144
    v_mul_u32_u24 v244, 5462, v242
    v_lshrrev_b32 v244, 16, v244
    v_mul_u32_u24 v246, 12, v244
    v_sub_u32 v246, v242, v246
    v_xor_b32 v246, s4, v246
    v_lshrrev_b32 v247, 2, v246
    v_lshlrev_b32 v247, 11, v247
    v_and_b32 v246, 3, v246
    v_lshl_add_u32 v246, v246, 4, v247
    v_add_u32 v244, s3, v244
    v_mad_u32_u24 v234, v244, s5, v246
    v_add_u32 v243, 64, v242
    v_mul_u32_u24 v244, 5462, v243
    v_lshrrev_b32 v244, 16, v244
    v_mul_u32_u24 v246, 12, v244
    v_sub_u32 v246, v243, v246
    v_xor_b32 v246, s4, v246
    v_lshrrev_b32 v247, 2, v246
    v_lshlrev_b32 v247, 11, v247
    v_and_b32 v246, 3, v246
    v_lshl_add_u32 v246, v246, 4, v247
    v_add_u32 v244, s3, v244
    v_mad_u32_u24 v235, v244, s5, v246
    v_subrev_u32 v235, 1024, v235
    s_mul_i32 s62, s50, 3584
    s_add_u32 s62, s62, 0x18000
    s_mov_b32 s44, s34
    s_and_b32 s45, s35, 0xffff
    s_mov_b32 s46, 0x10000000
    s_mov_b32 s47, 0x20000
    v_and_b32 v243, 15, v242
    v_lshrrev_b32 v244, 4, v242
    v_lshrrev_b32 v245, 1, v243
    v_xor_b32 v245, v245, v244
    v_lshlrev_b32 v246, 7, v243
    v_add_u32 v246, s61, v246
    v_lshl_add_u32 v236, v245, 4, v246
    v_xor_b32 v237, 64, v236
    v_bfe_u32 v245, v242, 2, 2
    v_and_b32 v246, 3, v242
    v_and_b32 v247, 1, v244
    v_mul_u32_u24 v248, 3584, v244
    v_lshl_add_u32 v248, v246, 3, v248
    v_add_u32 v248, 0x18000, v248
    s_movk_i32 s5, 2048
    v_mul_u32_u24 v246, 192, v245
    v_add3_u32 v246, v246, v248, s5
    v_lshl_add_u32 v240, v247, 5, v246
    v_xor_b32 v243, 1, v247
    v_lshl_add_u32 v241, v243, 5, v246
    v_lshl_add_u32 v248, v245, 8, v248
    v_lshl_add_u32 v247, v247, 2, v245
    v_lshl_add_u32 v248, v247, 5, v248
    s_lshl_b32 s3, s65, 5
    v_xor_b32 v208, s3, v248
    s_add_u32 s3, s3, 32
    v_xor_b32 v209, s3, v248
    s_add_u32 s3, s3, 32
    v_xor_b32 v210, s3, v248
    s_add_u32 s3, s3, 32
    v_xor_b32 v211, s3, v248
    s_add_u32 s3, s3, 32
    v_xor_b32 v212, s3, v248
    s_add_u32 s3, s3, 32
    v_xor_b32 v213, s3, v248
    s_cmp_eq_u32 s65, 0
    s_cselect_b32 s3, 192, 0
    v_xor_b32 v214, s3, v248
    s_and_b32 s3, s50, 1
    s_lshl_b32 s3, s3, 7
    s_lshr_b32 s4, s50, 1
    s_add_u32 s3, s3, s4
    s_lshl_b32 s4, s52, 1
    s_add_u32 s3, s3, s4
    s_lshl_b32 s3, s3, 11
    v_and_b32 v221, 31, v242
    v_lshlrev_b32 v221, 3, v221
    v_lshrrev_b32 v243, 5, v242
    v_lshl_add_u32 v220, v243, 17, v221
    v_add_u32 v220, s3, v220
    v_mov_b32 v222, 0
    s_mov_b32 s96, s28
    s_and_b32 s97, s29, 0xffff
    s_movk_i32 s98, 2048
    s_mov_b32 s99, 0x20000
    s_and_b32 s3, s2, 7
    s_lshl_b32 s3, s3, 5
    s_lshr_b32 s4, s2, 3
    s_add_u32 s3, s3, s4
    s_lshl_b32 s3, s3, 2
    s_add_u32 s3, s3, s50
    s_mul_i32 s3, s3, 7168
    s_mov_b32 s16, s3
    s_bitcmp1_b32 s2, 0
    s_cselect_b32 s17, 0xffe40000, 0
    s_add_u32 s17, s17, 0xe0000
    s_and_b32 s27, s27, 0xffff
    v_cmp_gt_u32 vcc, 56, v242
    v_lshlrev_b32 v249, 7, v242
    v_mov_b32 v248, 0x70000000
    v_cndmask_b32 v249, v248, v249, vcc
    s_lshl_b32 s3, s2, 7
    s_add_u32 s3, s3, 0x400000
    v_lshl_add_u32 v247, v242, 20, s3
    s_cmp_eq_u32 s50, 1
    s_cselect_b32 s3, 38, 0
    v_cmp_gt_u32 vcc, s3, v242
    s_and_b32 vcc_lo, vcc_lo, 0x0
    s_and_b32 vcc_hi, vcc_hi, 0x30
    v_cndmask_b32 v247, v248, v247, vcc
    s_getpc_b64 s[4:5]
L_crp:
    s_and_b32 s4, s4, 0xffffff80
    s_and_b32 s5, s5, 0xffff
    s_mov_b32 s6, L_end-L_crp
    s_mov_b32 s7, 0x20000
    s_lshr_b32 s3, s2, 3
    s_lshl_b32 s3, s3, 2
    s_add_u32 s3, s3, s50
    s_lshl_b32 s3, s3, 7
    v_lshlrev_b32 v215, 14, v242
    v_add_u32 v215, s3, v215
    s_mov_b32 s18, 2
    v_mov_b64 v[0:1], 0
    v_mov_b64 v[2:3], 0
    v_mov_b64 v[4:5], 0
    v_mov_b64 v[6:7], 0
    v_mov_b64 v[8:9], 0
    v_mov_b64 v[10:11], 0
    v_mov_b64 v[12:13], 0
    v_mov_b64 v[14:15], 0
    v_mov_b64 v[16:17], 0
    v_mov_b64 v[18:19], 0
    v_mov_b64 v[20:21], 0
    v_mov_b64 v[22:23], 0
    v_mov_b64 v[24:25], 0
    v_mov_b64 v[26:27], 0
    v_mov_b64 v[28:29], 0
    v_mov_b64 v[30:31], 0
    v_mov_b64 v[32:33], 0
    v_mov_b64 v[34:35], 0
    v_mov_b64 v[36:37], 0
    v_mov_b64 v[38:39], 0
    v_mov_b64 v[40:41], 0
    v_mov_b64 v[42:43], 0
    v_mov_b64 v[44:45], 0
    v_mov_b64 v[46:47], 0
    v_mov_b64 v[48:49], 0
    v_mov_b64 v[50:51], 0
    v_mov_b64 v[52:53], 0
    v_mov_b64 v[54:55], 0
    v_mov_b64 v[56:57], 0
    v_mov_b64 v[58:59], 0
    v_mov_b64 v[60:61], 0
    v_mov_b64 v[62:63], 0
    v_mov_b64 v[64:65], 0
    v_mov_b64 v[66:67], 0
    v_mov_b64 v[68:69], 0
    v_mov_b64 v[70:71], 0
    v_mov_b64 v[72:73], 0
    v_mov_b64 v[74:75], 0
    v_mov_b64 v[76:77], 0
    v_mov_b64 v[78:79], 0
    v_mov_b64 v[80:81], 0
    v_mov_b64 v[82:83], 0
    v_mov_b64 v[84:85], 0
    v_mov_b64 v[86:87], 0
    v_mov_b64 v[88:89], 0
    v_mov_b64 v[90:91], 0
    v_mov_b64 v[92:93], 0
    v_mov_b64 v[94:95], 0
    v_mov_b64 v[96:97], 0
    v_mov_b64 v[98:99], 0
    v_mov_b64 v[100:101], 0
    v_mov_b64 v[102:103], 0
    v_mov_b64 v[104:105], 0
    v_mov_b64 v[106:107], 0
    v_mov_b64 v[108:109], 0
    v_mov_b64 v[110:111], 0
    v_mov_b64 v[112:113], 0
    v_mov_b64 v[114:115], 0
    v_mov_b64 v[116:117], 0
    v_mov_b64 v[118:119], 0
    v_mov_b64 v[120:121], 0
    v_mov_b64 v[122:123], 0
    v_mov_b64 v[124:125], 0
    v_mov_b64 v[126:127], 0
    v_mov_b64 v[128:129], 0
    v_mov_b64 v[130:131], 0
    v_mov_b64 v[132:133], 0
    v_mov_b64 v[134:135], 0
    v_mov_b64 v[136:137], 0
    v_mov_b64 v[138:139], 0
    v_mov_b64 v[140:141], 0
    v_mov_b64 v[142:143], 0
    v_mov_b64 v[144:145], 0
    v_mov_b64 v[146:147], 0
    v_mov_b64 v[148:149], 0
    v_mov_b64 v[150:151], 0
    v_mov_b64 v[152:153], 0
    v_mov_b64 v[154:155], 0
    v_mov_b64 v[156:157], 0
    v_mov_b64 v[158:159], 0
    v_mov_b64 v[160:161], 0
    v_mov_b64 v[162:163], 0
    v_mov_b64 v[164:165], 0
    v_mov_b64 v[166:167], 0
    v_mov_b64 v[168:169], 0
    v_mov_b64 v[170:171], 0
    v_mov_b64 v[172:173], 0
    v_mov_b64 v[174:175], 0
    v_mov_b64 v[176:177], 0
    v_mov_b64 v[178:179], 0
    v_mov_b64 v[180:181], 0
    v_mov_b64 v[182:183], 0
    v_mov_b64 v[184:185], 0
    v_mov_b64 v[186:187], 0
    v_mov_b64 v[188:189], 0
    v_mov_b64 v[190:191], 0
    v_mov_b64 v[192:193], 0
    v_mov_b64 v[194:195], 0
    v_mov_b64 v[196:197], 0
    v_mov_b64 v[198:199], 0
    v_mov_b64 v[200:201], 0
    v_mov_b64 v[202:203], 0
    v_mov_b64 v[204:205], 0
    v_mov_b64 v[206:207], 0
    v_lshlrev_b32 v243, 9, v242
    s_mov_b32 s58, 0x0
    s_add_u32 m0, s61, 0x0
    s_nop 0
    buffer_load_dwordx4 v224, s[36:39], s58 offen lds
    buffer_load_dwordx4 v225, s[36:39], s58 offen offset:1024 lds
    buffer_load_dwordx4 v226, s[36:39], s58 offen offset:2048 lds
    buffer_load_dwordx4 v227, s[36:39], s58 offen offset:3072 lds
    s_mov_b32 s59, 0x0
    s_add_u32 m0, s62, 0x0
    s_nop 0
    buffer_load_dwordx4 v232, s[40:43], s59 offen lds
    buffer_load_dwordx4 v233, s[40:43], s59 offen offset:1024 lds
    s_mov_b32 s63, 0x0
    s_add_u32 m0, s62, 0x800
    s_nop 0
    buffer_load_dwordx4 v234, s[8:11], s63 offen lds
    s_mov_b32 exec_hi, 0
    buffer_load_dwordx4 v235, s[8:11], s63 offen offset:1024 lds
    s_mov_b32 exec_hi, -1
    s_mov_b32 s58, 0x0
    s_add_u32 m0, s61, 0x1000
    s_nop 0
    buffer_load_dwordx4 v228, s[36:39], s58 offen lds
    buffer_load_dwordx4 v229, s[36:39], s58 offen offset:1024 lds
    buffer_load_dwordx4 v230, s[36:39], s58 offen offset:2048 lds
    buffer_load_dwordx4 v231, s[36:39], s58 offen offset:3072 lds
    s_mov_b32 s59, 0x38000
    s_add_u32 m0, s62, 0x3800
    s_nop 0
    buffer_load_dwordx4 v232, s[40:43], s59 offen lds
    buffer_load_dwordx4 v233, s[40:43], s59 offen offset:1024 lds
    s_mov_b32 s63, 0x30000
    s_add_u32 m0, s62, 0x4000
    s_nop 0
    buffer_load_dwordx4 v234, s[8:11], s63 offen lds
    s_mov_b32 exec_hi, 0
    buffer_load_dwordx4 v235, s[8:11], s63 offen offset:1024 lds
    s_mov_b32 exec_hi, -1
    s_mov_b32 s58, 0x80
    s_add_u32 m0, s61, 0x8000
    s_nop 0
    buffer_load_dwordx4 v224, s[36:39], s58 offen lds
    buffer_load_dwordx4 v225, s[36:39], s58 offen offset:1024 lds
    buffer_load_dwordx4 v226, s[36:39], s58 offen offset:2048 lds
    buffer_load_dwordx4 v227, s[36:39], s58 offen offset:3072 lds
    v_add_u32 v238, s54, v236
    s_waitcnt vmcnt(8)
    s_barrier
    ds_read_b64_tr_b16 a[64:65], v240 offset:0
    ds_read_b64_tr_b16 a[66:67], v240 offset:768
    s_mov_b32 s58, 0x80
    s_add_u32 m0, s61, 0x9000
    s_nop 0
    buffer_load_dwordx4 v228, s[36:39], s58 offen lds
    ds_read_b64_tr_b16 a[68:69], v241 offset:0
    ds_read_b64_tr_b16 a[70:71], v241 offset:768
    ds_read_b64_tr_b16 a[72:73], v240 offset:64
    buffer_load_dwordx4 v229, s[36:39], s58 offen offset:1024 lds
    ds_read_b64_tr_b16 a[74:75], v240 offset:832
    ds_read_b128 a[0:3], v238 offset:0
    buffer_load_dwordx4 v230, s[36:39], s58 offen offset:2048 lds
    ds_read_b64_tr_b16 a[76:77], v241 offset:64
    ds_read_b64_tr_b16 a[78:79], v241 offset:832
    ds_read_b128 a[4:7], v238 offset:2048
    buffer_load_dwordx4 v231, s[36:39], s58 offen offset:3072 lds
    ds_read_b64_tr_b16 a[80:81], v240 offset:128
    ds_read_b64_tr_b16 a[82:83], v240 offset:896
    ds_read_b128 a[8:11], v238 offset:4096
    s_mov_b32 s59, 0x70000
    s_add_u32 m0, s62, 0x7000
    s_nop 0
    buffer_load_dwordx4 v232, s[40:43], s59 offen lds
    ds_read_b64_tr_b16 a[84:85], v241 offset:128
    ds_read_b64_tr_b16 a[86:87], v241 offset:896
    ds_read_b128 a[12:15], v238 offset:6144
    buffer_load_dwordx4 v233, s[40:43], s59 offen offset:1024 lds
    ds_read_b64_tr_b16 a[88:89], v208 offset:0
    ds_read_b64_tr_b16 a[90:91], v208 offset:1024
    s_mov_b32 s63, 0x60000
    s_add_u32 m0, s62, 0x7800
    s_nop 0
    buffer_load_dwordx4 v234, s[8:11], s63 offen lds
    ds_read_b64_tr_b16 a[92:93], v209 offset:0
    ds_read_b64_tr_b16 a[94:95], v209 offset:1024
    s_mov_b32 exec_hi, 0
    buffer_load_dwordx4 v235, s[8:11], s63 offen offset:1024 lds
    s_mov_b32 exec_hi, -1
    ds_read_b64_tr_b16 a[96:97], v210 offset:0
    ds_read_b64_tr_b16 a[98:99], v210 offset:1024
    ds_read_b64_tr_b16 a[100:101], v211 offset:0
    ds_read_b64_tr_b16 a[102:103], v211 offset:1024
    ds_read_b64_tr_b16 a[104:105], v212 offset:0
    ds_read_b64_tr_b16 a[106:107], v212 offset:1024
    ds_read_b64_tr_b16 a[108:109], v213 offset:0
    ds_read_b64_tr_b16 a[110:111], v213 offset:1024
    buffer_load_dwordx2 v[216:217], v220, s[36:39], s12 offen
    buffer_load_dwordx2 v[218:219], v221, s[96:99], s12 offen
    s_add_u32 s12, s12, 256
    buffer_load_dword v250, v251, s[84:87], s64 offen
    ds_read_b64_tr_b16 a[112:113], v214 offset:0
    ds_read_b64_tr_b16 a[114:115], v214 offset:1024
    s_nop 1
    s_mov_b32 s60, 7
    s_waitcnt lgkmcnt(15)
    v_mfma_f32_16x16x32_bf16 v[0:3], a[64:67], a[0:3], v[0:3]
    s_mov_b32 s56, s53
    s_cmp_eq_u32 s60, s94
    s_cbranch_scc0 L_pfrp_0
    buffer_load_dword v250, v251, s[84:87], s88 offen
    s_mov_b64 exec, s[92:93]
    buffer_load_dword v250, v251, s[84:87], s89 offen
    s_mov_b64 exec, -1
    buffer_load_dword v250, v248, s[44:47], 0 offen sc1
    v_bfrev_b32 v248, 2
    s_sub_u32 s94, s94, s18
    s_add_u32 s88, s88, s90
    s_add_u32 s89, s89, s90
    s_add_u32 s91, s91, 0x80000000
    s_cbranch_scc0 L_pfrp_0
    s_mov_b64 s[84:85], s[26:27]
    s_mov_b32 s86, 0x700000
    v_mov_b32 v251, v249
    s_mov_b32 s88, s16
    s_mov_b32 s89, 0x80000000
    s_mov_b32 s90, s17
    s_mov_b32 s16, 0x80000000
    s_mov_b32 s18, 1
    v_mov_b32 v248, v247
    v_bfrev_b32 v247, 2
L_pfrp_0:
    v_mfma_f32_16x16x32_bf16 v[4:7], a[64:67], a[4:7], v[4:7]
    s_mov_b32 s53, s54
    v_mfma_f32_16x16x32_bf16 v[8:11], a[64:67], a[8:11], v[8:11]
    s_mov_b32 s54, s55
    s_waitcnt lgkmcnt(14)
    v_mfma_f32_16x16x32_bf16 v[12:15], a[64:67], a[12:15], v[12:15]
    s_mov_b32 s55, s56
    v_mfma_f32_16x16x32_bf16 v[16:19], a[68:71], a[0:3], v[16:19]
    v_add_u32 v239, s53, v237
    v_mfma_f32_16x16x32_bf16 v[20:23], a[68:71], a[4:7], v[20:23]
    v_mfma_f32_16x16x32_bf16 v[24:27], a[68:71], a[8:11], v[24:27]
    v_mfma_f32_16x16x32_bf16 v[28:31], a[68:71], a[12:15], v[28:31]
    s_waitcnt vmcnt(15) lgkmcnt(0)
    s_barrier
    ds_read_b64_tr_b16 a[64:65], v240 offset:14336
    v_mfma_f32_16x16x32_bf16 v[128:131], a[72:75], a[0:3], v[128:131]
    ds_read_b64_tr_b16 a[66:67], v240 offset:15104
    v_mfma_f32_16x16x32_bf16 v[132:135], a[72:75], a[4:7], v[132:135]
    ds_read_b64_tr_b16 a[68:69], v241 offset:14336
    v_mfma_f32_16x16x32_bf16 v[136:139], a[72:75], a[8:11], v[136:139]
    ds_read_b64_tr_b16 a[70:71], v241 offset:15104
    v_mfma_f32_16x16x32_bf16 v[140:143], a[72:75], a[12:15], v[140:143]
    ds_read_b64_tr_b16 a[72:73], v240 offset:14400
    v_mfma_f32_16x16x32_bf16 v[144:147], a[76:79], a[0:3], v[144:147]
    ds_read_b64_tr_b16 a[74:75], v240 offset:15168
    v_mfma_f32_16x16x32_bf16 v[148:151], a[76:79], a[4:7], v[148:151]
    ds_read_b128 a[16:19], v239 offset:0
    v_mfma_f32_16x16x32_bf16 v[152:155], a[76:79], a[8:11], v[152:155]
    v_mfma_f32_16x16x32_bf16 v[156:159], a[76:79], a[12:15], v[156:159]
    ds_read_b64_tr_b16 a[76:77], v241 offset:14400
    v_mfma_f32_16x16x32_bf16 v[160:163], a[0:3], a[80:83], v[160:163]
    ds_read_b64_tr_b16 a[78:79], v241 offset:15168
    v_mfma_f32_16x16x32_bf16 v[164:167], a[4:7], a[80:83], v[164:167]
    ds_read_b128 a[20:23], v239 offset:2048
    v_mfma_f32_16x16x32_bf16 v[168:171], a[8:11], a[80:83], v[168:171]
    v_mfma_f32_16x16x32_bf16 v[172:175], a[12:15], a[80:83], v[172:175]
    ds_read_b64_tr_b16 a[80:81], v240 offset:14464
    v_mfma_f32_16x16x32_bf16 v[176:179], a[0:3], a[84:87], v[176:179]
    ds_read_b64_tr_b16 a[82:83], v240 offset:15232
    v_mfma_f32_16x16x32_bf16 v[180:183], a[4:7], a[84:87], v[180:183]
    ds_read_b128 a[24:27], v239 offset:4096
    v_mfma_f32_16x16x32_bf16 v[184:187], a[8:11], a[84:87], v[184:187]
    v_mfma_f32_16x16x32_bf16 v[188:191], a[12:15], a[84:87], v[188:191]
    ds_read_b64_tr_b16 a[84:85], v241 offset:14464
    v_mfma_f32_16x16x32_bf16 v[32:35], a[88:91], a[0:3], v[32:35]
    ds_read_b64_tr_b16 a[86:87], v241 offset:15232
    v_mfma_f32_16x16x32_bf16 v[36:39], a[88:91], a[4:7], v[36:39]
    ds_read_b128 a[28:31], v239 offset:6144
    v_mfma_f32_16x16x32_bf16 v[40:43], a[88:91], a[8:11], v[40:43]
    v_mfma_f32_16x16x32_bf16 v[44:47], a[88:91], a[12:15], v[44:47]
    ds_read_b64_tr_b16 a[88:89], v208 offset:14336
    v_mfma_f32_16x16x32_bf16 v[48:51], a[92:95], a[0:3], v[48:51]
    ds_read_b64_tr_b16 a[90:91], v208 offset:15360
    v_mfma_f32_16x16x32_bf16 v[52:55], a[92:95], a[4:7], v[52:55]
    v_mfma_f32_16x16x32_bf16 v[56:59], a[92:95], a[8:11], v[56:59]
    v_mfma_f32_16x16x32_bf16 v[60:63], a[92:95], a[12:15], v[60:63]
    ds_read_b64_tr_b16 a[92:93], v209 offset:14336
    v_mfma_f32_16x16x32_bf16 v[64:67], a[96:99], a[0:3], v[64:67]
    ds_read_b64_tr_b16 a[94:95], v209 offset:15360
    s_mov_b32 s59, 0xa8000
    v_mfma_f32_16x16x32_bf16 v[68:71], a[96:99], a[4:7], v[68:71]
    s_add_u32 m0, s62, 0xa800
    v_mfma_f32_16x16x32_bf16 v[72:75], a[96:99], a[8:11], v[72:75]
    buffer_load_dwordx4 v232, s[40:43], s59 offen lds
    v_mfma_f32_16x16x32_bf16 v[76:79], a[96:99], a[12:15], v[76:79]
    ds_read_b64_tr_b16 a[96:97], v210 offset:14336
    v_mfma_f32_16x16x32_bf16 v[80:83], a[100:103], a[0:3], v[80:83]
    ds_read_b64_tr_b16 a[98:99], v210 offset:15360
    v_mfma_f32_16x16x32_bf16 v[84:87], a[100:103], a[4:7], v[84:87]
    v_mfma_f32_16x16x32_bf16 v[88:91], a[100:103], a[8:11], v[88:91]
    buffer_load_dwordx4 v233, s[40:43], s59 offen offset:1024 lds
    v_mfma_f32_16x16x32_bf16 v[92:95], a[100:103], a[12:15], v[92:95]
    ds_read_b64_tr_b16 a[100:101], v211 offset:14336
    v_mfma_f32_16x16x32_bf16 v[96:99], a[104:107], a[0:3], v[96:99]
    ds_read_b64_tr_b16 a[102:103], v211 offset:15360
    s_mov_b32 s63, 0x90000
    v_mfma_f32_16x16x32_bf16 v[100:103], a[104:107], a[4:7], v[100:103]
    s_add_u32 m0, s62, 0xb000
    v_mfma_f32_16x16x32_bf16 v[104:107], a[104:107], a[8:11], v[104:107]
    buffer_load_dwordx4 v234, s[8:11], s63 offen lds
    v_mfma_f32_16x16x32_bf16 v[108:111], a[104:107], a[12:15], v[108:111]
    ds_read_b64_tr_b16 a[104:105], v212 offset:14336
    v_mfma_f32_16x16x32_bf16 v[112:115], a[108:111], a[0:3], v[112:115]
    ds_read_b64_tr_b16 a[106:107], v212 offset:15360
    v_mfma_f32_16x16x32_bf16 v[116:119], a[108:111], a[4:7], v[116:119]
    v_mfma_f32_16x16x32_bf16 v[120:123], a[108:111], a[8:11], v[120:123]
    s_mov_b32 exec_hi, 0
    buffer_load_dwordx4 v235, s[8:11], s63 offen offset:1024 lds
    s_mov_b32 exec_hi, -1
    v_mfma_f32_16x16x32_bf16 v[124:127], a[108:111], a[12:15], v[124:127]
    ds_read_b64_tr_b16 a[108:109], v213 offset:14336
    v_mfma_f32_16x16x32_bf16 v[192:195], a[112:115], a[0:3], v[192:195]
    ds_read_b64_tr_b16 a[110:111], v213 offset:15360
    v_mfma_f32_16x16x32_bf16 v[196:199], a[112:115], a[4:7], v[196:199]
    v_mfma_f32_16x16x32_bf16 v[200:203], a[112:115], a[8:11], v[200:203]
    v_mfma_f32_16x16x32_bf16 v[204:207], a[112:115], a[12:15], v[204:207]
    ds_read_b64_tr_b16 a[112:113], v214 offset:14336
    ds_read_b64_tr_b16 a[114:115], v214 offset:15360
    s_waitcnt lgkmcnt(15)
    v_mfma_f32_16x16x32_bf16 v[0:3], a[64:67], a[16:19], v[0:3]
    v_mfma_f32_16x16x32_bf16 v[4:7], a[64:67], a[20:23], v[4:7]
    v_mfma_f32_16x16x32_bf16 v[8:11], a[64:67], a[24:27], v[8:11]
    s_waitcnt lgkmcnt(14)
    v_mfma_f32_16x16x32_bf16 v[12:15], a[64:67], a[28:31], v[12:15]
    v_mfma_f32_16x16x32_bf16 v[16:19], a[68:71], a[16:19], v[16:19]
    v_add_u32 v238, s54, v236
    v_mfma_f32_16x16x32_bf16 v[20:23], a[68:71], a[20:23], v[20:23]
    v_mfma_f32_16x16x32_bf16 v[24:27], a[68:71], a[24:27], v[24:27]
    v_mfma_f32_16x16x32_bf16 v[28:31], a[68:71], a[28:31], v[28:31]
    s_waitcnt vmcnt(7) lgkmcnt(0)
    s_barrier
    ds_read_b64_tr_b16 a[64:65], v240 offset:28672
    v_mfma_f32_16x16x32_bf16 v[128:131], a[72:75], a[16:19], v[128:131]
    ds_read_b64_tr_b16 a[66:67], v240 offset:29440
    v_mfma_f32_16x16x32_bf16 v[132:135], a[72:75], a[20:23], v[132:135]
    ds_read_b64_tr_b16 a[68:69], v241 offset:28672
    v_mfma_f32_16x16x32_bf16 v[136:139], a[72:75], a[24:27], v[136:139]
    ds_read_b64_tr_b16 a[70:71], v241 offset:29440
    v_mfma_f32_16x16x32_bf16 v[140:143], a[72:75], a[28:31], v[140:143]
    ds_read_b64_tr_b16 a[72:73], v240 offset:28736
    v_mfma_f32_16x16x32_bf16 v[144:147], a[76:79], a[16:19], v[144:147]
    ds_read_b64_tr_b16 a[74:75], v240 offset:29504
    v_mfma_f32_16x16x32_bf16 v[148:151], a[76:79], a[20:23], v[148:151]
    ds_read_b128 a[32:35], v238 offset:0
    v_mfma_f32_16x16x32_bf16 v[152:155], a[76:79], a[24:27], v[152:155]
    v_mfma_f32_16x16x32_bf16 v[156:159], a[76:79], a[28:31], v[156:159]
    ds_read_b64_tr_b16 a[76:77], v241 offset:28736
    v_mfma_f32_16x16x32_bf16 v[160:163], a[16:19], a[80:83], v[160:163]
    ds_read_b64_tr_b16 a[78:79], v241 offset:29504
    v_mfma_f32_16x16x32_bf16 v[164:167], a[20:23], a[80:83], v[164:167]
    ds_read_b128 a[36:39], v238 offset:2048
    v_mfma_f32_16x16x32_bf16 v[168:171], a[24:27], a[80:83], v[168:171]
    v_mfma_f32_16x16x32_bf16 v[172:175], a[28:31], a[80:83], v[172:175]
    ds_read_b64_tr_b16 a[80:81], v240 offset:28800
    v_mfma_f32_16x16x32_bf16 v[176:179], a[16:19], a[84:87], v[176:179]
    ds_read_b64_tr_b16 a[82:83], v240 offset:29568
    v_mfma_f32_16x16x32_bf16 v[180:183], a[20:23], a[84:87], v[180:183]
    ds_read_b128 a[40:43], v238 offset:4096
    v_mfma_f32_16x16x32_bf16 v[184:187], a[24:27], a[84:87], v[184:187]
    v_mfma_f32_16x16x32_bf16 v[188:191], a[28:31], a[84:87], v[188:191]
    ds_read_b64_tr_b16 a[84:85], v241 offset:28800
    v_mfma_f32_16x16x32_bf16 v[32:35], a[88:91], a[16:19], v[32:35]
    ds_read_b64_tr_b16 a[86:87], v241 offset:29568
    v_mfma_f32_16x16x32_bf16 v[36:39], a[88:91], a[20:23], v[36:39]
    ds_read_b128 a[44:47], v238 offset:6144
    v_mfma_f32_16x16x32_bf16 v[40:43], a[88:91], a[24:27], v[40:43]
    v_mfma_f32_16x16x32_bf16 v[44:47], a[88:91], a[28:31], v[44:47]
    ds_read_b64_tr_b16 a[88:89], v208 offset:28672
    v_mfma_f32_16x16x32_bf16 v[48:51], a[92:95], a[16:19], v[48:51]
    ds_read_b64_tr_b16 a[90:91], v208 offset:29696
    v_mfma_f32_16x16x32_bf16 v[52:55], a[92:95], a[20:23], v[52:55]
    v_mfma_f32_16x16x32_bf16 v[56:59], a[92:95], a[24:27], v[56:59]
    v_mfma_f32_16x16x32_bf16 v[60:63], a[92:95], a[28:31], v[60:63]
    ds_read_b64_tr_b16 a[92:93], v209 offset:28672
    v_mfma_f32_16x16x32_bf16 v[64:67], a[96:99], a[16:19], v[64:67]
    ds_read_b64_tr_b16 a[94:95], v209 offset:29696
    v_mfma_f32_16x16x32_bf16 v[68:71], a[96:99], a[20:23], v[68:71]
    v_mfma_f32_16x16x32_bf16 v[72:75], a[96:99], a[24:27], v[72:75]
    v_mfma_f32_16x16x32_bf16 v[76:79], a[96:99], a[28:31], v[76:79]
    ds_read_b64_tr_b16 a[96:97], v210 offset:28672
    v_mfma_f32_16x16x32_bf16 v[80:83], a[100:103], a[16:19], v[80:83]
    ds_read_b64_tr_b16 a[98:99], v210 offset:29696
    s_mov_b32 s59, 0xe0000
    v_mfma_f32_16x16x32_bf16 v[84:87], a[100:103], a[20:23], v[84:87]
    s_add_u32 m0, s62, 0x0
    v_mfma_f32_16x16x32_bf16 v[88:91], a[100:103], a[24:27], v[88:91]
    buffer_load_dwordx4 v232, s[40:43], s59 offen lds
    v_mfma_f32_16x16x32_bf16 v[92:95], a[100:103], a[28:31], v[92:95]
    ds_read_b64_tr_b16 a[100:101], v211 offset:28672
    v_mfma_f32_16x16x32_bf16 v[96:99], a[104:107], a[16:19], v[96:99]
    ds_read_b64_tr_b16 a[102:103], v211 offset:29696
    v_mfma_f32_16x16x32_bf16 v[100:103], a[104:107], a[20:23], v[100:103]
    v_mfma_f32_16x16x32_bf16 v[104:107], a[104:107], a[24:27], v[104:107]
    buffer_load_dwordx4 v233, s[40:43], s59 offen offset:1024 lds
    v_mfma_f32_16x16x32_bf16 v[108:111], a[104:107], a[28:31], v[108:111]
    ds_read_b64_tr_b16 a[104:105], v212 offset:28672
    v_mfma_f32_16x16x32_bf16 v[112:115], a[108:111], a[16:19], v[112:115]
    ds_read_b64_tr_b16 a[106:107], v212 offset:29696
    s_mov_b32 s63, 0xc0000
    v_mfma_f32_16x16x32_bf16 v[116:119], a[108:111], a[20:23], v[116:119]
    s_add_u32 m0, s62, 0x800
    v_mfma_f32_16x16x32_bf16 v[120:123], a[108:111], a[24:27], v[120:123]
    buffer_load_dwordx4 v234, s[8:11], s63 offen lds
    v_mfma_f32_16x16x32_bf16 v[124:127], a[108:111], a[28:31], v[124:127]
    ds_read_b64_tr_b16 a[108:109], v213 offset:28672
    v_mfma_f32_16x16x32_bf16 v[192:195], a[112:115], a[16:19], v[192:195]
    ds_read_b64_tr_b16 a[110:111], v213 offset:29696
    v_mfma_f32_16x16x32_bf16 v[196:199], a[112:115], a[20:23], v[196:199]
    v_mfma_f32_16x16x32_bf16 v[200:203], a[112:115], a[24:27], v[200:203]
    s_mov_b32 exec_hi, 0
    buffer_load_dwordx4 v235, s[8:11], s63 offen offset:1024 lds
    s_mov_b32 exec_hi, -1
    v_mfma_f32_16x16x32_bf16 v[204:207], a[112:115], a[28:31], v[204:207]
    ds_read_b64_tr_b16 a[112:113], v214 offset:28672
    ds_read_b64_tr_b16 a[114:115], v214 offset:29696
    s_mov_b32 s58, 0x100
    s_waitcnt lgkmcnt(15)
    v_mfma_f32_16x16x32_bf16 v[0:3], a[64:67], a[32:35], v[0:3]
    s_mov_b32 s56, s53
    s_add_u32 m0, s61, 0x10000
    v_mfma_f32_16x16x32_bf16 v[4:7], a[64:67], a[36:39], v[4:7]
    s_mov_b32 s53, s54
    buffer_load_dwordx4 v224, s[36:39], s58 offen lds
    v_mfma_f32_16x16x32_bf16 v[8:11], a[64:67], a[40:43], v[8:11]
    s_mov_b32 s54, s55
    s_waitcnt lgkmcnt(14)
    v_mfma_f32_16x16x32_bf16 v[12:15], a[64:67], a[44:47], v[12:15]
    s_mov_b32 s55, s56
    buffer_load_dwordx4 v225, s[36:39], s58 offen offset:1024 lds
    v_mfma_f32_16x16x32_bf16 v[16:19], a[68:71], a[32:35], v[16:19]
    v_add_u32 v239, s53, v237
    v_mfma_f32_16x16x32_bf16 v[20:23], a[68:71], a[36:39], v[20:23]
    v_mfma_f32_16x16x32_bf16 v[24:27], a[68:71], a[40:43], v[24:27]
    buffer_load_dwordx4 v226, s[36:39], s58 offen offset:2048 lds
    v_mfma_f32_16x16x32_bf16 v[28:31], a[68:71], a[44:47], v[28:31]
    s_waitcnt vmcnt(7) lgkmcnt(0)
    s_barrier
    ds_read_b64_tr_b16 a[64:65], v240 offset:43008
    v_mfma_f32_16x16x32_bf16 v[128:131], a[72:75], a[32:35], v[128:131]
    ds_read_b64_tr_b16 a[66:67], v240 offset:43776
    v_mfma_f32_16x16x32_bf16 v[132:135], a[72:75], a[36:39], v[132:135]
    ds_read_b64_tr_b16 a[68:69], v241 offset:43008
    v_mfma_f32_16x16x32_bf16 v[136:139], a[72:75], a[40:43], v[136:139]
    ds_read_b64_tr_b16 a[70:71], v241 offset:43776
    buffer_load_dwordx4 v227, s[36:39], s58 offen offset:3072 lds
    v_mfma_f32_16x16x32_bf16 v[140:143], a[72:75], a[44:47], v[140:143]
    ds_read_b64_tr_b16 a[72:73], v240 offset:43072
    v_mfma_f32_16x16x32_bf16 v[144:147], a[76:79], a[32:35], v[144:147]
    ds_read_b64_tr_b16 a[74:75], v240 offset:43840
    s_mov_b32 s58, 0x100
    v_mfma_f32_16x16x32_bf16 v[148:151], a[76:79], a[36:39], v[148:151]
    ds_read_b128 a[48:51], v239 offset:0
    s_add_u32 m0, s61, 0x11000
    v_mfma_f32_16x16x32_bf16 v[152:155], a[76:79], a[40:43], v[152:155]
    buffer_load_dwordx4 v228, s[36:39], s58 offen lds
    v_mfma_f32_16x16x32_bf16 v[156:159], a[76:79], a[44:47], v[156:159]
    ds_read_b64_tr_b16 a[76:77], v241 offset:43072
    v_mfma_f32_16x16x32_bf16 v[160:163], a[32:35], a[80:83], v[160:163]
    ds_read_b64_tr_b16 a[78:79], v241 offset:43840
    v_mfma_f32_16x16x32_bf16 v[164:167], a[36:39], a[80:83], v[164:167]
    ds_read_b128 a[52:55], v239 offset:2048
    v_mfma_f32_16x16x32_bf16 v[168:171], a[40:43], a[80:83], v[168:171]
    buffer_load_dwordx4 v229, s[36:39], s58 offen offset:1024 lds
    v_mfma_f32_16x16x32_bf16 v[172:175], a[44:47], a[80:83], v[172:175]
    ds_read_b64_tr_b16 a[80:81], v240 offset:43136
    v_mfma_f32_16x16x32_bf16 v[176:179], a[32:35], a[84:87], v[176:179]
    ds_read_b64_tr_b16 a[82:83], v240 offset:43904
    v_mfma_f32_16x16x32_bf16 v[180:183], a[36:39], a[84:87], v[180:183]
    ds_read_b128 a[56:59], v239 offset:4096
    v_mfma_f32_16x16x32_bf16 v[184:187], a[40:43], a[84:87], v[184:187]
    buffer_load_dwordx4 v230, s[36:39], s58 offen offset:2048 lds
    v_mfma_f32_16x16x32_bf16 v[188:191], a[44:47], a[84:87], v[188:191]
    ds_read_b64_tr_b16 a[84:85], v241 offset:43136
    v_mfma_f32_16x16x32_bf16 v[32:35], a[88:91], a[32:35], v[32:35]
    ds_read_b64_tr_b16 a[86:87], v241 offset:43904
    v_mfma_f32_16x16x32_bf16 v[36:39], a[88:91], a[36:39], v[36:39]
    ds_read_b128 a[60:63], v239 offset:6144
    v_mfma_f32_16x16x32_bf16 v[40:43], a[88:91], a[40:43], v[40:43]
    buffer_load_dwordx4 v231, s[36:39], s58 offen offset:3072 lds
    v_mfma_f32_16x16x32_bf16 v[44:47], a[88:91], a[44:47], v[44:47]
    ds_read_b64_tr_b16 a[88:89], v208 offset:43008
    s_mov_b32 s59, 0x118000
    v_mfma_f32_16x16x32_bf16 v[48:51], a[92:95], a[32:35], v[48:51]
    ds_read_b64_tr_b16 a[90:91], v208 offset:44032
    s_add_u32 m0, s62, 0x3800
    v_mfma_f32_16x16x32_bf16 v[52:55], a[92:95], a[36:39], v[52:55]
    buffer_load_dwordx4 v232, s[40:43], s59 offen lds
    v_mfma_f32_16x16x32_bf16 v[56:59], a[92:95], a[40:43], v[56:59]
    buffer_load_dwordx4 v233, s[40:43], s59 offen offset:1024 lds
    v_mfma_f32_16x16x32_bf16 v[60:63], a[92:95], a[44:47], v[60:63]
    ds_read_b64_tr_b16 a[92:93], v209 offset:43008
    v_mfma_f32_16x16x32_bf16 v[64:67], a[96:99], a[32:35], v[64:67]
    ds_read_b64_tr_b16 a[94:95], v209 offset:44032
    s_mov_b32 s63, 0xf0000
    v_mfma_f32_16x16x32_bf16 v[68:71], a[96:99], a[36:39], v[68:71]
    s_add_u32 m0, s62, 0x4000
    v_mfma_f32_16x16x32_bf16 v[72:75], a[96:99], a[40:43], v[72:75]
    buffer_load_dwordx4 v234, s[8:11], s63 offen lds
    v_mfma_f32_16x16x32_bf16 v[76:79], a[96:99], a[44:47], v[76:79]
    s_waitcnt lgkmcnt(5)
    s_barrier
    ds_read_b64_tr_b16 a[96:97], v210 offset:43008
    v_mfma_f32_16x16x32_bf16 v[80:83], a[100:103], a[32:35], v[80:83]
    ds_read_b64_tr_b16 a[98:99], v210 offset:44032
    v_mfma_f32_16x16x32_bf16 v[84:87], a[100:103], a[36:39], v[84:87]
    s_mov_b32 exec_hi, 0
    buffer_load_dwordx4 v235, s[8:11], s63 offen offset:1024 lds
    s_mov_b32 exec_hi, -1
    v_mfma_f32_16x16x32_bf16 v[88:91], a[100:103], a[40:43], v[88:91]
    v_mfma_f32_16x16x32_bf16 v[92:95], a[100:103], a[44:47], v[92:95]
    ds_read_b64_tr_b16 a[100:101], v211 offset:43008
    s_mov_b32 s58, 0x180
    v_mfma_f32_16x16x32_bf16 v[96:99], a[104:107], a[32:35], v[96:99]
    ds_read_b64_tr_b16 a[102:103], v211 offset:44032
    s_add_u32 m0, s61, 0x0
    v_mfma_f32_16x16x32_bf16 v[100:103], a[104:107], a[36:39], v[100:103]
    buffer_load_dwordx4 v224, s[36:39], s58 offen lds
    v_mfma_f32_16x16x32_bf16 v[104:107], a[104:107], a[40:43], v[104:107]
    buffer_load_dwordx4 v225, s[36:39], s58 offen offset:1024 lds
    v_mfma_f32_16x16x32_bf16 v[108:111], a[104:107], a[44:47], v[108:111]
    ds_read_b64_tr_b16 a[104:105], v212 offset:43008
    v_mfma_f32_16x16x32_bf16 v[112:115], a[108:111], a[32:35], v[112:115]
    ds_read_b64_tr_b16 a[106:107], v212 offset:44032
    v_mfma_f32_16x16x32_bf16 v[116:119], a[108:111], a[36:39], v[116:119]
    v_mfma_f32_16x16x32_bf16 v[120:123], a[108:111], a[40:43], v[120:123]
    buffer_load_dwordx4 v226, s[36:39], s58 offen offset:2048 lds
    v_mfma_f32_16x16x32_bf16 v[124:127], a[108:111], a[44:47], v[124:127]
    ds_read_b64_tr_b16 a[108:109], v213 offset:43008
    v_mfma_f32_16x16x32_bf16 v[192:195], a[112:115], a[32:35], v[192:195]
    ds_read_b64_tr_b16 a[110:111], v213 offset:44032
    v_mfma_f32_16x16x32_bf16 v[196:199], a[112:115], a[36:39], v[196:199]
    v_mfma_f32_16x16x32_bf16 v[200:203], a[112:115], a[40:43], v[200:203]
    buffer_load_dwordx4 v227, s[36:39], s58 offen offset:3072 lds
    v_mfma_f32_16x16x32_bf16 v[204:207], a[112:115], a[44:47], v[204:207]
    ds_read_b64_tr_b16 a[112:113], v214 offset:43008
    ds_read_b64_tr_b16 a[114:115], v214 offset:44032
    v_mfma_f32_16x16x32_bf16 v[0:3], a[64:67], a[48:51], v[0:3]
    s_mov_b32 s63, 0x120000
    v_mfma_f32_16x16x32_bf16 v[4:7], a[64:67], a[52:55], v[4:7]
    s_add_u32 m0, s62, 0x7800
    v_mfma_f32_16x16x32_bf16 v[8:11], a[64:67], a[56:59], v[8:11]
    buffer_load_dwordx4 v234, s[8:11], s63 offen lds
    s_waitcnt lgkmcnt(14)
    v_mfma_f32_16x16x32_bf16 v[12:15], a[64:67], a[60:63], v[12:15]
    v_mfma_f32_16x16x32_bf16 v[16:19], a[68:71], a[48:51], v[16:19]
    v_add_u32 v238, s54, v236
    v_mfma_f32_16x16x32_bf16 v[20:23], a[68:71], a[52:55], v[20:23]
    v_add_u32 v239, s54, v237
    v_mfma_f32_16x16x32_bf16 v[24:27], a[68:71], a[56:59], v[24:27]
    s_mov_b32 exec_hi, 0
    buffer_load_dwordx4 v235, s[8:11], s63 offen offset:1024 lds
    s_mov_b32 exec_hi, -1
    v_mfma_f32_16x16x32_bf16 v[28:31], a[68:71], a[60:63], v[28:31]
    s_waitcnt vmcnt(6) lgkmcnt(0)
    s_barrier
    ds_read_b64_tr_b16 a[64:65], v240 offset:0
    ds_read_b64_tr_b16 a[116:117], v240 offset:14336
    v_mfma_f32_16x16x32_bf16 v[128:131], a[72:75], a[48:51], v[128:131]
    ds_read_b64_tr_b16 a[66:67], v240 offset:768
    s_mov_b32 s63, 0x150000
    ds_read_b64_tr_b16 a[118:119], v240 offset:15104
    v_mfma_f32_16x16x32_bf16 v[132:135], a[72:75], a[52:55], v[132:135]
    ds_read_b64_tr_b16 a[68:69], v241 offset:0
    v_dot2_f32_bf16 v222, v216, v218, v222
    s_add_u32 m0, s62, 0xb000
    ds_read_b64_tr_b16 a[120:121], v241 offset:14336
    v_mfma_f32_16x16x32_bf16 v[136:139], a[72:75], a[56:59], v[136:139]
    ds_read_b64_tr_b16 a[70:71], v241 offset:768
    v_dot2_f32_bf16 v222, v217, v219, v222
    buffer_load_dwordx4 v234, s[8:11], s63 offen lds
    ds_read_b64_tr_b16 a[122:123], v241 offset:15104
    v_mfma_f32_16x16x32_bf16 v[140:143], a[72:75], a[60:63], v[140:143]
    ds_read_b64_tr_b16 a[72:73], v240 offset:64
    ds_read_b64_tr_b16 a[124:125], v240 offset:14400
    v_mfma_f32_16x16x32_bf16 v[144:147], a[76:79], a[48:51], v[144:147]
    ds_read_b64_tr_b16 a[74:75], v240 offset:832
    ds_read_b64_tr_b16 a[126:127], v240 offset:15168
    v_mfma_f32_16x16x32_bf16 v[148:151], a[76:79], a[52:55], v[148:151]
    ds_read_b128 a[0:3], v238 offset:0
    s_mov_b32 exec_hi, 0
    buffer_load_dwordx4 v235, s[8:11], s63 offen offset:1024 lds
    s_mov_b32 exec_hi, -1
    v_mfma_f32_16x16x32_bf16 v[152:155], a[76:79], a[56:59], v[152:155]
    v_mfma_f32_16x16x32_bf16 v[156:159], a[76:79], a[60:63], v[156:159]
    ds_read_b64_tr_b16 a[76:77], v241 offset:64
    s_mov_b32 s59, 0x150000
    ds_read_b64_tr_b16 a[128:129], v241 offset:14400
    v_mfma_f32_16x16x32_bf16 v[160:163], a[48:51], a[80:83], v[160:163]
    ds_read_b64_tr_b16 a[78:79], v241 offset:832
    s_add_u32 m0, s62, 0x7000
    ds_read_b64_tr_b16 a[130:131], v241 offset:15168
    v_mfma_f32_16x16x32_bf16 v[164:167], a[52:55], a[80:83], v[164:167]
    ds_read_b128 a[4:7], v238 offset:2048
    buffer_load_dwordx4 v232, s[40:43], s59 offen lds
    v_mfma_f32_16x16x32_bf16 v[168:171], a[56:59], a[80:83], v[168:171]
    buffer_load_dwordx4 v233, s[40:43], s59 offen offset:1024 lds
    v_mfma_f32_16x16x32_bf16 v[172:175], a[60:63], a[80:83], v[172:175]
    ds_read_b64_tr_b16 a[80:81], v240 offset:128
    s_mov_b32 s59, 0x188000
    ds_read_b64_tr_b16 a[132:133], v240 offset:14464
    v_mfma_f32_16x16x32_bf16 v[176:179], a[48:51], a[84:87], v[176:179]
    ds_read_b64_tr_b16 a[82:83], v240 offset:896
    s_add_u32 m0, s62, 0xa800
    ds_read_b64_tr_b16 a[134:135], v240 offset:15232
    v_mfma_f32_16x16x32_bf16 v[180:183], a[52:55], a[84:87], v[180:183]
    ds_read_b128 a[8:11], v238 offset:4096
    buffer_load_dwordx4 v232, s[40:43], s59 offen lds
    v_mfma_f32_16x16x32_bf16 v[184:187], a[56:59], a[84:87], v[184:187]
    buffer_load_dwordx4 v233, s[40:43], s59 offen offset:1024 lds
    v_mfma_f32_16x16x32_bf16 v[188:191], a[60:63], a[84:87], v[188:191]
    ds_read_b64_tr_b16 a[84:85], v241 offset:128
    s_mov_b32 s58, 0x180
    ds_read_b64_tr_b16 a[136:137], v241 offset:14464
    v_mfma_f32_16x16x32_bf16 v[32:35], a[88:91], a[48:51], v[32:35]
    ds_read_b64_tr_b16 a[86:87], v241 offset:896
    s_add_u32 m0, s61, 0x1000
    ds_read_b64_tr_b16 a[138:139], v241 offset:15232
    v_mfma_f32_16x16x32_bf16 v[36:39], a[88:91], a[52:55], v[36:39]
    ds_read_b128 a[12:15], v238 offset:6144
    buffer_load_dwordx4 v228, s[36:39], s58 offen lds
    v_mfma_f32_16x16x32_bf16 v[40:43], a[88:91], a[56:59], v[40:43]
    buffer_load_dwordx4 v229, s[36:39], s58 offen offset:1024 lds
    v_mfma_f32_16x16x32_bf16 v[44:47], a[88:91], a[60:63], v[44:47]
    ds_read_b64_tr_b16 a[88:89], v208 offset:0
    ds_read_b64_tr_b16 a[140:141], v208 offset:14336
    v_mfma_f32_16x16x32_bf16 v[48:51], a[92:95], a[48:51], v[48:51]
    ds_read_b64_tr_b16 a[90:91], v208 offset:1024
    ds_read_b64_tr_b16 a[142:143], v208 offset:15360
    v_mfma_f32_16x16x32_bf16 v[52:55], a[92:95], a[52:55], v[52:55]
    buffer_load_dwordx4 v230, s[36:39], s58 offen offset:2048 lds
    ds_read_b128 a[16:19], v239 offset:0
    v_mfma_f32_16x16x32_bf16 v[56:59], a[92:95], a[56:59], v[56:59]
    buffer_load_dwordx4 v231, s[36:39], s58 offen offset:3072 lds
    v_mfma_f32_16x16x32_bf16 v[60:63], a[92:95], a[60:63], v[60:63]
    ds_read_b64_tr_b16 a[92:93], v209 offset:0
    s_mov_b32 s58, 0x200
    ds_read_b64_tr_b16 a[144:145], v209 offset:14336
    v_mfma_f32_16x16x32_bf16 v[64:67], a[96:99], a[48:51], v[64:67]
    ds_read_b64_tr_b16 a[94:95], v209 offset:1024
    s_add_u32 m0, s61, 0x8000
    ds_read_b64_tr_b16 a[146:147], v209 offset:15360
    v_mfma_f32_16x16x32_bf16 v[68:71], a[96:99], a[52:55], v[68:71]
    buffer_load_dwordx4 v224, s[36:39], s58 offen lds
    ds_read_b128 a[20:23], v239 offset:2048
    v_mfma_f32_16x16x32_bf16 v[72:75], a[96:99], a[56:59], v[72:75]
    buffer_load_dwordx4 v225, s[36:39], s58 offen offset:1024 lds
    v_mfma_f32_16x16x32_bf16 v[76:79], a[96:99], a[60:63], v[76:79]
    s_waitcnt lgkmcnt(11)
    s_barrier
    ds_read_b64_tr_b16 a[96:97], v210 offset:0
    ds_read_b64_tr_b16 a[148:149], v210 offset:14336
    v_mfma_f32_16x16x32_bf16 v[80:83], a[100:103], a[48:51], v[80:83]
    ds_read_b64_tr_b16 a[98:99], v210 offset:1024
    ds_read_b64_tr_b16 a[150:151], v210 offset:15360
    v_mfma_f32_16x16x32_bf16 v[84:87], a[100:103], a[52:55], v[84:87]
    buffer_load_dwordx4 v226, s[36:39], s58 offen offset:2048 lds
    ds_read_b128 a[24:27], v239 offset:4096
    v_mfma_f32_16x16x32_bf16 v[88:91], a[100:103], a[56:59], v[88:91]
    buffer_load_dwordx4 v227, s[36:39], s58 offen offset:3072 lds
    v_mfma_f32_16x16x32_bf16 v[92:95], a[100:103], a[60:63], v[92:95]
    ds_read_b64_tr_b16 a[100:101], v211 offset:0
    ds_read_b64_tr_b16 a[152:153], v211 offset:14336
    v_mfma_f32_16x16x32_bf16 v[96:99], a[104:107], a[48:51], v[96:99]
    ds_read_b64_tr_b16 a[102:103], v211 offset:1024
    s_mov_b32 s63, 0x180000
    ds_read_b64_tr_b16 a[154:155], v211 offset:15360
    v_mfma_f32_16x16x32_bf16 v[100:103], a[104:107], a[52:55], v[100:103]
    s_add_u32 m0, s62, 0x800
    ds_read_b128 a[28:31], v239 offset:6144
    v_mfma_f32_16x16x32_bf16 v[104:107], a[104:107], a[56:59], v[104:107]
    buffer_load_dwordx4 v234, s[8:11], s63 offen lds
    v_mfma_f32_16x16x32_bf16 v[108:111], a[104:107], a[60:63], v[108:111]
    ds_read_b64_tr_b16 a[104:105], v212 offset:0
    ds_read_b64_tr_b16 a[156:157], v212 offset:14336
    v_mfma_f32_16x16x32_bf16 v[112:115], a[108:111], a[48:51], v[112:115]
    ds_read_b64_tr_b16 a[106:107], v212 offset:1024
    ds_read_b64_tr_b16 a[158:159], v212 offset:15360
    v_mfma_f32_16x16x32_bf16 v[116:119], a[108:111], a[52:55], v[116:119]
    s_mov_b32 exec_hi, 0
    buffer_load_dwordx4 v235, s[8:11], s63 offen offset:1024 lds
    s_mov_b32 exec_hi, -1
    s_mov_b32 s63, 0x1b0000
    ds_read_b64_tr_b16 a[160:161], v213 offset:14336
    v_mfma_f32_16x16x32_bf16 v[120:123], a[108:111], a[56:59], v[120:123]
    s_add_u32 m0, s62, 0x4000
    v_mfma_f32_16x16x32_bf16 v[124:127], a[108:111], a[60:63], v[124:127]
    ds_read_b64_tr_b16 a[108:109], v213 offset:0
    buffer_load_dwordx4 v234, s[8:11], s63 offen lds
    ds_read_b64_tr_b16 a[162:163], v213 offset:15360
    v_mfma_f32_16x16x32_bf16 v[192:195], a[112:115], a[48:51], v[192:195]
    ds_read_b64_tr_b16 a[110:111], v213 offset:1024
    buffer_load_dwordx2 v[216:217], v220, s[36:39], s12 offen
    ds_read_b64_tr_b16 a[164:165], v214 offset:14336
    v_mfma_f32_16x16x32_bf16 v[196:199], a[112:115], a[52:55], v[196:199]
    buffer_load_dwordx2 v[218:219], v221, s[96:99], s12 offen
    ds_read_b64_tr_b16 a[166:167], v214 offset:15360
    v_mfma_f32_16x16x32_bf16 v[200:203], a[112:115], a[56:59], v[200:203]
    s_add_u32 s12, s12, 256
    s_mov_b32 exec_hi, 0
    buffer_load_dwordx4 v235, s[8:11], s63 offen offset:1024 lds
    s_mov_b32 exec_hi, -1
    v_mfma_f32_16x16x32_bf16 v[204:207], a[112:115], a[60:63], v[204:207]
    ds_read_b64_tr_b16 a[112:113], v214 offset:0
    ds_read_b64_tr_b16 a[114:115], v214 offset:1024
    s_cmp_eq_u32 s60, s95
    s_cbranch_scc0 L_pfrp_1
    buffer_load_dword v250, v251, s[84:87], s88 offen
    s_mov_b64 exec, s[92:93]
    buffer_load_dword v250, v251, s[84:87], s89 offen
    s_mov_b64 exec, -1
    buffer_load_dword v250, v248, s[44:47], 0 offen sc1
    v_bfrev_b32 v248, 2
    s_sub_u32 s95, s95, s18
    s_add_u32 s88, s88, s90
    s_add_u32 s89, s89, s90
    s_add_u32 s91, s91, 0x80000000
    s_cbranch_scc0 L_pfrp_1
    s_mov_b64 s[84:85], s[26:27]
    s_mov_b32 s86, 0x700000
    v_mov_b32 v251, v249
    s_mov_b32 s88, s16
    s_mov_b32 s89, 0x80000000
    s_mov_b32 s90, s17
    s_mov_b32 s16, 0x80000000
    s_mov_b32 s18, 1
    v_mov_b32 v248, v247
    v_bfrev_b32 v247, 2
L_pfrp_1:
    s_waitcnt vmcnt(18) lgkmcnt(12)
    s_mov_b32 s60, 6
.p2align 6
L_g1_loop:
    v_add_u32 v238, s55, v236
    v_mfma_f32_16x16x32_bf16 v[0:3], a[64:67], a[0:3], v[0:3]
    v_add_u32 v239, s55, v237
    v_mfma_f32_16x16x32_bf16 v[0:3], a[116:119], a[16:19], v[0:3]
    s_mov_b32 s56, s53
    s_waitcnt vmcnt(23)
    ds_read_b128 a[32:35], v238 offset:0
    v_mfma_f32_16x16x32_bf16 v[4:7], a[64:67], a[4:7], v[4:7]
    s_mov_b32 s53, s54
    ds_read_b128 a[48:51], v239 offset:0
    v_mfma_f32_16x16x32_bf16 v[4:7], a[116:119], a[20:23], v[4:7]
    s_mov_b32 s54, s55
    ds_read_b128 a[36:39], v238 offset:2048
    s_waitcnt lgkmcnt(15)
    v_mfma_f32_16x16x32_bf16 v[8:11], a[64:67], a[8:11], v[8:11]
    s_mov_b32 s55, s56
    ds_read_b128 a[52:55], v239 offset:2048
    v_mfma_f32_16x16x32_bf16 v[8:11], a[116:119], a[24:27], v[8:11]
    v_mfma_f32_16x16x32_bf16 v[12:15], a[64:67], a[12:15], v[12:15]
    v_mfma_f32_16x16x32_bf16 v[12:15], a[116:119], a[28:31], v[12:15]
    s_waitcnt vmcnt(18) lgkmcnt(4)
    s_barrier
    ds_read_b64_tr_b16 a[64:65], v240 offset:28672
    v_mfma_f32_16x16x32_bf16 v[28:31], a[68:71], a[12:15], v[28:31]
    s_add_u32 s59, s59, 0x38000
    ds_read_b64_tr_b16 a[66:67], v240 offset:29440
    v_mfma_f32_16x16x32_bf16 v[28:31], a[120:123], a[28:31], v[28:31]
    s_add_u32 m0, s62, 0x0
    v_mfma_f32_16x16x32_bf16 v[24:27], a[68:71], a[8:11], v[24:27]
    buffer_load_dwordx4 v232, s[40:43], s59 offen lds
    v_mfma_f32_16x16x32_bf16 v[24:27], a[120:123], a[24:27], v[24:27]
    ds_read_b64_tr_b16 a[116:117], v240 offset:43008
    v_mfma_f32_16x16x32_bf16 v[20:23], a[68:71], a[4:7], v[20:23]
    ds_read_b64_tr_b16 a[118:119], v240 offset:43776
    v_mfma_f32_16x16x32_bf16 v[20:23], a[120:123], a[20:23], v[20:23]
    v_mfma_f32_16x16x32_bf16 v[16:19], a[68:71], a[0:3], v[16:19]
    buffer_load_dwordx4 v233, s[40:43], s59 offen offset:1024 lds
    v_mfma_f32_16x16x32_bf16 v[16:19], a[120:123], a[16:19], v[16:19]
    ds_read_b64_tr_b16 a[68:69], v241 offset:28672
    v_mfma_f32_16x16x32_bf16 v[128:131], a[72:75], a[0:3], v[128:131]
    s_add_u32 s59, s59, 0x38000
    ds_read_b64_tr_b16 a[70:71], v241 offset:29440
    v_mfma_f32_16x16x32_bf16 v[128:131], a[124:127], a[16:19], v[128:131]
    s_add_u32 m0, s62, 0x3800
    v_mfma_f32_16x16x32_bf16 v[132:135], a[72:75], a[4:7], v[132:135]
    buffer_load_dwordx4 v232, s[40:43], s59 offen lds
    v_mfma_f32_16x16x32_bf16 v[132:135], a[124:127], a[20:23], v[132:135]
    ds_read_b64_tr_b16 a[120:121], v241 offset:43008
    v_mfma_f32_16x16x32_bf16 v[136:139], a[72:75], a[8:11], v[136:139]
    ds_read_b64_tr_b16 a[122:123], v241 offset:43776
    v_mfma_f32_16x16x32_bf16 v[136:139], a[124:127], a[24:27], v[136:139]
    v_mfma_f32_16x16x32_bf16 v[140:143], a[72:75], a[12:15], v[140:143]
    buffer_load_dwordx4 v233, s[40:43], s59 offen offset:1024 lds
    v_mfma_f32_16x16x32_bf16 v[140:143], a[124:127], a[28:31], v[140:143]
    ds_read_b64_tr_b16 a[72:73], v240 offset:28736
    v_mfma_f32_16x16x32_bf16 v[156:159], a[76:79], a[12:15], v[156:159]
    s_add_u32 m0, s61, s55
    ds_read_b64_tr_b16 a[74:75], v240 offset:29504
    v_mfma_f32_16x16x32_bf16 v[156:159], a[128:131], a[28:31], v[156:159]
    s_add_u32 m0, m0, 0x1000
    v_mfma_f32_16x16x32_bf16 v[152:155], a[76:79], a[8:11], v[152:155]
    buffer_load_dwordx4 v228, s[36:39], s58 offen lds
    v_mfma_f32_16x16x32_bf16 v[152:155], a[128:131], a[24:27], v[152:155]
    ds_read_b64_tr_b16 a[124:125], v240 offset:43072
    v_mfma_f32_16x16x32_bf16 v[148:151], a[76:79], a[4:7], v[148:151]
    ds_read_b64_tr_b16 a[126:127], v240 offset:43840
    v_mfma_f32_16x16x32_bf16 v[148:151], a[128:131], a[20:23], v[148:151]
    v_mfma_f32_16x16x32_bf16 v[144:147], a[76:79], a[0:3], v[144:147]
    buffer_load_dwordx4 v229, s[36:39], s58 offen offset:1024 lds
    v_mfma_f32_16x16x32_bf16 v[144:147], a[128:131], a[16:19], v[144:147]
    ds_read_b64_tr_b16 a[76:77], v241 offset:28736
    v_mfma_f32_16x16x32_bf16 v[160:163], a[0:3], a[80:83], v[160:163]
    ds_read_b64_tr_b16 a[78:79], v241 offset:29504
    v_mfma_f32_16x16x32_bf16 v[160:163], a[16:19], a[132:135], v[160:163]
    v_mfma_f32_16x16x32_bf16 v[164:167], a[4:7], a[80:83], v[164:167]
    buffer_load_dwordx4 v230, s[36:39], s58 offen offset:2048 lds
    v_mfma_f32_16x16x32_bf16 v[164:167], a[20:23], a[132:135], v[164:167]
    ds_read_b64_tr_b16 a[128:129], v241 offset:43072
    v_mfma_f32_16x16x32_bf16 v[168:171], a[8:11], a[80:83], v[168:171]
    ds_read_b64_tr_b16 a[130:131], v241 offset:43840
    v_mfma_f32_16x16x32_bf16 v[168:171], a[24:27], a[132:135], v[168:171]
    v_mfma_f32_16x16x32_bf16 v[172:175], a[12:15], a[80:83], v[172:175]
    buffer_load_dwordx4 v231, s[36:39], s58 offen offset:3072 lds
    v_mfma_f32_16x16x32_bf16 v[172:175], a[28:31], a[132:135], v[172:175]
    s_add_u32 s57, s57, 128
    ds_read_b64_tr_b16 a[80:81], v240 offset:28800
    v_mfma_f32_16x16x32_bf16 v[188:191], a[12:15], a[84:87], v[188:191]
    s_cmp_lt_u32 s57, 2048
    ds_read_b64_tr_b16 a[82:83], v240 offset:29568
    s_cselect_b32 s58, s57, 0x80000000
    v_mfma_f32_16x16x32_bf16 v[188:191], a[28:31], a[136:139], v[188:191]
    s_add_u32 m0, s61, s53
    v_mfma_f32_16x16x32_bf16 v[184:187], a[8:11], a[84:87], v[184:187]
    buffer_load_dwordx4 v224, s[36:39], s58 offen lds
    v_mfma_f32_16x16x32_bf16 v[184:187], a[24:27], a[136:139], v[184:187]
    ds_read_b64_tr_b16 a[132:133], v240 offset:43136
    v_mfma_f32_16x16x32_bf16 v[180:183], a[4:7], a[84:87], v[180:183]
    ds_read_b64_tr_b16 a[134:135], v240 offset:43904
    v_mfma_f32_16x16x32_bf16 v[180:183], a[20:23], a[136:139], v[180:183]
    v_mfma_f32_16x16x32_bf16 v[176:179], a[0:3], a[84:87], v[176:179]
    buffer_load_dwordx4 v225, s[36:39], s58 offen offset:1024 lds
    v_mfma_f32_16x16x32_bf16 v[176:179], a[16:19], a[136:139], v[176:179]
    ds_read_b64_tr_b16 a[84:85], v241 offset:28800
    v_mfma_f32_16x16x32_bf16 v[32:35], a[88:91], a[0:3], v[32:35]
    ds_read_b64_tr_b16 a[86:87], v241 offset:29568
    v_mfma_f32_16x16x32_bf16 v[32:35], a[140:143], a[16:19], v[32:35]
    v_mfma_f32_16x16x32_bf16 v[36:39], a[88:91], a[4:7], v[36:39]
    buffer_load_dwordx4 v226, s[36:39], s58 offen offset:2048 lds
    v_mfma_f32_16x16x32_bf16 v[36:39], a[140:143], a[20:23], v[36:39]
    ds_read_b64_tr_b16 a[136:137], v241 offset:43136
    v_mfma_f32_16x16x32_bf16 v[40:43], a[88:91], a[8:11], v[40:43]
    ds_read_b64_tr_b16 a[138:139], v241 offset:43904
    v_mfma_f32_16x16x32_bf16 v[40:43], a[140:143], a[24:27], v[40:43]
    s_waitcnt vmcnt(21)
    ds_read_b128 a[40:43], v238 offset:4096
    v_mfma_f32_16x16x32_bf16 v[44:47], a[88:91], a[12:15], v[44:47]
    buffer_load_dwordx4 v227, s[36:39], s58 offen offset:3072 lds
    v_mfma_f32_16x16x32_bf16 v[44:47], a[140:143], a[28:31], v[44:47]
    ds_read_b128 a[56:59], v239 offset:4096
    v_mfma_f32_16x16x32_bf16 v[60:63], a[92:95], a[12:15], v[60:63]
    ds_read_b128 a[44:47], v238 offset:6144
    v_mfma_f32_16x16x32_bf16 v[60:63], a[144:147], a[28:31], v[60:63]
    ds_read_b128 a[60:63], v239 offset:6144
    v_mfma_f32_16x16x32_bf16 v[56:59], a[92:95], a[8:11], v[56:59]
    buffer_load_dword v250, v215, s[4:7], 0 offen sc1
    v_mfma_f32_16x16x32_bf16 v[56:59], a[144:147], a[24:27], v[56:59]
    s_waitcnt lgkmcnt(4)
    s_barrier
    ds_read_b64_tr_b16 a[88:89], v208 offset:28672
    v_mfma_f32_16x16x32_bf16 v[52:55], a[92:95], a[4:7], v[52:55]
    s_add_u32 s63, s63, 0x30000
    ds_read_b64_tr_b16 a[90:91], v208 offset:29696
    v_mfma_f32_16x16x32_bf16 v[52:55], a[144:147], a[20:23], v[52:55]
    s_add_u32 m0, s62, 0x7800
    ds_read_b64_tr_b16 a[140:141], v208 offset:43008
    v_mfma_f32_16x16x32_bf16 v[48:51], a[92:95], a[0:3], v[48:51]
    buffer_load_dwordx4 v234, s[8:11], s63 offen lds
    v_mfma_f32_16x16x32_bf16 v[48:51], a[144:147], a[16:19], v[48:51]
    ds_read_b64_tr_b16 a[142:143], v208 offset:44032
    v_mfma_f32_16x16x32_bf16 v[64:67], a[96:99], a[0:3], v[64:67]
    ds_read_b64_tr_b16 a[92:93], v209 offset:28672
    v_mfma_f32_16x16x32_bf16 v[64:67], a[148:151], a[16:19], v[64:67]
    ds_read_b64_tr_b16 a[94:95], v209 offset:29696
    v_mfma_f32_16x16x32_bf16 v[68:71], a[96:99], a[4:7], v[68:71]
    s_mov_b32 exec_hi, 0
    buffer_load_dwordx4 v235, s[8:11], s63 offen offset:1024 lds
    s_mov_b32 exec_hi, -1
    v_mfma_f32_16x16x32_bf16 v[68:71], a[148:151], a[20:23], v[68:71]
    ds_read_b64_tr_b16 a[144:145], v209 offset:43008
    v_mfma_f32_16x16x32_bf16 v[72:75], a[96:99], a[8:11], v[72:75]
    s_add_u32 s63, s63, 0x30000
    ds_read_b64_tr_b16 a[146:147], v209 offset:44032
    v_mfma_f32_16x16x32_bf16 v[72:75], a[148:151], a[24:27], v[72:75]
    s_add_u32 m0, s62, 0xb000
    v_mfma_f32_16x16x32_bf16 v[76:79], a[96:99], a[12:15], v[76:79]
    buffer_load_dwordx4 v234, s[8:11], s63 offen lds
    v_mfma_f32_16x16x32_bf16 v[76:79], a[148:151], a[28:31], v[76:79]
    ds_read_b64_tr_b16 a[96:97], v210 offset:28672
    v_mfma_f32_16x16x32_bf16 v[92:95], a[100:103], a[12:15], v[92:95]
    ds_read_b64_tr_b16 a[98:99], v210 offset:29696
    v_mfma_f32_16x16x32_bf16 v[92:95], a[152:155], a[28:31], v[92:95]
    v_mfma_f32_16x16x32_bf16 v[88:91], a[100:103], a[8:11], v[88:91]
    s_mov_b32 exec_hi, 0
    buffer_load_dwordx4 v235, s[8:11], s63 offen offset:1024 lds
    s_mov_b32 exec_hi, -1
    v_mfma_f32_16x16x32_bf16 v[88:91], a[152:155], a[24:27], v[88:91]
    ds_read_b64_tr_b16 a[148:149], v210 offset:43008
    v_mfma_f32_16x16x32_bf16 v[84:87], a[100:103], a[4:7], v[84:87]
    ds_read_b64_tr_b16 a[150:151], v210 offset:44032
    v_mfma_f32_16x16x32_bf16 v[84:87], a[152:155], a[20:23], v[84:87]
    v_mfma_f32_16x16x32_bf16 v[80:83], a[100:103], a[0:3], v[80:83]
    v_mfma_f32_16x16x32_bf16 v[80:83], a[152:155], a[16:19], v[80:83]
    ds_read_b64_tr_b16 a[100:101], v211 offset:28672
    v_mfma_f32_16x16x32_bf16 v[96:99], a[104:107], a[0:3], v[96:99]
    ds_read_b64_tr_b16 a[102:103], v211 offset:29696
    v_mfma_f32_16x16x32_bf16 v[96:99], a[156:159], a[16:19], v[96:99]
    s_cmp_eq_u32 s60, s94
    s_cbranch_scc0 L_pfr_0
    buffer_load_dword v250, v251, s[84:87], s88 offen
    s_mov_b64 exec, s[92:93]
    buffer_load_dword v250, v251, s[84:87], s89 offen
    s_mov_b64 exec, -1
    buffer_load_dword v250, v248, s[44:47], 0 offen sc1
    v_bfrev_b32 v248, 2
    s_sub_u32 s94, s94, s18
    s_add_u32 s88, s88, s90
    s_add_u32 s89, s89, s90
    s_add_u32 s91, s91, 0x80000000
    s_cbranch_scc0 L_pfr_0
    s_mov_b64 s[84:85], s[26:27]
    s_mov_b32 s86, 0x700000
    v_mov_b32 v251, v249
    s_mov_b32 s88, s16
    s_mov_b32 s89, 0x80000000
    s_mov_b32 s90, s17
    s_mov_b32 s16, 0x80000000
    s_mov_b32 s18, 1
    v_mov_b32 v248, v247
    v_bfrev_b32 v247, 2
L_pfr_0:
    v_mfma_f32_16x16x32_bf16 v[100:103], a[104:107], a[4:7], v[100:103]
    v_mfma_f32_16x16x32_bf16 v[100:103], a[156:159], a[20:23], v[100:103]
    ds_read_b64_tr_b16 a[152:153], v211 offset:43008
    v_mfma_f32_16x16x32_bf16 v[104:107], a[104:107], a[8:11], v[104:107]
    ds_read_b64_tr_b16 a[154:155], v211 offset:44032
    v_mfma_f32_16x16x32_bf16 v[104:107], a[156:159], a[24:27], v[104:107]
    v_mfma_f32_16x16x32_bf16 v[108:111], a[104:107], a[12:15], v[108:111]
    v_mfma_f32_16x16x32_bf16 v[108:111], a[156:159], a[28:31], v[108:111]
    ds_read_b64_tr_b16 a[104:105], v212 offset:28672
    v_mfma_f32_16x16x32_bf16 v[124:127], a[108:111], a[12:15], v[124:127]
    ds_read_b64_tr_b16 a[106:107], v212 offset:29696
    v_mfma_f32_16x16x32_bf16 v[124:127], a[160:163], a[28:31], v[124:127]
    v_mfma_f32_16x16x32_bf16 v[120:123], a[108:111], a[8:11], v[120:123]
    v_mfma_f32_16x16x32_bf16 v[120:123], a[160:163], a[24:27], v[120:123]
    ds_read_b64_tr_b16 a[156:157], v212 offset:43008
    v_mfma_f32_16x16x32_bf16 v[116:119], a[108:111], a[4:7], v[116:119]
    ds_read_b64_tr_b16 a[158:159], v212 offset:44032
    v_mfma_f32_16x16x32_bf16 v[116:119], a[160:163], a[20:23], v[116:119]
    v_mfma_f32_16x16x32_bf16 v[112:115], a[108:111], a[0:3], v[112:115]
    v_mfma_f32_16x16x32_bf16 v[112:115], a[160:163], a[16:19], v[112:115]
    ds_read_b64_tr_b16 a[108:109], v213 offset:28672
    v_mfma_f32_16x16x32_bf16 v[192:195], a[112:115], a[0:3], v[192:195]
    ds_read_b64_tr_b16 a[110:111], v213 offset:29696
    v_mfma_f32_16x16x32_bf16 v[192:195], a[164:167], a[16:19], v[192:195]
    v_mfma_f32_16x16x32_bf16 v[196:199], a[112:115], a[4:7], v[196:199]
    v_mfma_f32_16x16x32_bf16 v[196:199], a[164:167], a[20:23], v[196:199]
    ds_read_b64_tr_b16 a[160:161], v213 offset:43008
    v_mfma_f32_16x16x32_bf16 v[200:203], a[112:115], a[8:11], v[200:203]
    ds_read_b64_tr_b16 a[162:163], v213 offset:44032
    v_mfma_f32_16x16x32_bf16 v[200:203], a[164:167], a[24:27], v[200:203]
    v_mfma_f32_16x16x32_bf16 v[204:207], a[112:115], a[12:15], v[204:207]
    ds_read_b64_tr_b16 a[112:113], v214 offset:28672
    ds_read_b64_tr_b16 a[114:115], v214 offset:29696
    v_mfma_f32_16x16x32_bf16 v[204:207], a[164:167], a[28:31], v[204:207]
    ds_read_b64_tr_b16 a[164:165], v214 offset:43008
    ds_read_b64_tr_b16 a[166:167], v214 offset:44032
    v_add_u32 v238, s55, v236
    v_mfma_f32_16x16x32_bf16 v[0:3], a[64:67], a[32:35], v[0:3]
    v_add_u32 v239, s55, v237
    v_mfma_f32_16x16x32_bf16 v[0:3], a[116:119], a[48:51], v[0:3]
    s_mov_b32 s56, s53
    s_waitcnt vmcnt(23)
    ds_read_b128 a[0:3], v238 offset:0
    v_mfma_f32_16x16x32_bf16 v[4:7], a[64:67], a[36:39], v[4:7]
    s_mov_b32 s53, s54
    ds_read_b128 a[16:19], v239 offset:0
    v_mfma_f32_16x16x32_bf16 v[4:7], a[116:119], a[52:55], v[4:7]
    s_mov_b32 s54, s55
    ds_read_b128 a[4:7], v238 offset:2048
    s_waitcnt lgkmcnt(15)
    v_mfma_f32_16x16x32_bf16 v[8:11], a[64:67], a[40:43], v[8:11]
    s_mov_b32 s55, s56
    ds_read_b128 a[20:23], v239 offset:2048
    v_mfma_f32_16x16x32_bf16 v[8:11], a[116:119], a[56:59], v[8:11]
    v_mfma_f32_16x16x32_bf16 v[12:15], a[64:67], a[44:47], v[12:15]
    v_mfma_f32_16x16x32_bf16 v[12:15], a[116:119], a[60:63], v[12:15]
    s_waitcnt vmcnt(17) lgkmcnt(4)
    s_barrier
    ds_read_b64_tr_b16 a[64:65], v240 offset:0
    v_mfma_f32_16x16x32_bf16 v[28:31], a[68:71], a[44:47], v[28:31]
    s_add_u32 s59, s59, 0x38000
    ds_read_b64_tr_b16 a[66:67], v240 offset:768
    v_mfma_f32_16x16x32_bf16 v[28:31], a[120:123], a[60:63], v[28:31]
    s_add_u32 m0, s62, 0x7000
    v_mfma_f32_16x16x32_bf16 v[24:27], a[68:71], a[40:43], v[24:27]
    buffer_load_dwordx4 v232, s[40:43], s59 offen lds
    v_mfma_f32_16x16x32_bf16 v[24:27], a[120:123], a[56:59], v[24:27]
    ds_read_b64_tr_b16 a[116:117], v240 offset:14336
    v_mfma_f32_16x16x32_bf16 v[20:23], a[68:71], a[36:39], v[20:23]
    ds_read_b64_tr_b16 a[118:119], v240 offset:15104
    v_mfma_f32_16x16x32_bf16 v[20:23], a[120:123], a[52:55], v[20:23]
    v_mfma_f32_16x16x32_bf16 v[16:19], a[68:71], a[32:35], v[16:19]
    buffer_load_dwordx4 v233, s[40:43], s59 offen offset:1024 lds
    v_mfma_f32_16x16x32_bf16 v[16:19], a[120:123], a[48:51], v[16:19]
    ds_read_b64_tr_b16 a[68:69], v241 offset:0
    v_mfma_f32_16x16x32_bf16 v[128:131], a[72:75], a[32:35], v[128:131]
    s_add_u32 s59, s59, 0x38000
    ds_read_b64_tr_b16 a[70:71], v241 offset:768
    v_mfma_f32_16x16x32_bf16 v[128:131], a[124:127], a[48:51], v[128:131]
    s_add_u32 m0, s62, 0xa800
    s_waitcnt vmcnt(19)
    v_dot2_f32_bf16 v222, v216, v218, v222
    v_mfma_f32_16x16x32_bf16 v[132:135], a[72:75], a[36:39], v[132:135]
    buffer_load_dwordx4 v232, s[40:43], s59 offen lds
    v_dot2_f32_bf16 v222, v217, v219, v222
    v_mfma_f32_16x16x32_bf16 v[132:135], a[124:127], a[52:55], v[132:135]
    ds_read_b64_tr_b16 a[120:121], v241 offset:14336
    v_mfma_f32_16x16x32_bf16 v[136:139], a[72:75], a[40:43], v[136:139]
    ds_read_b64_tr_b16 a[122:123], v241 offset:15104
    v_mfma_f32_16x16x32_bf16 v[136:139], a[124:127], a[56:59], v[136:139]
    v_mfma_f32_16x16x32_bf16 v[140:143], a[72:75], a[44:47], v[140:143]
    buffer_load_dwordx4 v233, s[40:43], s59 offen offset:1024 lds
    v_mfma_f32_16x16x32_bf16 v[140:143], a[124:127], a[60:63], v[140:143]
    ds_read_b64_tr_b16 a[72:73], v240 offset:64
    v_mfma_f32_16x16x32_bf16 v[156:159], a[76:79], a[44:47], v[156:159]
    s_add_u32 m0, s61, s55
    ds_read_b64_tr_b16 a[74:75], v240 offset:832
    v_mfma_f32_16x16x32_bf16 v[156:159], a[128:131], a[60:63], v[156:159]
    s_add_u32 m0, m0, 0x1000
    v_mfma_f32_16x16x32_bf16 v[152:155], a[76:79], a[40:43], v[152:155]
    buffer_load_dwordx4 v228, s[36:39], s58 offen lds
    v_mfma_f32_16x16x32_bf16 v[152:155], a[128:131], a[56:59], v[152:155]
    ds_read_b64_tr_b16 a[124:125], v240 offset:14400
    v_mfma_f32_16x16x32_bf16 v[148:151], a[76:79], a[36:39], v[148:151]
    ds_read_b64_tr_b16 a[126:127], v240 offset:15168
    v_mfma_f32_16x16x32_bf16 v[148:151], a[128:131], a[52:55], v[148:151]
    v_mfma_f32_16x16x32_bf16 v[144:147], a[76:79], a[32:35], v[144:147]
    buffer_load_dwordx4 v229, s[36:39], s58 offen offset:1024 lds
    v_mfma_f32_16x16x32_bf16 v[144:147], a[128:131], a[48:51], v[144:147]
    ds_read_b64_tr_b16 a[76:77], v241 offset:64
    v_mfma_f32_16x16x32_bf16 v[160:163], a[32:35], a[80:83], v[160:163]
    ds_read_b64_tr_b16 a[78:79], v241 offset:832
    v_mfma_f32_16x16x32_bf16 v[160:163], a[48:51], a[132:135], v[160:163]
    v_mfma_f32_16x16x32_bf16 v[164:167], a[36:39], a[80:83], v[164:167]
    buffer_load_dwordx4 v230, s[36:39], s58 offen offset:2048 lds
    v_mfma_f32_16x16x32_bf16 v[164:167], a[52:55], a[132:135], v[164:167]
    ds_read_b64_tr_b16 a[128:129], v241 offset:14400
    v_mfma_f32_16x16x32_bf16 v[168:171], a[40:43], a[80:83], v[168:171]
    ds_read_b64_tr_b16 a[130:131], v241 offset:15168
    v_mfma_f32_16x16x32_bf16 v[168:171], a[56:59], a[132:135], v[168:171]
    v_mfma_f32_16x16x32_bf16 v[172:175], a[44:47], a[80:83], v[172:175]
    buffer_load_dwordx4 v231, s[36:39], s58 offen offset:3072 lds
    v_mfma_f32_16x16x32_bf16 v[172:175], a[60:63], a[132:135], v[172:175]
    s_add_u32 s57, s57, 128
    ds_read_b64_tr_b16 a[80:81], v240 offset:128
    v_mfma_f32_16x16x32_bf16 v[188:191], a[44:47], a[84:87], v[188:191]
    s_cmp_lt_u32 s57, 2048
    ds_read_b64_tr_b16 a[82:83], v240 offset:896
    s_cselect_b32 s58, s57, 0x80000000
    v_mfma_f32_16x16x32_bf16 v[188:191], a[60:63], a[136:139], v[188:191]
    s_add_u32 m0, s61, s53
    v_mfma_f32_16x16x32_bf16 v[184:187], a[40:43], a[84:87], v[184:187]
    buffer_load_dwordx4 v224, s[36:39], s58 offen lds
    v_mfma_f32_16x16x32_bf16 v[184:187], a[56:59], a[136:139], v[184:187]
    ds_read_b64_tr_b16 a[132:133], v240 offset:14464
    v_mfma_f32_16x16x32_bf16 v[180:183], a[36:39], a[84:87], v[180:183]
    ds_read_b64_tr_b16 a[134:135], v240 offset:15232
    v_mfma_f32_16x16x32_bf16 v[180:183], a[52:55], a[136:139], v[180:183]
    v_mfma_f32_16x16x32_bf16 v[176:179], a[32:35], a[84:87], v[176:179]
    buffer_load_dwordx4 v225, s[36:39], s58 offen offset:1024 lds
    v_mfma_f32_16x16x32_bf16 v[176:179], a[48:51], a[136:139], v[176:179]
    ds_read_b64_tr_b16 a[84:85], v241 offset:128
    v_mfma_f32_16x16x32_bf16 v[32:35], a[88:91], a[32:35], v[32:35]
    ds_read_b64_tr_b16 a[86:87], v241 offset:896
    v_mfma_f32_16x16x32_bf16 v[32:35], a[140:143], a[48:51], v[32:35]
    v_mfma_f32_16x16x32_bf16 v[36:39], a[88:91], a[36:39], v[36:39]
    buffer_load_dwordx4 v226, s[36:39], s58 offen offset:2048 lds
    v_mfma_f32_16x16x32_bf16 v[36:39], a[140:143], a[52:55], v[36:39]
    ds_read_b64_tr_b16 a[136:137], v241 offset:14464
    v_mfma_f32_16x16x32_bf16 v[40:43], a[88:91], a[40:43], v[40:43]
    ds_read_b64_tr_b16 a[138:139], v241 offset:15232
    v_mfma_f32_16x16x32_bf16 v[40:43], a[140:143], a[56:59], v[40:43]
    s_waitcnt vmcnt(20)
    ds_read_b128 a[8:11], v238 offset:4096
    v_mfma_f32_16x16x32_bf16 v[44:47], a[88:91], a[44:47], v[44:47]
    buffer_load_dwordx4 v227, s[36:39], s58 offen offset:3072 lds
    v_mfma_f32_16x16x32_bf16 v[44:47], a[140:143], a[60:63], v[44:47]
    ds_read_b128 a[24:27], v239 offset:4096
    v_mfma_f32_16x16x32_bf16 v[60:63], a[92:95], a[44:47], v[60:63]
    ds_read_b128 a[12:15], v238 offset:6144
    v_mfma_f32_16x16x32_bf16 v[60:63], a[144:147], a[60:63], v[60:63]
    ds_read_b128 a[28:31], v239 offset:6144
    v_mfma_f32_16x16x32_bf16 v[56:59], a[92:95], a[40:43], v[56:59]
    buffer_load_dwordx2 v[216:217], v220, s[36:39], s12 offen
    v_mfma_f32_16x16x32_bf16 v[56:59], a[144:147], a[56:59], v[56:59]
    s_waitcnt lgkmcnt(4)
    s_barrier
    ds_read_b64_tr_b16 a[88:89], v208 offset:0
    v_mfma_f32_16x16x32_bf16 v[52:55], a[92:95], a[36:39], v[52:55]
    s_add_u32 s63, s63, 0x30000
    ds_read_b64_tr_b16 a[90:91], v208 offset:1024
    v_mfma_f32_16x16x32_bf16 v[52:55], a[144:147], a[52:55], v[52:55]
    s_add_u32 m0, s62, 0x800
    ds_read_b64_tr_b16 a[140:141], v208 offset:14336
    v_mfma_f32_16x16x32_bf16 v[48:51], a[92:95], a[32:35], v[48:51]
    buffer_load_dwordx4 v234, s[8:11], s63 offen lds
    v_mfma_f32_16x16x32_bf16 v[48:51], a[144:147], a[48:51], v[48:51]
    ds_read_b64_tr_b16 a[142:143], v208 offset:15360
    v_mfma_f32_16x16x32_bf16 v[64:67], a[96:99], a[32:35], v[64:67]
    ds_read_b64_tr_b16 a[92:93], v209 offset:0
    v_mfma_f32_16x16x32_bf16 v[64:67], a[148:151], a[48:51], v[64:67]
    ds_read_b64_tr_b16 a[94:95], v209 offset:1024
    v_mfma_f32_16x16x32_bf16 v[68:71], a[96:99], a[36:39], v[68:71]
    s_mov_b32 exec_hi, 0
    buffer_load_dwordx4 v235, s[8:11], s63 offen offset:1024 lds
    s_mov_b32 exec_hi, -1
    v_mfma_f32_16x16x32_bf16 v[68:71], a[148:151], a[52:55], v[68:71]
    ds_read_b64_tr_b16 a[144:145], v209 offset:14336
    v_mfma_f32_16x16x32_bf16 v[72:75], a[96:99], a[40:43], v[72:75]
    s_add_u32 s63, s63, 0x30000
    ds_read_b64_tr_b16 a[146:147], v209 offset:15360
    v_mfma_f32_16x16x32_bf16 v[72:75], a[148:151], a[56:59], v[72:75]
    s_add_u32 m0, s62, 0x4000
    v_mfma_f32_16x16x32_bf16 v[76:79], a[96:99], a[44:47], v[76:79]
    buffer_load_dwordx4 v234, s[8:11], s63 offen lds
    v_mfma_f32_16x16x32_bf16 v[76:79], a[148:151], a[60:63], v[76:79]
    ds_read_b64_tr_b16 a[96:97], v210 offset:0
    v_mfma_f32_16x16x32_bf16 v[92:95], a[100:103], a[44:47], v[92:95]
    ds_read_b64_tr_b16 a[98:99], v210 offset:1024
    v_mfma_f32_16x16x32_bf16 v[92:95], a[152:155], a[60:63], v[92:95]
    v_mfma_f32_16x16x32_bf16 v[88:91], a[100:103], a[40:43], v[88:91]
    s_mov_b32 exec_hi, 0
    buffer_load_dwordx4 v235, s[8:11], s63 offen offset:1024 lds
    s_mov_b32 exec_hi, -1
    v_mfma_f32_16x16x32_bf16 v[88:91], a[152:155], a[56:59], v[88:91]
    ds_read_b64_tr_b16 a[148:149], v210 offset:14336
    v_mfma_f32_16x16x32_bf16 v[84:87], a[100:103], a[36:39], v[84:87]
    ds_read_b64_tr_b16 a[150:151], v210 offset:15360
    v_mfma_f32_16x16x32_bf16 v[84:87], a[152:155], a[52:55], v[84:87]
    v_mfma_f32_16x16x32_bf16 v[80:83], a[100:103], a[32:35], v[80:83]
    buffer_load_dwordx2 v[218:219], v221, s[96:99], s12 offen
    v_mfma_f32_16x16x32_bf16 v[80:83], a[152:155], a[48:51], v[80:83]
    s_add_u32 s12, s12, 256
    ds_read_b64_tr_b16 a[100:101], v211 offset:0
    v_mfma_f32_16x16x32_bf16 v[96:99], a[104:107], a[32:35], v[96:99]
    ds_read_b64_tr_b16 a[102:103], v211 offset:1024
    v_mfma_f32_16x16x32_bf16 v[96:99], a[156:159], a[48:51], v[96:99]
    s_cmp_eq_u32 s60, s95
    s_cbranch_scc0 L_pfr_1
    buffer_load_dword v250, v251, s[84:87], s88 offen
    s_mov_b64 exec, s[92:93]
    buffer_load_dword v250, v251, s[84:87], s89 offen
    s_mov_b64 exec, -1
    buffer_load_dword v250, v248, s[44:47], 0 offen sc1
    v_bfrev_b32 v248, 2
    s_sub_u32 s95, s95, s18
    s_add_u32 s88, s88, s90
    s_add_u32 s89, s89, s90
    s_add_u32 s91, s91, 0x80000000
    s_cbranch_scc0 L_pfr_1
    s_mov_b64 s[84:85], s[26:27]
    s_mov_b32 s86, 0x700000
    v_mov_b32 v251, v249
    s_mov_b32 s88, s16
    s_mov_b32 s89, 0x80000000
    s_mov_b32 s90, s17
    s_mov_b32 s16, 0x80000000
    s_mov_b32 s18, 1
    v_mov_b32 v248, v247
    v_bfrev_b32 v247, 2
L_pfr_1:
    v_mfma_f32_16x16x32_bf16 v[100:103], a[104:107], a[36:39], v[100:103]
    v_mfma_f32_16x16x32_bf16 v[100:103], a[156:159], a[52:55], v[100:103]
    ds_read_b64_tr_b16 a[152:153], v211 offset:14336
    v_mfma_f32_16x16x32_bf16 v[104:107], a[104:107], a[40:43], v[104:107]
    ds_read_b64_tr_b16 a[154:155], v211 offset:15360
    v_mfma_f32_16x16x32_bf16 v[104:107], a[156:159], a[56:59], v[104:107]
    v_mfma_f32_16x16x32_bf16 v[108:111], a[104:107], a[44:47], v[108:111]
    v_mfma_f32_16x16x32_bf16 v[108:111], a[156:159], a[60:63], v[108:111]
    ds_read_b64_tr_b16 a[104:105], v212 offset:0
    v_mfma_f32_16x16x32_bf16 v[124:127], a[108:111], a[44:47], v[124:127]
    ds_read_b64_tr_b16 a[106:107], v212 offset:1024
    v_mfma_f32_16x16x32_bf16 v[124:127], a[160:163], a[60:63], v[124:127]
    v_mfma_f32_16x16x32_bf16 v[120:123], a[108:111], a[40:43], v[120:123]
    v_mfma_f32_16x16x32_bf16 v[120:123], a[160:163], a[56:59], v[120:123]
    ds_read_b64_tr_b16 a[156:157], v212 offset:14336
    v_mfma_f32_16x16x32_bf16 v[116:119], a[108:111], a[36:39], v[116:119]
    ds_read_b64_tr_b16 a[158:159], v212 offset:15360
    v_mfma_f32_16x16x32_bf16 v[116:119], a[160:163], a[52:55], v[116:119]
    v_mfma_f32_16x16x32_bf16 v[112:115], a[108:111], a[32:35], v[112:115]
    v_mfma_f32_16x16x32_bf16 v[112:115], a[160:163], a[48:51], v[112:115]
    ds_read_b64_tr_b16 a[108:109], v213 offset:0
    v_mfma_f32_16x16x32_bf16 v[192:195], a[112:115], a[32:35], v[192:195]
    ds_read_b64_tr_b16 a[110:111], v213 offset:1024
    v_mfma_f32_16x16x32_bf16 v[192:195], a[164:167], a[48:51], v[192:195]
    v_mfma_f32_16x16x32_bf16 v[196:199], a[112:115], a[36:39], v[196:199]
    v_mfma_f32_16x16x32_bf16 v[196:199], a[164:167], a[52:55], v[196:199]
    ds_read_b64_tr_b16 a[160:161], v213 offset:14336
    v_mfma_f32_16x16x32_bf16 v[200:203], a[112:115], a[40:43], v[200:203]
    ds_read_b64_tr_b16 a[162:163], v213 offset:15360
    v_mfma_f32_16x16x32_bf16 v[200:203], a[164:167], a[56:59], v[200:203]
    v_mfma_f32_16x16x32_bf16 v[204:207], a[112:115], a[44:47], v[204:207]
    ds_read_b64_tr_b16 a[112:113], v214 offset:0
    ds_read_b64_tr_b16 a[114:115], v214 offset:1024
    v_mfma_f32_16x16x32_bf16 v[204:207], a[164:167], a[60:63], v[204:207]
    ds_read_b64_tr_b16 a[164:165], v214 offset:14336
    ds_read_b64_tr_b16 a[166:167], v214 offset:15360
    s_sub_u32 s60, s60, 1
    s_cmp_lg_u32 s60, 0
    s_cbranch_scc1 L_g1_loop
L_g1_end:
    s_mov_b32 s96, s32
    s_and_b32 s97, s33, 0xffff
    s_lshl_b32 s63, s50, 12
    v_mfma_f32_16x16x32_bf16 v[128:131], a[72:75], a[0:3], v[128:131]
    s_movk_i32 s98, 256
    buffer_load_dword v254, off, s[96:99], 0 sc1
    s_lshl_b32 s3, s52, 17
    v_mfma_f32_16x16x32_bf16 v[128:131], a[124:127], a[16:19], v[128:131]
    s_lshl_b32 s4, s48, 14
    s_add_u32 s3, s3, s4
    v_add_u32 v238, 0x0, v236
    v_mfma_f32_16x16x32_bf16 v[132:135], a[72:75], a[4:7], v[132:135]
    s_add_u32 s3, s3, s63
    s_add_u32 s12, s3, 0x400000
    v_add_u32 v237, 0x0, v237
    v_mfma_f32_16x16x32_bf16 v[132:135], a[124:127], a[20:23], v[132:135]
    s_cmp_eq_u32 s48, 0
    s_cselect_b32 s4, 0, 0x4000
    s_sub_u32 s13, s12, s4
    s_lshr_b32 s4, s4, 2
    s_waitcnt lgkmcnt(15)
    v_mfma_f32_16x16x32_bf16 v[136:139], a[72:75], a[8:11], v[136:139]
    s_waitcnt vmcnt(24)
    ds_read_b128 a[32:35], v238 offset:0
    s_sub_u32 s29, s15, s4
    s_mov_b32 s53, 0x3e8293ee
    v_mfma_f32_16x16x32_bf16 v[136:139], a[124:127], a[24:27], v[136:139]
    s_cmp_eq_u32 s48, 7
    s_cselect_b32 s12, 0x80000000, s12
    s_add_u32 s14, s12, 0x400000
    s_lshl_b32 s3, s50, 10
    v_mfma_f32_16x16x32_bf16 v[140:143], a[72:75], a[12:15], v[140:143]
    s_lshr_b32 s51, s52, 3
    v_add_u32 v234, s3, v252
    v_lshl_add_u32 v235, v242, 3, s3
    v_mfma_f32_16x16x32_bf16 v[140:143], a[124:127], a[28:31], v[140:143]
    s_waitcnt vmcnt(19)
    s_barrier
    v_mfma_f32_16x16x32_bf16 v[156:159], a[76:79], a[12:15], v[156:159]
    s_and_b32 s49, s52, 7
    s_lshl_b32 s49, s49, 2
    ds_read_b64_tr_b16 a[168:169], v240 offset:28736
    ds_read_b64_tr_b16 a[170:171], v240 offset:29504
    v_mfma_f32_16x16x32_bf16 v[156:159], a[128:131], a[28:31], v[156:159]
    s_lshr_b32 s49, 0x76451230, s49
    s_and_b32 s49, s49, 7
    ds_read_b128 a[48:51], v237 offset:0
    v_lshrrev_b32 v243, 4, v242
    v_mfma_f32_16x16x32_bf16 v[152:155], a[76:79], a[8:11], v[152:155]
    s_lshl_b32 s3, s50, 14
    v_lshlrev_b32 v232, 1, v243
    v_and_b32 v255, 15, v242
    v_mfma_f32_16x16x32_bf16 v[152:155], a[128:131], a[24:27], v[152:155]
    ds_read_b64_tr_b16 a[172:173], v240 offset:43072
    ds_read_b64_tr_b16 a[174:175], v240 offset:43840
    v_xor_b32 v232, v232, v255
    v_lshl_add_u32 v233, v243, 11, s3
    v_lshl_add_u32 v232, v232, 4, v233
    v_mfma_f32_16x16x32_bf16 v[148:151], a[76:79], a[4:7], v[148:151]
    ds_read_b128 a[36:39], v238 offset:2048
    v_xor_b32 v233, 0x80, v232
    v_mfma_f32_16x16x32_bf16 v[148:151], a[128:131], a[20:23], v[148:151]
    ds_read_b128 a[52:55], v237 offset:2048
    v_add_u32 v233, 0x1c00, v233
    v_mfma_f32_16x16x32_bf16 v[144:147], a[76:79], a[0:3], v[144:147]
    s_lshl_b32 s61, s50, 11
    v_lshlrev_b32 v243, 2, v243
    v_sub_u32 v243, v255, v243
    v_cmp_lt_i32 s[16:17], v243, 0
    v_mfma_f32_16x16x32_bf16 v[144:147], a[128:131], a[16:19], v[144:147]
    s_waitcnt vmcnt(11)
    ds_read_b128 a[40:43], v238 offset:4096
    v_cmp_lt_i32 s[18:19], v243, 1
    v_cmp_lt_i32 s[22:23], v243, 2
    v_mfma_f32_16x16x32_bf16 v[160:163], a[0:3], a[80:83], v[160:163]
    ds_read_b128 a[56:59], v237 offset:4096
    s_lshr_b32 s5, s52, 1
    v_mfma_f32_16x16x32_bf16 v[160:163], a[16:19], a[132:135], v[160:163]
    s_mul_i32 s5, s5, 7
    s_lshl_b32 s6, s65, 2
    ds_read_b128 a[44:47], v238 offset:6144
    v_mfma_f32_16x16x32_bf16 v[164:167], a[4:7], a[80:83], v[164:167]
    s_add_u32 s6, s6, s5
    s_lshl_b32 s59, s6, 16
    ds_read_b128 a[60:63], v237 offset:6144
    v_cmp_lt_i32 s[24:25], v243, 3
    v_mfma_f32_16x16x32_bf16 v[164:167], a[20:23], a[132:135], v[164:167]
    s_mul_i32 s3, s51, 28
    s_add_u32 s3, s3, 28
    ds_read_b64_tr_b16 a[228:229], v241 offset:28736
    v_mfma_f32_16x16x32_bf16 v[168:171], a[8:11], a[80:83], v[168:171]
    s_lshl_b32 s66, s3, 16
    s_add_u32 s3, s3, 32
    ds_read_b64_tr_b16 a[230:231], v241 offset:29504
    v_mfma_f32_16x16x32_bf16 v[168:171], a[24:27], a[132:135], v[168:171]
    s_lshl_b32 s55, s3, 14
    ds_read_b64_tr_b16 a[232:233], v241 offset:43072
    ds_read_b64_tr_b16 a[234:235], v241 offset:43840
    v_mfma_f32_16x16x32_bf16 v[172:175], a[12:15], a[80:83], v[172:175]
    s_lshl_b32 s62, s49, 8
    s_add_u32 s40, s26, s62
    s_addc_u32 s41, s27, 0
    v_mfma_f32_16x16x32_bf16 v[172:175], a[28:31], a[132:135], v[172:175]
    s_and_b32 s41, s41, 0xffff
    s_sub_u32 s42, 0x700000, s62
    ds_read_b64_tr_b16 a[236:237], v240 offset:28800
    v_mfma_f32_16x16x32_bf16 v[188:191], a[12:15], a[84:87], v[188:191]
    s_lshl_b32 s8, s65, 16
    ds_read_b64_tr_b16 a[238:239], v240 offset:29568
    s_lshl_b32 s9, s65, 18
    s_and_b32 s3, s50, 1
    v_mfma_f32_16x16x32_bf16 v[188:191], a[28:31], a[136:139], v[188:191]
    s_lshr_b32 s4, s50, 1
    ds_read_b64_tr_b16 a[240:241], v240 offset:43136
    s_sub_u32 s3, s3, s4
    v_mfma_f32_16x16x32_bf16 v[184:187], a[8:11], a[84:87], v[184:187]
    s_lshl_b32 s10, s3, 14
    ds_read_b64_tr_b16 a[242:243], v240 offset:43904
    ds_read_b64_tr_b16 a[244:245], v241 offset:28800
    v_mfma_f32_16x16x32_bf16 v[184:187], a[24:27], a[136:139], v[184:187]
    s_add_u32 s6, s6, 32
    s_lshl_b32 s6, s6, 14
    ds_read_b64_tr_b16 a[246:247], v241 offset:29568
    v_mfma_f32_16x16x32_bf16 v[180:183], a[4:7], a[84:87], v[180:183]
    s_add_u32 s85, s6, s63
    s_add_u32 s5, s5, 35
    ds_read_b64_tr_b16 a[248:249], v241 offset:43136
    v_mfma_f32_16x16x32_bf16 v[180:183], a[20:23], a[136:139], v[180:183]
    s_lshl_b32 s5, s5, 14
    s_add_u32 s5, s5, s63
    ds_read_b64_tr_b16 a[250:251], v241 offset:43904
    v_mfma_f32_16x16x32_bf16 v[176:179], a[0:3], a[84:87], v[176:179]
    s_lshl_b32 s4, s65, 9
    s_add_u32 s86, s5, s4
    s_sub_u32 s5, s5, s8
    v_mfma_f32_16x16x32_bf16 v[176:179], a[16:19], a[136:139], v[176:179]
    s_mul_i32 s7, s48, 0x240000
    s_add_u32 s58, s5, 0x4000
    s_waitcnt lgkmcnt(15)
    v_mfma_f32_16x16x32_bf16 v[136:139], a[168:171], a[40:43], v[136:139]
    v_mfma_f32_16x16x32_bf16 v[128:131], a[168:171], a[32:35], v[128:131]
    s_add_u32 s7, s7, 0x1000000
    s_add_u32 s36, s34, s7
    v_mfma_f32_16x16x32_bf16 v[132:135], a[168:171], a[36:39], v[132:135]
    s_addc_u32 s37, s35, 0
    v_mfma_f32_16x16x32_bf16 v[128:131], a[172:175], a[48:51], v[128:131]
    s_mov_b32 s38, 0x240000
    s_and_b32 s37, s37, 0xffff
    s_lshl_b32 s3, s52, 14
    v_mfma_f32_16x16x32_bf16 v[132:135], a[172:175], a[52:55], v[132:135]
    s_add_u32 s57, s3, s63
    v_and_b32 v243, 0x200, v252
    s_waitcnt lgkmcnt(14)
    v_mfma_f32_16x16x32_bf16 v[136:139], a[172:175], a[56:59], v[136:139]
    s_waitcnt lgkmcnt(13)
    v_mfma_f32_16x16x32_bf16 v[140:143], a[168:171], a[44:47], v[140:143]
    s_waitcnt lgkmcnt(12)
    v_mfma_f32_16x16x32_bf16 v[140:143], a[172:175], a[60:63], v[140:143]
    s_waitcnt vmcnt(2) lgkmcnt(0)
    s_barrier
    ds_read_b64_tr_b16 a[252:253], v240 offset:28672
    ds_read_b64_tr_b16 a[254:255], v240 offset:29440
    v_add_u32 v236, v243, v252
    v_bfe_u32 v243, v242, 2, 4
    v_mfma_f32_16x16x32_bf16 v[156:159], a[228:231], a[44:47], v[156:159]
    s_add_u32 m0, s61, 0x10000
    s_waitcnt vmcnt(1)
    ds_read_b64_tr_b16 a[72:73], v240 offset:43008
    v_mfma_f32_16x16x32_bf16 v[156:159], a[232:235], a[60:63], v[156:159]
    buffer_load_dwordx4 v232, s[40:43], s59 offen lds
    v_dot2_f32_bf16 v222, v216, v218, v222
    v_mfma_f32_16x16x32_bf16 v[152:155], a[228:231], a[40:43], v[152:155]
    ds_read_b64_tr_b16 a[74:75], v240 offset:43776
    v_dot2_f32_bf16 v222, v217, v219, v222
    v_mfma_f32_16x16x32_bf16 v[152:155], a[232:235], a[56:59], v[152:155]
    buffer_load_dwordx4 v233, s[40:43], s59 offen offset:1024 lds
    s_add_u32 s59, s59, 0x10000
    v_add_f32_dpp v222, v222, v222 row_ror:8 row_mask:0xf bank_mask:0xf
    v_mfma_f32_16x16x32_bf16 v[144:147], a[228:231], a[32:35], v[144:147]
    s_nop 0
    v_add_f32_dpp v222, v222, v222 row_ror:4 row_mask:0xf bank_mask:0xf
    v_cvt_pk_bf16_f32 v132, v132, v133
    s_nop 0
    v_add_f32_dpp v222, v222, v222 row_ror:2 row_mask:0xf bank_mask:0xf
    v_mfma_f32_16x16x32_bf16 v[148:151], a[228:231], a[36:39], v[148:151]
    s_add_u32 m0, s61, 0x12000
    v_add_f32_dpp v222, v222, v222 row_ror:1 row_mask:0xf bank_mask:0xf
    v_mov_b32 v223, v222
    v_mfma_f32_16x16x32_bf16 v[148:151], a[232:235], a[52:55], v[148:151]
    buffer_load_dwordx4 v232, s[40:43], s59 offen lds
    v_permlane16_swap_b32 v222, v223
    v_add_f32 v222, v222, v223
    v_cvt_pk_bf16_f32 v222, v222, v222
    v_mfma_f32_16x16x32_bf16 v[144:147], a[232:235], a[48:51], v[144:147]
    ds_read_b64_tr_b16 a[124:125], v241 offset:28672
    buffer_load_dwordx4 v233, s[40:43], s59 offen offset:1024 lds
    v_and_b32 v222, 0xffff0000, v222
    v_mul_f32 v222, 0xbfb8aa3b, v222
    s_add_u32 s59, s59, 0x10000
    v_mfma_f32_16x16x32_bf16 v[160:163], a[32:35], a[236:239], v[160:163]
    s_add_u32 m0, s61, 0x14000
    ds_read_b64_tr_b16 a[126:127], v241 offset:29440
    ds_read_b64_tr_b16 a[76:77], v241 offset:43008
    v_mfma_f32_16x16x32_bf16 v[160:163], a[48:51], a[240:243], v[160:163]
    buffer_load_dwordx4 v232, s[40:43], s59 offen lds
    v_cvt_pk_bf16_f32 v133, v134, v135
    v_mfma_f32_16x16x32_bf16 v[164:167], a[36:39], a[236:239], v[164:167]
    ds_read_b64_tr_b16 a[78:79], v241 offset:43776
    v_cvt_pk_bf16_f32 v128, v128, v129
    v_cvt_pk_bf16_f32 v129, v130, v131
    v_mfma_f32_16x16x32_bf16 v[164:167], a[52:55], a[240:243], v[164:167]
    buffer_load_dwordx4 v233, s[40:43], s59 offen offset:1024 lds
    s_add_u32 s59, s59, 0x20000
    v_cvt_pk_bf16_f32 v130, v144, v145
    v_mfma_f32_16x16x32_bf16 v[168:171], a[40:43], a[236:239], v[168:171]
    s_sub_u32 s59, s59, s9
    v_cvt_pk_bf16_f32 v131, v146, v147
    s_sub_u32 s59, s59, s9
    s_add_u32 m0, s61, 0x16000
    v_mfma_f32_16x16x32_bf16 v[168:171], a[56:59], a[240:243], v[168:171]
    buffer_store_dwordx4 v[128:131], v252, s[44:47], s12 offen offset:0 sc1
    v_cvt_pk_bf16_f32 v135, v150, v151
    v_exp_f32 v222, v222
    v_cvt_pk_bf16_f32 v134, v148, v149
    v_mfma_f32_16x16x32_bf16 v[172:175], a[44:47], a[236:239], v[172:175]
    buffer_load_dwordx4 v232, s[40:43], s59 offen lds
    v_cvt_pk_bf16_f32 v136, v136, v137
    v_mfma_f32_16x16x32_bf16 v[172:175], a[60:63], a[240:243], v[172:175]
    buffer_store_dwordx4 v[132:135], v252, s[44:47], s12 offen offset:1024 sc1
    buffer_load_dwordx4 v233, s[40:43], s59 offen offset:1024 lds
    v_cvt_pk_bf16_f32 v137, v138, v139
    v_cvt_pk_bf16_f32 v138, v152, v153
    v_mfma_f32_16x16x32_bf16 v[184:187], a[40:43], a[244:247], v[184:187]
    v_and_b32 v255, 7, v243
    v_cvt_pk_bf16_f32 v139, v154, v155
    v_mfma_f32_16x16x32_bf16 v[188:191], a[44:47], a[244:247], v[188:191]
    buffer_store_dwordx4 v[136:139], v252, s[44:47], s12 offen offset:2048 sc1
    v_cvt_pk_bf16_f32 v140, v140, v141
    v_add_f32 v222, 1.0, v222
    v_cvt_pk_bf16_f32 v141, v142, v143
    v_mfma_f32_16x16x32_bf16 v[188:191], a[60:63], a[248:251], v[188:191]
    v_cvt_pk_bf16_f32 v143, v158, v159
    v_cvt_pk_bf16_f32 v142, v156, v157
    v_mfma_f32_16x16x32_bf16 v[184:187], a[56:59], a[248:251], v[184:187]
    buffer_store_dwordx4 v[140:143], v252, s[44:47], s12 offen offset:3072 sc1
    v_rcp_f32 v222, v222
    s_add_u32 s59, s59, 0x10000
    v_mfma_f32_16x16x32_bf16 v[180:183], a[36:39], a[244:247], v[180:183]
    s_lshr_b32 s90, s15, 1
    v_lshrrev_b32 v220, 2, v242
    v_mfma_f32_16x16x32_bf16 v[180:183], a[52:55], a[248:251], v[180:183]
    s_lshl_b32 s91, s50, 4
    v_cvt_pk_bf16_f32 v164, v164, v165
    v_lshlrev_b32 v243, 8, v243
    v_mfma_f32_16x16x32_bf16 v[176:179], a[32:35], a[244:247], v[176:179]
    v_mfma_f32_16x16x32_bf16 v[176:179], a[48:51], a[248:251], v[176:179]
    v_lshl_add_u32 v243, v255, 5, v243
    s_add_u32 s90, s90, s91
    v_mfma_f32_16x16x32_bf16 v[0:3], a[64:67], a[0:3], v[0:3]
    v_cvt_pk_bf16_f32 v160, v160, v161
    v_and_b32 v255, 3, v242
    v_mfma_f32_16x16x32_bf16 v[4:7], a[64:67], a[4:7], v[4:7]
    v_cvt_pk_bf16_f32 v161, v162, v163
    v_lshl_add_u32 v243, v255, 3, v243
    v_mfma_f32_16x16x32_bf16 v[4:7], a[116:119], a[20:23], v[4:7]
    v_cvt_pk_bf16_f32 v162, v176, v177
    v_cvt_pk_bf16_f32 v163, v178, v179
    v_mfma_f32_16x16x32_bf16 v[8:11], a[64:67], a[8:11], v[8:11]
    buffer_store_dwordx4 v[160:163], v252, s[44:47], s14 offen offset:0 sc1
    v_cvt_pk_bf16_f32 v168, v168, v169
    v_cvt_pk_bf16_f32 v165, v166, v167
    v_cvt_pk_bf16_f32 v166, v180, v181
    v_mfma_f32_16x16x32_bf16 v[12:15], a[64:67], a[12:15], v[12:15]
    v_cvt_pk_bf16_f32 v167, v182, v183
    v_add_u32 v243, 0xc000, v243
    v_mfma_f32_16x16x32_bf16 v[0:3], a[116:119], a[16:19], v[0:3]
    buffer_store_dwordx4 v[164:167], v252, s[44:47], s14 offen offset:1024 sc1
    v_cvt_pk_bf16_f32 v222, v222, v222
    v_cvt_pk_bf16_f32 v169, v170, v171
    v_and_b32 v222, 0xffff0000, v222
    v_mfma_f32_16x16x32_bf16 v[28:31], a[68:71], a[12:15], v[28:31]
    ds_read_b64_tr_b16 a[128:129], v208 offset:28672
    ds_read_b64_tr_b16 a[130:131], v208 offset:29696
    v_mfma_f32_16x16x32_bf16 v[28:31], a[120:123], a[28:31], v[28:31]
    s_add_u32 s90, s90, 0x1380000
    ds_read_b64_tr_b16 a[80:81], v208 offset:43008
    v_cvt_pk_bf16_f32 v170, v184, v185
    v_mfma_f32_16x16x32_bf16 v[24:27], a[68:71], a[8:11], v[24:27]
    ds_read_b64_tr_b16 a[82:83], v208 offset:44032
    v_cvt_pk_bf16_f32 v171, v186, v187
    v_mfma_f32_16x16x32_bf16 v[24:27], a[120:123], a[24:27], v[24:27]
    buffer_store_dwordx4 v[168:171], v252, s[44:47], s14 offen offset:2048 sc1
    v_cvt_pk_bf16_f32 v172, v172, v173
    v_cvt_pk_bf16_f32 v173, v174, v175
    v_cvt_pk_bf16_f32 v175, v190, v191
    v_mfma_f32_16x16x32_bf16 v[20:23], a[68:71], a[4:7], v[20:23]
    s_mov_b32 s64, 0x8000
    v_cvt_pk_bf16_f32 v174, v188, v189
    v_mfma_f32_16x16x32_bf16 v[16:19], a[68:71], a[0:3], v[16:19]
    buffer_store_dwordx4 v[172:175], v252, s[44:47], s14 offen offset:3072 sc1
    ds_write_b128 v234, v[128:131] offset:16384
    v_mfma_f32_16x16x32_bf16 v[12:15], a[116:119], a[28:31], v[12:15]
    ds_write2st64_b64 v235, v[160:161], v[162:163] offset0:96 offset1:97
    v_mfma_f32_16x16x32_bf16 v[8:11], a[116:119], a[24:27], v[8:11]
    ds_read_b64_tr_b16 a[132:133], v209 offset:28672
    v_mfma_f32_16x16x32_bf16 v[16:19], a[120:123], a[16:19], v[16:19]
    ds_write_b128 v234, v[132:135] offset:20480
    v_mfma_f32_16x16x32_bf16 v[20:23], a[120:123], a[20:23], v[20:23]
    s_waitcnt lgkmcnt(14)
    ds_read_b64_tr_b16 a[134:135], v209 offset:29696
    ds_write2st64_b64 v235, v[164:165], v[166:167] offset0:104 offset1:105
    v_mfma_f32_16x16x32_bf16 v[0:3], a[252:255], a[32:35], v[0:3]
    s_waitcnt lgkmcnt(14)
    ds_read_b64_tr_b16 a[84:85], v209 offset:43008
    ds_write_b128 v234, v[136:139] offset:24576
    ds_read_b64_tr_b16 a[86:87], v209 offset:44032
    v_mfma_f32_16x16x32_bf16 v[4:7], a[252:255], a[36:39], v[4:7]
    ds_write2st64_b64 v235, v[168:169], v[170:171] offset0:112 offset1:113
    v_mfma_f32_16x16x32_bf16 v[0:3], a[72:75], a[48:51], v[0:3]
    ds_write_b128 v234, v[140:143] offset:28672
    v_mfma_f32_16x16x32_bf16 v[4:7], a[72:75], a[52:55], v[4:7]
    ds_write2st64_b64 v235, v[172:173], v[174:175] offset0:120 offset1:121
    s_waitcnt vmcnt(16)
    v_mfma_f32_16x16x32_bf16 v[8:11], a[252:255], a[40:43], v[8:11]
L_sp_n:
    v_readfirstlane_b32 s88, v254
    s_sub_u32 s64, s64, 1
    s_cbranch_scc1 L_sg_n
    s_cmp_lg_u32 s88, 0
    s_cbranch_scc1 L_sg_n
    buffer_load_dword v254, off, s[96:99], 0 sc1
    s_waitcnt vmcnt(0)
    s_branch L_sp_n
L_sg_n:
    v_mov_b32 v223, s88
    v_mfma_f32_16x16x32_bf16 v[8:11], a[72:75], a[56:59], v[8:11]
    s_mov_b32 exec_lo, 1
    s_mov_b32 exec_hi, 1
    buffer_store_dwordx2 v[222:223], v220, s[44:47], s90 offen sc1
    s_mov_b64 exec, -1
    v_mfma_f32_16x16x32_bf16 v[12:15], a[252:255], a[44:47], v[12:15]
    v_mul_f32 v2, s53, v2
    s_lshl_b32 s3, s51, 6
    v_mfma_f32_16x16x32_bf16 v[32:35], a[88:91], a[0:3], v[32:35]
    v_mul_f32 v0, s53, v0
    v_mul_f32 v3, s53, v3
    v_mfma_f32_16x16x32_bf16 v[12:15], a[72:75], a[60:63], v[12:15]
    v_mul_f32 v1, s53, v1
    s_waitcnt lgkmcnt(15)
    v_mfma_f32_16x16x32_bf16 v[28:31], a[124:127], a[44:47], v[28:31]
    v_cvt_pk_bf16_f32 v177, v2, v3
    v_xor_b32 v216, s3, v243
    v_mfma_f32_16x16x32_bf16 v[20:23], a[124:127], a[36:39], v[20:23]
    s_add_u32 s3, s3, 32
    s_and_b32 s3, s3, 0xff
    v_mfma_f32_16x16x32_bf16 v[28:31], a[76:79], a[60:63], v[28:31]
    v_xor_b32 v217, s3, v243
    v_mfma_f32_16x16x32_bf16 v[24:27], a[124:127], a[40:43], v[24:27]
    s_add_u32 s3, s3, 32
    s_and_b32 s3, s3, 0xff
    v_xor_b32 v218, s3, v243
    v_mfma_f32_16x16x32_bf16 v[20:23], a[76:79], a[52:55], v[20:23]
    s_add_u32 s3, s3, 32
    v_add_u32 v225, 0x10000, v217
    v_add_u32 v224, 0x10000, v216
    v_mfma_f32_16x16x32_bf16 v[16:19], a[124:127], a[32:35], v[16:19]
    s_and_b32 s3, s3, 0xff
    v_xor_b32 v219, s3, v243
    s_add_u32 s3, s3, 32
    v_mfma_f32_16x16x32_bf16 v[16:19], a[76:79], a[48:51], v[16:19]
    s_and_b32 s3, s3, 0xff
    v_mul_f32 v4, s53, v4
    v_xor_b32 v220, s3, v243
    v_mfma_f32_16x16x32_bf16 v[32:35], a[140:143], a[16:19], v[32:35]
    v_add_u32 v227, 0x10000, v219
    v_mfma_f32_16x16x32_bf16 v[24:27], a[76:79], a[56:59], v[24:27]
    v_add_u32 v228, 0x10000, v220
    v_mul_f32 v10, s53, v10
    v_mfma_f32_16x16x32_bf16 v[36:39], a[88:91], a[4:7], v[36:39]
    v_mul_f32 v16, s53, v16
    v_mul_f32 v17, s53, v17
    v_mfma_f32_16x16x32_bf16 v[36:39], a[140:143], a[20:23], v[36:39]
    s_add_u32 s3, s3, 32
    v_mul_f32 v18, s53, v18
    v_mul_f32 v19, s53, v19
    v_mfma_f32_16x16x32_bf16 v[40:43], a[88:91], a[8:11], v[40:43]
    v_cvt_pk_bf16_f32 v176, v0, v1
    v_cvt_pk_bf16_f32 v178, v16, v17
    v_mfma_f32_16x16x32_bf16 v[40:43], a[140:143], a[24:27], v[40:43]
    v_cvt_pk_bf16_f32 v179, v18, v19
    v_mul_f32 v6, s53, v6
    v_mfma_f32_16x16x32_bf16 v[44:47], a[88:91], a[12:15], v[44:47]
    v_mul_f32 v5, s53, v5
    v_mul_f32 v7, s53, v7
    v_mfma_f32_16x16x32_bf16 v[44:47], a[140:143], a[28:31], v[44:47]
    ds_read_b64_tr_b16 a[136:137], v210 offset:28672
    v_mul_f32 v20, s53, v20
    v_mfma_f32_16x16x32_bf16 v[60:63], a[92:95], a[12:15], v[60:63]
    ds_read_b64_tr_b16 a[138:139], v210 offset:29696
    v_add_u32 v226, 0x10000, v218
    v_mfma_f32_16x16x32_bf16 v[60:63], a[144:147], a[28:31], v[60:63]
    s_and_b32 s3, s3, 0xff
    ds_read_b64_tr_b16 a[168:169], v210 offset:43008
    v_mul_f32 v21, s53, v21
    v_mfma_f32_16x16x32_bf16 v[56:59], a[92:95], a[8:11], v[56:59]
    ds_read_b64_tr_b16 a[170:171], v210 offset:44032
    v_mul_f32 v23, s53, v23
    v_mfma_f32_16x16x32_bf16 v[56:59], a[144:147], a[24:27], v[56:59]
    v_cvt_pk_bf16_f32 v180, v4, v5
    v_mul_f32 v22, s53, v22
    v_mfma_f32_16x16x32_bf16 v[52:55], a[92:95], a[4:7], v[52:55]
    v_cvt_pk_bf16_f32 v183, v22, v23
    v_cvt_pk_bf16_f32 v181, v6, v7
    v_mfma_f32_16x16x32_bf16 v[52:55], a[144:147], a[20:23], v[52:55]
    v_cvt_pk_bf16_f32 v182, v20, v21
    v_mfma_f32_16x16x32_bf16 v[48:51], a[92:95], a[0:3], v[48:51]
    v_mul_f32 v9, s53, v9
    v_mul_f32 v8, s53, v8
    v_mfma_f32_16x16x32_bf16 v[48:51], a[144:147], a[16:19], v[48:51]
    ds_read_b64_tr_b16 a[172:173], v211 offset:28672
    s_waitcnt lgkmcnt(15)
    v_mfma_f32_16x16x32_bf16 v[32:35], a[128:131], a[32:35], v[32:35]
    ds_read_b64_tr_b16 a[174:175], v211 offset:29696
    v_mul_f32 v11, s53, v11
    v_mfma_f32_16x16x32_bf16 v[32:35], a[80:83], a[48:51], v[32:35]
    ds_read_b64_tr_b16 a[228:229], v211 offset:43008
    v_mul_f32 v24, s53, v24
    v_mfma_f32_16x16x32_bf16 v[36:39], a[128:131], a[36:39], v[36:39]
    ds_read_b64_tr_b16 a[230:231], v211 offset:44032
    v_mul_f32 v25, s53, v25
    v_mfma_f32_16x16x32_bf16 v[36:39], a[80:83], a[52:55], v[36:39]
    v_mul_f32 v26, s53, v26
    v_mul_f32 v27, s53, v27
    v_mfma_f32_16x16x32_bf16 v[40:43], a[128:131], a[40:43], v[40:43]
    v_cvt_pk_bf16_f32 v184, v8, v9
    v_cvt_pk_bf16_f32 v185, v10, v11
    v_mfma_f32_16x16x32_bf16 v[40:43], a[80:83], a[56:59], v[40:43]
    v_cvt_pk_bf16_f32 v187, v26, v27
    v_cvt_pk_bf16_f32 v186, v24, v25
    v_mfma_f32_16x16x32_bf16 v[44:47], a[128:131], a[44:47], v[44:47]
    v_mul_f32 v13, s53, v13
    v_mul_f32 v12, s53, v12
    v_mfma_f32_16x16x32_bf16 v[44:47], a[80:83], a[60:63], v[44:47]
    s_waitcnt lgkmcnt(15)
    v_mul_f32 v14, s53, v14
    v_mul_f32 v15, s53, v15
    v_mfma_f32_16x16x32_bf16 v[60:63], a[132:135], a[44:47], v[60:63]
    s_waitcnt lgkmcnt(11)
    v_mul_f32 v29, s53, v29
    v_mul_f32 v28, s53, v28
    v_mfma_f32_16x16x32_bf16 v[60:63], a[84:87], a[60:63], v[60:63]
    v_mul_f32 v30, s53, v30
    v_mul_f32 v31, s53, v31
    v_mfma_f32_16x16x32_bf16 v[56:59], a[132:135], a[40:43], v[56:59]
    v_cvt_pk_bf16_f32 v188, v12, v13
    v_cvt_pk_bf16_f32 v189, v14, v15
    v_mfma_f32_16x16x32_bf16 v[56:59], a[84:87], a[56:59], v[56:59]
    v_cvt_pk_bf16_f32 v190, v28, v29
    v_cvt_pk_bf16_f32 v191, v30, v31
    v_mfma_f32_16x16x32_bf16 v[52:55], a[132:135], a[36:39], v[52:55]
    v_mov_b32 v12, 0xf149f2ca
    v_mov_b32 v0, 0x3f803f80
    v_mfma_f32_16x16x32_bf16 v[52:55], a[84:87], a[52:55], v[52:55]
    v_mov_b32 v1, 0x3f803f80
    v_mov_b32 v16, 0xf149f2ca
    v_mfma_f32_16x16x32_bf16 v[48:51], a[132:135], a[32:35], v[48:51]
    v_mov_b32 v17, 0xf149f2ca
    v_mov_b32 v2, 0x3f803f80
    v_mfma_f32_16x16x32_bf16 v[48:51], a[84:87], a[48:51], v[48:51]
    v_mov_b32 v3, 0x3f803f80
    v_mov_b32 v18, 0xf149f2ca
    v_mfma_f32_16x16x32_bf16 v[64:67], a[96:99], a[0:3], v[64:67]
    v_cndmask_b32 v8, v12, 0, s[16:17]
    v_cndmask_b32 v4, 0, v12, s[16:17]
    v_mfma_f32_16x16x32_bf16 v[68:71], a[96:99], a[4:7], v[68:71]
    v_cndmask_b32 v9, v12, 0, s[18:19]
    v_cndmask_b32 v6, 0, v12, s[22:23]
    v_mfma_f32_16x16x32_bf16 v[68:71], a[148:151], a[20:23], v[68:71]
    v_cndmask_b32 v10, v12, 0, s[22:23]
    v_cndmask_b32 v7, 0, v12, s[24:25]
    v_mfma_f32_16x16x32_bf16 v[72:75], a[96:99], a[8:11], v[72:75]
    v_cndmask_b32 v11, v12, 0, s[24:25]
    v_cvt_pk_bf16_f32 v144, v32, v33
    v_mfma_f32_16x16x32_bf16 v[72:75], a[148:151], a[24:27], v[72:75]
    v_cvt_pk_bf16_f32 v145, v34, v35
    v_cvt_pk_bf16_f32 v146, v48, v49
    v_mfma_f32_16x16x32_bf16 v[76:79], a[96:99], a[12:15], v[76:79]
    v_cvt_pk_bf16_f32 v147, v50, v51
    v_pk_max_i16 v144, v144, 0
    v_mfma_f32_16x16x32_bf16 v[76:79], a[148:151], a[28:31], v[76:79]
    ds_read_b64_tr_b16 a[232:233], v212 offset:28672
    v_pk_max_i16 v145, v145, 0
    v_mfma_f32_16x16x32_bf16 v[92:95], a[100:103], a[12:15], v[92:95]
    ds_read_b64_tr_b16 a[234:235], v212 offset:29696
    v_pk_max_i16 v146, v146, 0
    v_mfma_f32_16x16x32_bf16 v[92:95], a[152:155], a[28:31], v[92:95]
    ds_read_b64_tr_b16 a[236:237], v212 offset:43008
    v_pk_max_i16 v147, v147, 0
    v_mfma_f32_16x16x32_bf16 v[88:91], a[100:103], a[8:11], v[88:91]
    s_add_u32 s92, s85, 0x0
    ds_read_b64_tr_b16 a[238:239], v212 offset:44032
    v_cvt_pk_bf16_f32 v155, v58, v59
    v_mfma_f32_16x16x32_bf16 v[64:67], a[148:151], a[16:19], v[64:67]
    buffer_store_dwordx4 v[144:147], v252, s[36:39], s92 offen offset:0 sc1
    v_cvt_pk_bf16_f32 v149, v38, v39
    v_cndmask_b32 v5, 0, v12, s[18:19]
    v_cvt_pk_bf16_f32 v148, v36, v37
    v_mfma_f32_16x16x32_bf16 v[84:87], a[100:103], a[4:7], v[84:87]
    v_cvt_pk_bf16_f32 v150, v52, v53
    v_cvt_pk_bf16_f32 v151, v54, v55
    v_mfma_f32_16x16x32_bf16 v[84:87], a[152:155], a[20:23], v[84:87]
    v_pk_max_i16 v148, v148, 0
    v_pk_max_i16 v149, v149, 0
    v_mfma_f32_16x16x32_bf16 v[80:83], a[100:103], a[0:3], v[80:83]
    v_pk_max_i16 v150, v150, 0
    v_pk_max_i16 v151, v151, 0
    v_mfma_f32_16x16x32_bf16 v[80:83], a[152:155], a[16:19], v[80:83]
    ds_read_b64_tr_b16 a[240:241], v213 offset:28672
    v_mov_b32 v19, 0xf149f2ca
    v_mfma_f32_16x16x32_bf16 v[88:91], a[152:155], a[24:27], v[88:91]
    buffer_store_dwordx4 v[148:151], v252, s[36:39], s92 offen offset:1024 sc1
    v_cvt_pk_bf16_f32 v152, v40, v41
    s_waitcnt lgkmcnt(11)
    v_mfma_f32_16x16x32_bf16 v[64:67], a[136:139], a[32:35], v[64:67]
    ds_read_b64_tr_b16 a[242:243], v213 offset:29696
    s_waitcnt lgkmcnt(10)
    v_mfma_f32_16x16x32_bf16 v[64:67], a[168:171], a[48:51], v[64:67]
    ds_read_b64_tr_b16 a[244:245], v213 offset:43008
    v_cvt_pk_bf16_f32 v153, v42, v43
    v_mfma_f32_16x16x32_bf16 v[68:71], a[136:139], a[36:39], v[68:71]
    ds_read_b64_tr_b16 a[246:247], v213 offset:44032
    v_cvt_pk_bf16_f32 v154, v56, v57
    v_mfma_f32_16x16x32_bf16 v[68:71], a[168:171], a[52:55], v[68:71]
    v_cvt_pk_bf16_f32 v156, v44, v45
    v_pk_max_i16 v152, v152, 0
    v_mfma_f32_16x16x32_bf16 v[72:75], a[136:139], a[40:43], v[72:75]
    v_pk_max_i16 v154, v154, 0
    v_pk_max_i16 v153, v153, 0
    v_mfma_f32_16x16x32_bf16 v[72:75], a[168:171], a[56:59], v[72:75]
    v_cvt_pk_bf16_f32 v157, v46, v47
    v_pk_max_i16 v155, v155, 0
    v_mfma_f32_16x16x32_bf16 v[76:79], a[136:139], a[44:47], v[76:79]
    buffer_store_dwordx4 v[152:155], v252, s[36:39], s92 offen offset:2048 sc1
    v_cvt_pk_bf16_f32 v159, v62, v63
    v_xor_b32 v221, s3, v243
    s_waitcnt lgkmcnt(10)
    v_mfma_f32_16x16x32_bf16 v[92:95], a[172:175], a[44:47], v[92:95]
    v_pk_max_i16 v156, v156, 0
    v_cvt_pk_bf16_f32 v158, v60, v61
    v_mfma_f32_16x16x32_bf16 v[76:79], a[168:171], a[60:63], v[76:79]
    v_pk_max_i16 v157, v157, 0
    s_waitcnt lgkmcnt(8)
    v_mfma_f32_16x16x32_bf16 v[92:95], a[228:231], a[60:63], v[92:95]
    v_pk_max_i16 v159, v159, 0
    v_pk_max_i16 v158, v158, 0
    v_mfma_f32_16x16x32_bf16 v[88:91], a[172:175], a[40:43], v[88:91]
    buffer_store_dwordx4 v[156:159], v252, s[36:39], s92 offen offset:3072 sc1
    s_add_u32 s3, s3, 32
    s_and_b32 s3, s3, 0xff
    v_xor_b32 v222, s3, v243
    v_mfma_f32_16x16x32_bf16 v[84:87], a[172:175], a[36:39], v[84:87]
    v_mfma_f32_16x16x32_bf16 v[84:87], a[228:231], a[52:55], v[84:87]
    v_add_u32 v229, 0x10000, v221
    s_add_u32 s3, s3, 32
    v_mfma_f32_16x16x32_bf16 v[80:83], a[172:175], a[32:35], v[80:83]
    s_and_b32 s3, s3, 0xff
    v_add_u32 v230, 0x10000, v222
    v_mfma_f32_16x16x32_bf16 v[80:83], a[228:231], a[48:51], v[80:83]
    v_xor_b32 v223, s3, v243
    v_mfma_f32_16x16x32_bf16 v[88:91], a[228:231], a[56:59], v[88:91]
    ds_read_b64_tr_b16 a[248:249], v214 offset:28672
    v_add_u32 v231, 0x10000, v223
    v_mfma_f32_16x16x32_bf16 v[96:99], a[104:107], a[0:3], v[96:99]
    ds_read_b64_tr_b16 a[250:251], v214 offset:29696
    ds_read_b64_tr_b16 a[64:65], v214 offset:43008
    v_mfma_f32_16x16x32_bf16 v[96:99], a[156:159], a[16:19], v[96:99]
    v_cvt_pk_bf16_f32 v129, v66, v67
    v_cvt_pk_bf16_f32 v128, v64, v65
    v_mfma_f32_16x16x32_bf16 v[100:103], a[104:107], a[4:7], v[100:103]
    ds_read_b64_tr_b16 a[66:67], v214 offset:44032
    v_cvt_pk_bf16_f32 v130, v80, v81
    v_mfma_f32_16x16x32_bf16 v[100:103], a[156:159], a[20:23], v[100:103]
    v_cvt_pk_bf16_f32 v132, v68, v69
    v_cvt_pk_bf16_f32 v131, v82, v83
    v_mfma_f32_16x16x32_bf16 v[104:107], a[104:107], a[8:11], v[104:107]
    v_pk_max_i16 v128, v128, 0
    v_cvt_pk_bf16_f32 v138, v88, v89
    v_mfma_f32_16x16x32_bf16 v[104:107], a[156:159], a[24:27], v[104:107]
    v_pk_max_i16 v129, v129, 0
    v_pk_max_i16 v130, v130, 0
    v_mfma_f32_16x16x32_bf16 v[108:111], a[104:107], a[12:15], v[108:111]
    v_pk_max_i16 v131, v131, 0
    v_cvt_pk_bf16_f32 v135, v86, v87
    v_mfma_f32_16x16x32_bf16 v[116:119], a[108:111], a[4:7], v[116:119]
    v_cvt_pk_bf16_f32 v139, v90, v91
    v_cvt_pk_bf16_f32 v133, v70, v71
    v_mfma_f32_16x16x32_bf16 v[124:127], a[108:111], a[12:15], v[124:127]
    v_cvt_pk_bf16_f32 v134, v84, v85
    v_pk_max_i16 v132, v132, 0
    v_mfma_f32_16x16x32_bf16 v[124:127], a[160:163], a[28:31], v[124:127]
    s_lshl_b32 s84, s48, 12
    v_cvt_pk_bf16_f32 v137, v74, v75
    v_pk_max_i16 v133, v133, 0
    v_mfma_f32_16x16x32_bf16 v[120:123], a[108:111], a[8:11], v[120:123]
    v_cvt_pk_bf16_f32 v136, v72, v73
    v_pk_max_i16 v135, v135, 0
    v_mfma_f32_16x16x32_bf16 v[120:123], a[160:163], a[24:27], v[120:123]
    s_add_u32 s84, s84, 0x2900000
    v_pk_max_i16 v136, v136, 0
    v_cvt_pk_bf16_f32 v140, v76, v77
    v_mfma_f32_16x16x32_bf16 v[116:119], a[160:163], a[20:23], v[116:119]
    v_pk_max_i16 v137, v137, 0
    v_pk_max_i16 v138, v138, 0
    v_mfma_f32_16x16x32_bf16 v[112:115], a[108:111], a[0:3], v[112:115]
    v_pk_max_i16 v134, v134, 0
    v_pk_max_i16 v139, v139, 0
    v_mfma_f32_16x16x32_bf16 v[112:115], a[160:163], a[16:19], v[112:115]
    v_cvt_pk_bf16_f32 v141, v78, v79
    v_cvt_pk_bf16_f32 v143, v94, v95
    v_mfma_f32_16x16x32_bf16 v[108:111], a[156:159], a[28:31], v[108:111]
    v_cvt_pk_bf16_f32 v142, v92, v93
    s_waitcnt lgkmcnt(10)
    v_mfma_f32_16x16x32_bf16 v[96:99], a[232:235], a[32:35], v[96:99]
    s_waitcnt lgkmcnt(8)
    v_mfma_f32_16x16x32_bf16 v[104:107], a[232:235], a[40:43], v[104:107]
    v_mfma_f32_16x16x32_bf16 v[96:99], a[236:239], a[48:51], v[96:99]
    v_pk_max_i16 v141, v141, 0
    v_pk_max_i16 v143, v143, 0
    v_mfma_f32_16x16x32_bf16 v[100:103], a[232:235], a[36:39], v[100:103]
    v_pk_max_i16 v140, v140, 0
    v_lshlrev_b32 v253, 7, v242
    v_mfma_f32_16x16x32_bf16 v[192:195], a[112:115], a[0:3], v[192:195]
    s_lshl_b32 s3, s51, 10
    v_pk_max_i16 v142, v142, 0
    v_mfma_f32_16x16x32_bf16 v[100:103], a[236:239], a[52:55], v[100:103]
    v_and_b32 v237, 0xf80, v253
    s_add_u32 s87, s3, s84
    v_mfma_f32_16x16x32_bf16 v[104:107], a[236:239], a[56:59], v[104:107]
    v_and_b32 v253, 0x380, v253
    v_mfma_f32_16x16x32_bf16 v[108:111], a[232:235], a[44:47], v[108:111]
    v_cvt_pk_bf16_f32 v160, v96, v97
    s_waitcnt lgkmcnt(6)
    v_mfma_f32_16x16x32_bf16 v[124:127], a[240:243], a[44:47], v[124:127]
    s_waitcnt lgkmcnt(4)
    v_cvt_pk_bf16_f32 v161, v98, v99
    v_mfma_f32_16x16x32_bf16 v[112:115], a[240:243], a[32:35], v[112:115]
    v_mfma_f32_16x16x32_bf16 v[112:115], a[244:247], a[48:51], v[112:115]
    v_mfma_f32_16x16x32_bf16 v[120:123], a[240:243], a[40:43], v[120:123]
    v_mfma_f32_16x16x32_bf16 v[116:119], a[240:243], a[36:39], v[116:119]
    v_mfma_f32_16x16x32_bf16 v[196:199], a[112:115], a[4:7], v[196:199]
    v_mfma_f32_16x16x32_bf16 v[196:199], a[164:167], a[20:23], v[196:199]
    v_pk_max_i16 v160, v160, 0
    v_mfma_f32_16x16x32_bf16 v[116:119], a[244:247], a[52:55], v[116:119]
    v_mfma_f32_16x16x32_bf16 v[108:111], a[236:239], a[60:63], v[108:111]
    s_nop 0
    v_cvt_pk_bf16_f32 v162, v112, v113
    v_mfma_f32_16x16x32_bf16 v[124:127], a[244:247], a[60:63], v[124:127]
    v_pk_max_i16 v161, v161, 0
    v_mfma_f32_16x16x32_bf16 v[200:203], a[112:115], a[8:11], v[200:203]
    v_cvt_pk_bf16_f32 v163, v114, v115
    v_pk_max_i16 v162, v162, 0
    v_mfma_f32_16x16x32_bf16 v[120:123], a[244:247], a[56:59], v[120:123]
    v_pk_max_i16 v163, v163, 0
    v_cvt_pk_bf16_f32 v164, v100, v101
    v_mfma_f32_16x16x32_bf16 v[192:195], a[164:167], a[16:19], v[192:195]
    s_waitcnt vmcnt(5) lgkmcnt(0)
    v_mfma_f32_16x16x32_bf16 v[200:203], a[164:167], a[24:27], v[200:203]
    s_barrier
    s_cmp_eq_u32 s50, 0
    s_cbranch_scc0 L_nf_q
    v_mov_b32 v255, s88
    s_mov_b64 exec, 1
    buffer_store_dword v255, v252, s[44:47], s15 offen offset:0 sc1
    s_mov_b64 exec, -1
L_nf_q:
    ds_read_b128 a[176:179], v234 offset:16384
    ds_read_b128 a[180:183], v234 offset:17408
    v_mfma_f32_16x16x32_bf16 v[204:207], a[112:115], a[12:15], v[204:207]
    v_cvt_pk_bf16_f32 v167, v118, v119
    v_cvt_pk_bf16_f32 v166, v116, v117
    v_mfma_f32_16x16x32_bf16 v[204:207], a[164:167], a[28:31], v[204:207]
    ds_read_b128 a[184:187], v234 offset:18432
    v_pk_max_i16 v166, v166, 0
    v_mfma_f32_16x16x32_bf16 v[204:207], a[248:251], a[44:47], v[204:207]
    ds_read_b128 a[188:191], v234 offset:19456
    v_cvt_pk_bf16_f32 v168, v104, v105
    v_mfma_f32_16x16x32_bf16 v[204:207], a[64:67], a[60:63], v[204:207]
    ds_read_b128 a[192:195], v234 offset:20480
    v_cvt_pk_bf16_f32 v170, v120, v121
    v_mfma_f32_16x16x32_bf16 v[200:203], a[248:251], a[40:43], v[200:203]
    ds_read_b128 a[196:199], v234 offset:21504
    v_cvt_pk_bf16_f32 v171, v122, v123
    v_mfma_f32_16x16x32_bf16 v[200:203], a[64:67], a[56:59], v[200:203]
    ds_read_b128 a[200:203], v234 offset:22528
    v_pk_max_i16 v170, v170, 0
    v_mfma_f32_16x16x32_bf16 v[196:199], a[248:251], a[36:39], v[196:199]
    ds_read_b128 a[204:207], v234 offset:23552
    v_cvt_pk_bf16_f32 v169, v106, v107
    v_mfma_f32_16x16x32_bf16 v[196:199], a[64:67], a[52:55], v[196:199]
    ds_read_b128 a[208:211], v234 offset:24576
    v_cvt_pk_bf16_f32 v173, v110, v111
    v_cvt_pk_bf16_f32 v175, v126, v127
    v_mfma_f32_16x16x32_bf16 v[192:195], a[248:251], a[32:35], v[192:195]
    ds_read_b128 a[212:215], v234 offset:25600
    v_cvt_pk_bf16_f32 v165, v102, v103
    v_mfma_f32_16x16x32_bf16 v[192:195], a[64:67], a[48:51], v[192:195]
    ds_read_b128 a[216:219], v234 offset:26624
    v_pk_max_i16 v175, v175, 0
    v_cvt_pk_bf16_f32 v174, v124, v125
    v_pk_max_i16 v174, v174, 0
    v_pk_max_i16 v168, v168, 0
    v_pk_max_i16 v169, v169, 0
    v_pk_max_i16 v173, v173, 0
    v_pk_max_i16 v167, v167, 0
    v_cvt_pk_bf16_f32 v192, v192, v193
    v_cvt_pk_bf16_f32 v193, v194, v195
    v_cvt_pk_bf16_f32 v195, v198, v199
    v_cvt_pk_bf16_f32 v194, v196, v197
    v_pk_max_i16 v195, v195, 0
    v_cvt_pk_bf16_f32 v200, v200, v201
    v_cvt_pk_bf16_f32 v201, v202, v203
    v_pk_max_i16 v192, v192, 0
    v_cvt_pk_bf16_f32 v202, v204, v205
    v_pk_max_i16 v202, v202, 0
    v_pk_max_i16 v193, v193, 0
    v_pk_max_i16 v194, v194, 0
    v_pk_max_i16 v201, v201, 0
    v_cvt_pk_bf16_f32 v203, v206, v207
    v_pk_max_i16 v203, v203, 0
    v_pk_max_i16 v200, v200, 0
    ds_read_b128 a[220:223], v234 offset:27648
    ds_read_b128 a[224:227], v234 offset:28672
    ds_read_b64_tr_b16 a[32:33], v220 offset:16384
    ds_read_b64_tr_b16 a[34:35], v220 offset:20480
    ds_read_b64_tr_b16 a[36:37], v220 offset:24576
    ds_read_b64_tr_b16 a[38:39], v220 offset:28672
    s_waitcnt lgkmcnt(15)
    v_mfma_f32_16x16x32_bf16 v[32:35], a[176:179], v[176:179], v[4:7]
    v_pk_max_i16 v171, v171, 0
    v_pk_max_i16 v164, v164, 0
    v_mfma_f32_16x16x32_bf16 v[36:39], a[176:179], v[180:183], 0
    v_permlane32_swap_b32 v200, v202
    v_mfma_f32_16x16x32_bf16 v[40:43], a[180:183], v[180:183], 0
    s_add_u32 s92, s85, 0x4000
    v_cvt_pk_bf16_f32 v172, v108, v109
    v_pk_max_i16 v172, v172, 0
    v_mfma_f32_16x16x32_bf16 v[44:47], a[176:179], v[184:187], 0
    v_max3_f32 v16, v16, v32, v33
    v_max3_f32 v16, v16, v34, v35
    v_max3_f32 v17, v17, v36, v37
    v_mfma_f32_16x16x32_bf16 v[48:51], a[180:183], v[184:187], 0
    v_max3_f32 v17, v17, v38, v39
    v_max3_f32 v17, v17, v40, v41
    v_mfma_f32_16x16x32_bf16 v[52:55], a[176:179], v[188:191], 0
    s_nop 0
    v_max3_f32 v18, v18, v44, v45
    v_max3_f32 v17, v17, v42, v43
    s_waitcnt lgkmcnt(14)
    v_mfma_f32_16x16x32_bf16 v[36:39], a[184:187], v[180:183], 0
    v_max3_f32 v18, v18, v46, v47
    v_max3_f32 v18, v18, v48, v49
    v_max3_f32 v18, v18, v50, v51
    v_mfma_f32_16x16x32_bf16 v[32:35], a[180:183], v[188:191], 0
    s_waitcnt lgkmcnt(2)
    buffer_store_dwordx4 v[128:131], v252, s[36:39], s92 offen offset:0 sc1
    v_permlane32_swap_b32 v192, v194
    v_max3_f32 v19, v19, v52, v53
    v_mfma_f32_16x16x32_bf16 v[40:43], a[188:191], v[180:183], 0
    v_permlane32_swap_b32 v201, v203
    v_mfma_f32_16x16x32_bf16 v[44:47], a[184:187], v[184:187], 0
    buffer_store_dwordx4 v[132:135], v252, s[36:39], s92 offen offset:1024 sc1
    v_max3_f32 v19, v19, v54, v55
    v_max3_f32 v19, v19, v32, v33
    v_max3_f32 v19, v19, v34, v35
    v_mfma_f32_16x16x32_bf16 v[48:51], a[188:191], v[184:187], 0
    v_max3_f32 v17, v17, v36, v37
    v_max3_f32 v17, v17, v38, v39
    v_mfma_f32_16x16x32_bf16 v[52:55], a[184:187], v[188:191], 0
    v_max3_f32 v17, v17, v40, v41
    v_max3_f32 v17, v17, v42, v43
    v_mfma_f32_16x16x32_bf16 v[32:35], a[188:191], v[188:191], 0
    v_max3_f32 v18, v18, v44, v45
    v_max3_f32 v18, v18, v46, v47
    v_mfma_f32_16x16x32_bf16 v[36:39], a[192:195], v[180:183], v[4:7]
    v_max3_f32 v18, v18, v48, v49
    v_max3_f32 v18, v18, v50, v51
    v_mfma_f32_16x16x32_bf16 v[48:51], a[192:195], v[188:191], 0
    v_permlane32_swap_b32 v193, v195
    v_mfma_f32_16x16x32_bf16 v[40:43], a[192:195], v[184:187], 0
    v_max3_f32 v19, v19, v52, v53
    v_max3_f32 v19, v19, v54, v55
    v_mfma_f32_16x16x32_bf16 v[44:47], a[196:199], v[184:187], 0
    v_max3_f32 v19, v19, v32, v33
    v_mov_b32 v243, 0
    v_mfma_f32_16x16x32_bf16 a[116:119], a[32:35], v[148:151], 0
    buffer_load_dword v254, v243, s[44:47], s29 offen sc1
    v_pk_max_i16 v165, v165, 0
    v_mfma_f32_16x16x32_bf16 a[112:115], a[32:35], v[144:147], 0
    buffer_store_dwordx4 v[136:139], v252, s[36:39], s92 offen offset:2048 sc1
    v_max3_f32 v19, v19, v34, v35
    v_max3_f32 v17, v17, v36, v37
    v_max3_f32 v17, v17, v38, v39
    v_mfma_f32_16x16x32_bf16 v[52:55], a[196:199], v[188:191], 0
    buffer_store_dwordx4 v[140:143], v252, s[36:39], s92 offen offset:3072 sc1
    v_max3_f32 v18, v18, v40, v41
    v_max3_f32 v18, v18, v42, v43
    v_mov_b32 v24, v16
    v_mfma_f32_16x16x32_bf16 v[32:35], a[200:203], v[184:187], 0
    v_max3_f32 v18, v18, v44, v45
    v_max3_f32 v18, v18, v46, v47
    v_mfma_f32_16x16x32_bf16 v[36:39], a[204:207], v[184:187], 0
    v_max3_f32 v19, v19, v48, v49
    v_max3_f32 v19, v19, v50, v51
    v_mfma_f32_16x16x32_bf16 v[40:43], a[200:203], v[188:191], 0
    v_max3_f32 v19, v19, v52, v53
    v_max3_f32 v19, v19, v54, v55
    v_mfma_f32_16x16x32_bf16 v[44:47], a[204:207], v[188:191], 0
    v_max3_f32 v18, v18, v32, v33
    v_max3_f32 v18, v18, v34, v35
    v_mfma_f32_16x16x32_bf16 v[48:51], a[208:211], v[184:187], v[4:7]
    v_max3_f32 v18, v18, v36, v37
    v_max3_f32 v18, v18, v38, v39
    v_mfma_f32_16x16x32_bf16 v[52:55], a[208:211], v[188:191], 0
    v_max3_f32 v19, v19, v40, v41
    v_max3_f32 v19, v19, v42, v43
    v_mfma_f32_16x16x32_bf16 v[32:35], a[212:215], v[188:191], 0
    v_max3_f32 v19, v19, v44, v45
    v_max3_f32 v19, v19, v46, v47
    v_mfma_f32_16x16x32_bf16 v[36:39], a[216:219], v[188:191], 0
    ds_read2st64_b64 a[0:3], v235 offset0:96 offset1:98
    v_max3_f32 v18, v18, v48, v49
    v_mfma_f32_16x16x32_bf16 v[40:43], a[220:223], v[188:191], 0
    v_max3_f32 v19, v19, v52, v53
    v_max3_f32 v19, v19, v54, v55
    v_mfma_f32_16x16x32_bf16 v[44:47], a[224:227], v[188:191], v[4:7]
    v_max3_f32 v19, v19, v32, v33
    v_max3_f32 v19, v19, v34, v35
    v_max3_f32 v18, v18, v50, v51
    v_max3_f32 v19, v19, v36, v37
    v_max3_f32 v19, v19, v38, v39
    v_max3_f32 v19, v19, v40, v41
    v_mfma_f32_16x16x32_bf16 a[120:123], a[32:35], v[152:155], 0
    ds_read2st64_b64 a[4:7], v235 offset0:97 offset1:99
    ds_read2st64_b64 a[8:11], v235 offset0:100 offset1:102
    ds_read2st64_b64 a[12:15], v235 offset0:101 offset1:103
    v_mov_b32 v26, v18
    v_max3_f32 v19, v19, v42, v43
    v_max3_f32 v19, v19, v44, v45
    v_mov_b32 v25, v17
    v_max3_f32 v19, v19, v46, v47
    v_permlane32_swap_b32 v16, v24
    v_permlane32_swap_b32 v18, v26
    v_mov_b32 v27, v19
    v_permlane32_swap_b32 v17, v25
    v_max_f32 v17, v17, v25
    v_max_f32 v18, v18, v26
    v_permlane32_swap_b32 v19, v27
    v_max_f32 v16, v16, v24
    v_max_f32 v19, v19, v27
    v_mov_b32 v24, v16
    v_mov_b32 v25, v17
    v_mov_b32 v26, v18
    v_permlane16_swap_b32 v16, v24
    v_permlane16_swap_b32 v17, v25
    v_mov_b32 v27, v19
    v_permlane16_swap_b32 v18, v26
    v_mfma_f32_16x16x32_bf16 a[124:127], a[32:35], v[156:159], 0
    v_mov_b64 v[58:59], 0
    v_max_f32 v17, v17, v25
    v_max_f32 v18, v18, v26
    v_permlane16_swap_b32 v19, v27
    v_sub_f32 v69, 0, v17
    v_max_f32 v16, v16, v24
    v_max_f32 v19, v19, v27
    v_sub_f32 v68, 0, v17
    v_sub_f32 v64, 0, v16
    v_sub_f32 v76, 0, v19
    v_sub_f32 v77, 0, v19
    v_cndmask_b32 v35, v64, v12, s[24:25]
    v_cndmask_b32 v34, v64, v12, s[22:23]
    v_cndmask_b32 v32, v64, v12, s[16:17]
    v_cndmask_b32 v33, v64, v12, s[18:19]
    v_mov_b64 v[78:79], v[76:77]
    v_mov_b64 v[70:71], v[68:69]
    v_mfma_f32_16x16x32_bf16 v[32:35], a[176:179], v[176:179], v[32:35]
    v_sub_f32 v65, 0, v16
    v_sub_f32 v72, 0, v18
    v_sub_f32 v73, 0, v18
    v_mfma_f32_16x16x32_bf16 v[44:47], a[180:183], v[180:183], v[68:71]
    v_mov_b64 v[74:75], v[72:73]
    v_mov_b64 v[66:67], v[64:65]
    v_mfma_f32_16x16x32_bf16 v[40:43], a[176:179], v[180:183], v[68:71]
    s_nop 0
    v_exp_f32 v32, v32
    v_exp_f32 v33, v33
    v_exp_f32 v34, v34
    v_exp_f32 v35, v35
    s_waitcnt lgkmcnt(4)
    v_mfma_f32_16x16x32_bf16 a[112:115], a[36:39], v[128:131], a[112:115]
    ds_read2st64_b64 a[16:19], v235 offset0:104 offset1:106
    ds_read2st64_b64 a[20:23], v235 offset0:105 offset1:107
    v_cvt_pk_bf16_f32 v56, v32, v33
    v_cvt_pk_bf16_f32 v57, v34, v35
    v_mfma_f32_16x16x32_bf16 v[32:35], a[176:179], v[184:187], v[72:75]
    v_exp_f32 v41, v41
    v_exp_f32 v40, v40
    v_mfma_f32_16x16x32_bf16 v[36:39], a[180:183], v[184:187], v[72:75]
    s_waitcnt lgkmcnt(5)
    v_exp_f32 v45, v45
    v_mfma_f32_16x16x32_bf16 v[80:83], a[0:3], v[56:59], 0
    ds_read_b64_tr_b16 a[40:41], v220 offset:32768
    ds_read_b64_tr_b16 a[42:43], v220 offset:36864
    v_exp_f32 v42, v42
    v_exp_f32 v46, v46
    v_exp_f32 v47, v47
    v_exp_f32 v43, v43
    v_cvt_pk_bf16_f32 v60, v40, v41
    v_exp_f32 v44, v44
    v_mfma_f32_16x16x32_bf16 v[112:115], v[0:3], v[56:59], 0
    s_mov_b32 s64, 0x8000
    v_exp_f32 v37, v37
    v_cvt_pk_bf16_f32 v62, v44, v45
    v_cvt_pk_bf16_f32 v63, v46, v47
    v_mfma_f32_16x16x32_bf16 v[44:47], a[180:183], v[188:191], v[76:79]
    s_waitcnt lgkmcnt(6)
    v_cvt_pk_bf16_f32 v61, v42, v43
    v_exp_f32 v33, v33
    v_mfma_f32_16x16x32_bf16 v[84:87], a[4:7], v[56:59], 0
    v_exp_f32 v34, v34
    v_exp_f32 v35, v35
    v_mfma_f32_16x16x32_bf16 v[88:91], a[0:3], v[60:63], 0
    v_exp_f32 v36, v36
    v_mfma_f32_16x16x32_bf16 v[92:95], a[4:7], v[60:63], 0
    v_cvt_pk_bf16_f32 v57, v34, v35
    v_exp_f32 v38, v38
    v_mfma_f32_16x16x32_bf16 v[116:119], v[0:3], v[60:63], 0
    v_exp_f32 v32, v32
    v_exp_f32 v39, v39
    v_cvt_pk_bf16_f32 v56, v32, v33
    v_cvt_pk_bf16_f32 v58, v36, v37
    v_cvt_pk_bf16_f32 v59, v38, v39
    v_mfma_f32_16x16x32_bf16 v[40:43], a[176:179], v[188:191], v[76:79]
    s_waitcnt vmcnt(2)
L_sp_q:
    v_cmp_ne_u32 vcc, s88, v254
    s_sub_u32 s64, s64, 1
    s_cmp_eq_u32 s64, 0
    s_cbranch_scc1 L_sg_q
    s_nop 1
    s_cbranch_vccz L_sg_q
    buffer_load_dword v254, v243, s[44:47], s29 offen sc1
    s_waitcnt vmcnt(0)
    s_branch L_sp_q
L_sg_q:
    buffer_load_dwordx4 a[144:147], v252, s[44:47], s13 offen offset:0 sc1
    buffer_load_dwordx4 a[148:151], v252, s[44:47], s13 offen offset:1024 sc1
    buffer_load_dwordx4 a[152:155], v252, s[44:47], s13 offen offset:2048 sc1
    buffer_load_dwordx4 a[156:159], v252, s[44:47], s13 offen offset:3072 sc1
    v_mfma_f32_16x16x32_bf16 a[124:127], a[36:39], v[140:143], a[124:127]
    s_add_u32 s13, s13, 0x400000
    buffer_load_dwordx4 a[160:163], v252, s[44:47], s13 offen offset:0 sc1
    buffer_load_dwordx4 a[164:167], v252, s[44:47], s13 offen offset:1024 sc1
    buffer_load_dwordx4 a[168:171], v252, s[44:47], s13 offen offset:2048 sc1
    buffer_load_dwordx4 a[172:175], v252, s[44:47], s13 offen offset:3072 sc1
    v_mfma_f32_16x16x32_bf16 a[116:119], a[36:39], v[132:135], a[116:119]
    s_lshl_b32 s91, s48, 11
    v_and_b32 v243, 0xf0, v252
    v_exp_f32 v41, v41
    v_lshlrev_b32 v243, 1, v243
    v_mfma_f32_16x16x32_bf16 v[32:35], a[184:187], v[180:183], v[68:71]
    s_lshl_b32 s3, s50, 9
    v_exp_f32 v40, v40
    v_mfma_f32_16x16x32_bf16 a[120:123], a[36:39], v[136:139], a[120:123]
    s_add_u32 s91, s91, s3
    s_waitcnt lgkmcnt(0)
    s_add_u32 s91, s91, 0x2800000
    v_mfma_f32_16x16x32_bf16 a[112:115], a[40:43], v[160:163], a[112:115]
    buffer_load_dwordx4 v[244:247], v243, s[44:47], s91 offen offset:0 sc1
    buffer_load_dwordx4 v[248:251], v243, s[44:47], s91 offen offset:16 sc1
    v_mfma_f32_16x16x32_bf16 v[36:39], a[188:191], v[180:183], v[68:71]
    v_exp_f32 v45, v45
    v_cvt_pk_bf16_f32 v60, v40, v41
    v_exp_f32 v44, v44
    v_exp_f32 v42, v42
    v_exp_f32 v43, v43
    v_mfma_f32_16x16x32_bf16 v[96:99], a[0:3], v[56:59], 0
    ds_read_b64_tr_b16 a[44:45], v221 offset:16384
    ds_read_b64_tr_b16 a[46:47], v221 offset:20480
    v_cvt_pk_bf16_f32 v62, v44, v45
    v_exp_f32 v47, v47
    v_exp_f32 v34, v34
    v_cvt_pk_bf16_f32 v61, v42, v43
    v_exp_f32 v46, v46
    v_mfma_f32_16x16x32_bf16 v[40:43], a[184:187], v[184:187], v[72:75]
    v_cvt_pk_bf16_f32 v63, v46, v47
    v_exp_f32 v32, v32
    v_mfma_f32_16x16x32_bf16 v[100:103], a[4:7], v[56:59], 0
    v_exp_f32 v33, v33
    v_mfma_f32_16x16x32_bf16 v[120:123], v[0:3], v[56:59], 0
    v_exp_f32 v35, v35
    v_exp_f32 v36, v36
    v_mfma_f32_16x16x32_bf16 v[108:111], a[4:7], v[60:63], 0
    v_cvt_pk_bf16_f32 v57, v34, v35
    v_exp_f32 v37, v37
    v_mfma_f32_16x16x32_bf16 v[44:47], a[188:191], v[184:187], v[72:75]
    v_exp_f32 v41, v41
    v_mfma_f32_16x16x32_bf16 v[104:107], a[0:3], v[60:63], 0
    v_cvt_pk_bf16_f32 v56, v32, v33
    v_exp_f32 v38, v38
    v_mfma_f32_16x16x32_bf16 v[32:35], a[184:187], v[188:191], v[76:79]
    v_exp_f32 v39, v39
    v_cvt_pk_bf16_f32 v58, v36, v37
    v_cvt_pk_bf16_f32 v59, v38, v39
    v_mfma_f32_16x16x32_bf16 a[116:119], a[40:43], v[164:167], a[116:119]
    ds_read2st64_b64 a[0:3], v235 offset0:108 offset1:110
    ds_read2st64_b64 a[4:7], v235 offset0:109 offset1:111
    v_exp_f32 v46, v46
    v_exp_f32 v43, v43
    v_mfma_f32_16x16x32_bf16 v[124:127], v[0:3], v[60:63], 0
    v_exp_f32 v40, v40
    v_mfma_f32_16x16x32_bf16 v[36:39], a[188:191], v[188:191], v[76:79]
    v_cvt_pk_bf16_f32 v60, v40, v41
    v_exp_f32 v42, v42
    v_mfma_f32_16x16x32_bf16 v[88:91], a[8:11], v[56:59], v[88:91]
    v_exp_f32 v44, v44
    v_exp_f32 v45, v45
    v_cvt_pk_bf16_f32 v61, v42, v43
    v_cndmask_b32 v40, v68, v12, s[16:17]
    v_mfma_f32_16x16x32_bf16 v[92:95], a[12:15], v[56:59], v[92:95]
    v_cndmask_b32 v43, v68, v12, s[24:25]
    v_exp_f32 v47, v47
    v_cndmask_b32 v41, v68, v12, s[18:19]
    v_exp_f32 v33, v33
    v_exp_f32 v34, v34
    v_exp_f32 v39, v39
    v_cndmask_b32 v42, v68, v12, s[22:23]
    v_cvt_pk_bf16_f32 v63, v46, v47
    v_cvt_pk_bf16_f32 v62, v44, v45
    v_mfma_f32_16x16x32_bf16 v[40:43], a[192:195], v[180:183], v[40:43]
    v_exp_f32 v32, v32
    v_mfma_f32_16x16x32_bf16 v[120:123], v[0:3], v[60:63], v[120:123]
    v_exp_f32 v36, v36
    v_mfma_f32_16x16x32_bf16 v[116:119], v[0:3], v[56:59], v[116:119]
    v_exp_f32 v37, v37
    v_cvt_pk_bf16_f32 v56, v32, v33
    v_exp_f32 v35, v35
    v_mfma_f32_16x16x32_bf16 v[96:99], a[8:11], v[60:63], v[96:99]
    v_cvt_pk_bf16_f32 v58, v36, v37
    v_exp_f32 v38, v38
    v_mfma_f32_16x16x32_bf16 v[100:103], a[12:15], v[60:63], v[100:103]
    v_cvt_pk_bf16_f32 v57, v34, v35
    v_cvt_pk_bf16_f32 v59, v38, v39
    v_mfma_f32_16x16x32_bf16 v[32:35], a[192:195], v[184:187], v[72:75]
    v_exp_f32 v40, v40
    v_exp_f32 v41, v41
    v_mfma_f32_16x16x32_bf16 v[104:107], a[8:11], v[56:59], v[104:107]
    v_exp_f32 v43, v43
    v_mfma_f32_16x16x32_bf16 v[108:111], a[12:15], v[56:59], v[108:111]
    v_exp_f32 v42, v42
    v_mov_b64 v[62:63], 0
    v_mfma_f32_16x16x32_bf16 v[124:127], v[0:3], v[56:59], v[124:127]
    v_cvt_pk_bf16_f32 v60, v40, v41
    v_cvt_pk_bf16_f32 v61, v42, v43
    v_mfma_f32_16x16x32_bf16 a[120:123], a[40:43], v[168:171], a[120:123]
    ds_read2st64_b64 a[8:11], v235 offset0:112 offset1:114
    ds_read2st64_b64 a[12:15], v235 offset0:113 offset1:115
    v_mfma_f32_16x16x32_bf16 v[36:39], a[196:199], v[184:187], v[72:75]
    s_waitcnt vmcnt(10)
    s_barrier
    s_cmp_eq_u32 s50, 0
    s_cbranch_scc0 L_nf_fn
    v_mov_b32 v255, s88
    s_mov_b64 exec, 1
    buffer_store_dword v255, v252, s[44:47], s15 offen offset:4 sc1
    s_mov_b64 exec, -1
L_nf_fn:
    v_mfma_f32_16x16x32_bf16 v[92:95], a[20:23], v[60:63], v[92:95]
    v_exp_f32 v34, v34
    v_mfma_f32_16x16x32_bf16 v[40:43], a[192:195], v[188:191], v[76:79]
    v_exp_f32 v33, v33
    v_exp_f32 v32, v32
    v_exp_f32 v36, v36
    v_mfma_f32_16x16x32_bf16 v[44:47], a[196:199], v[188:191], v[76:79]
    v_exp_f32 v35, v35
    v_mfma_f32_16x16x32_bf16 v[88:91], a[16:19], v[60:63], v[88:91]
    v_cvt_pk_bf16_f32 v56, v32, v33
    v_exp_f32 v37, v37
    v_exp_f32 v38, v38
    v_exp_f32 v39, v39
    v_mfma_f32_16x16x32_bf16 v[116:119], v[0:3], v[60:63], v[116:119]
    v_exp_f32 v40, v40
    v_cvt_pk_bf16_f32 v58, v36, v37
    v_cvt_pk_bf16_f32 v57, v34, v35
    v_cvt_pk_bf16_f32 v59, v38, v39
    v_mfma_f32_16x16x32_bf16 v[32:35], a[200:203], v[184:187], v[72:75]
    v_exp_f32 v41, v41
    v_mfma_f32_16x16x32_bf16 v[120:123], v[0:3], v[56:59], v[120:123]
    v_exp_f32 v42, v42
    v_exp_f32 v43, v43
    v_mfma_f32_16x16x32_bf16 v[36:39], a[204:207], v[184:187], v[72:75]
    v_cvt_pk_bf16_f32 v60, v40, v41
    v_exp_f32 v47, v47
    v_exp_f32 v45, v45
    v_exp_f32 v35, v35
    v_cvt_pk_bf16_f32 v61, v42, v43
    v_exp_f32 v44, v44
    v_mfma_f32_16x16x32_bf16 v[100:103], a[20:23], v[56:59], v[100:103]
    s_nop 0
    v_exp_f32 v36, v36
    v_mfma_f32_16x16x32_bf16 v[96:99], a[16:19], v[56:59], v[96:99]
    v_exp_f32 v33, v33
    v_cvt_pk_bf16_f32 v62, v44, v45
    v_mfma_f32_16x16x32_bf16 a[124:127], a[40:43], v[172:175], a[124:127]
    v_exp_f32 v46, v46
    v_mfma_f32_16x16x32_bf16 v[40:43], a[200:203], v[188:191], v[76:79]
    s_mov_b32 s98, 0x200000
    v_cvt_pk_bf16_f32 v63, v46, v47
    v_exp_f32 v32, v32
    v_exp_f32 v34, v34
    v_mfma_f32_16x16x32_bf16 v[44:47], a[204:207], v[188:191], v[76:79]
    ds_read_b64_tr_b16 a[48:49], v221 offset:24576
    ds_read_b64_tr_b16 a[50:51], v221 offset:28672
    v_mfma_f32_16x16x32_bf16 v[104:107], a[16:19], v[60:63], v[104:107]
    s_waitcnt lgkmcnt(6)
    v_exp_f32 v37, v37
    v_cvt_pk_bf16_f32 v57, v34, v35
    v_exp_f32 v39, v39
    v_mfma_f32_16x16x32_bf16 v[108:111], a[20:23], v[60:63], v[108:111]
    v_exp_f32 v38, v38
    v_mfma_f32_16x16x32_bf16 a[132:135], a[44:47], v[148:151], 0
    s_lshr_b32 s3, s2, 3
    v_cvt_pk_bf16_f32 v58, v36, v37
    v_cvt_pk_bf16_f32 v59, v38, v39
    s_lshl_b32 s96, s51, 5
    v_mfma_f32_16x16x32_bf16 a[136:139], a[44:47], v[152:155], 0
    s_add_u32 s3, s3, s96
    ds_read2st64_b64 a[16:19], v235 offset0:116 offset1:118
    ds_read2st64_b64 a[20:23], v235 offset0:117 offset1:119
    v_mfma_f32_16x16x32_bf16 v[124:127], v[0:3], v[60:63], v[124:127]
    s_lshl_b32 s3, s3, 14
    s_add_u32 s3, s3, s63
    s_and_b32 s97, s21, 0xffff
    v_mfma_f32_16x16x32_bf16 a[128:131], a[44:47], v[144:147], 0
    s_mov_b32 s96, s20
    v_cvt_pk_bf16_f32 v56, v32, v33
    v_lshlrev_b32 v238, 2, v252
    v_mfma_f32_16x16x32_bf16 a[140:143], a[44:47], v[156:159], 0
    buffer_load_dword v238, v238, s[96:99], s3 offen
    s_getpc_b64 s[96:97]
L_crg:
    v_exp_f32 v40, v40
    v_cndmask_b32 v34, v72, v12, s[22:23]
    v_exp_f32 v41, v41
    v_cndmask_b32 v35, v72, v12, s[24:25]
    s_and_b32 s96, s96, 0xffffff80
    v_cndmask_b32 v32, v72, v12, s[16:17]
    v_cndmask_b32 v33, v72, v12, s[18:19]
    s_waitcnt lgkmcnt(2)
    v_mfma_f32_16x16x32_bf16 a[128:131], a[48:51], v[128:131], a[128:131]
    v_exp_f32 v42, v42
    v_cvt_pk_bf16_f32 v60, v40, v41
    v_mfma_f32_16x16x32_bf16 v[96:99], a[0:3], v[56:59], v[96:99]
    ds_read_b64_tr_b16 a[52:53], v221 offset:32768
    ds_read_b64_tr_b16 a[54:55], v221 offset:36864
    v_mfma_f32_16x16x32_bf16 a[136:139], a[48:51], v[136:139], a[136:139]
    v_exp_f32 v44, v44
    v_mfma_f32_16x16x32_bf16 a[132:135], a[48:51], v[132:135], a[132:135]
    v_exp_f32 v45, v45
    v_mfma_f32_16x16x32_bf16 v[32:35], a[208:211], v[184:187], v[32:35]
    v_exp_f32 v43, v43
    v_mfma_f32_16x16x32_bf16 v[100:103], a[4:7], v[56:59], v[100:103]
    s_mov_b32 s98, L_end-L_crg
    v_cvt_pk_bf16_f32 v61, v42, v43
    v_exp_f32 v46, v46
    v_cvt_pk_bf16_f32 v62, v44, v45
    v_mfma_f32_16x16x32_bf16 v[120:123], v[0:3], v[56:59], v[120:123]
    v_exp_f32 v47, v47
    v_mfma_f32_16x16x32_bf16 v[40:43], a[208:211], v[188:191], v[76:79]
    v_mov_b64 v[58:59], 0
    v_cvt_pk_bf16_f32 v63, v46, v47
    v_mfma_f32_16x16x32_bf16 v[44:47], a[212:215], v[188:191], v[76:79]
    v_exp_f32 v33, v33
    v_mfma_f32_16x16x32_bf16 v[104:107], a[0:3], v[60:63], v[104:107]
    s_and_b32 s97, s97, 0xffff
    v_exp_f32 v34, v34
    v_exp_f32 v35, v35
    v_mfma_f32_16x16x32_bf16 v[108:111], a[4:7], v[60:63], v[108:111]
    v_exp_f32 v32, v32
    v_mfma_f32_16x16x32_bf16 v[124:127], v[0:3], v[60:63], v[124:127]
    s_waitcnt lgkmcnt(0)
    v_cvt_pk_bf16_f32 v57, v34, v35
    v_exp_f32 v40, v40
    v_cvt_pk_bf16_f32 v56, v32, v33
    v_mfma_f32_16x16x32_bf16 a[128:131], a[52:55], v[160:163], a[128:131]
    ds_read2st64_b64 a[0:3], v235 offset0:120 offset1:120
    ds_read2st64_b64 a[4:7], v235 offset0:121 offset1:121
    v_mfma_f32_16x16x32_bf16 v[32:35], a[216:219], v[188:191], v[76:79]
    v_exp_f32 v41, v41
    v_mfma_f32_16x16x32_bf16 a[132:135], a[52:55], v[164:167], a[132:135]
    v_exp_f32 v42, v42
    v_mfma_f32_16x16x32_bf16 v[36:39], a[220:223], v[188:191], v[76:79]
    ds_read_b64_tr_b16 a[56:57], v222 offset:16384
    ds_read_b64_tr_b16 a[58:59], v222 offset:20480
    v_cvt_pk_bf16_f32 v60, v40, v41
    v_mfma_f32_16x16x32_bf16 a[136:139], a[52:55], v[168:171], a[136:139]
    v_exp_f32 v44, v44
    v_exp_f32 v43, v43
    v_exp_f32 v45, v45
    v_exp_f32 v47, v47
    v_mfma_f32_16x16x32_bf16 v[96:99], a[8:11], v[56:59], v[96:99]
    v_cndmask_b32 v41, v76, v12, s[18:19]
    v_cvt_pk_bf16_f32 v61, v42, v43
    v_mfma_f32_16x16x32_bf16 a[140:143], a[48:51], v[140:143], a[140:143]
    v_exp_f32 v46, v46
    v_cndmask_b32 v42, v76, v12, s[22:23]
    v_cndmask_b32 v43, v76, v12, s[24:25]
    v_mfma_f32_16x16x32_bf16 a[140:143], a[52:55], v[172:175], a[140:143]
    buffer_load_dword v214, v215, s[96:99], 0 offen sc1
    v_cndmask_b32 v40, v76, v12, s[16:17]
    v_exp_f32 v37, v37
    v_mfma_f32_16x16x32_bf16 v[100:103], a[12:15], v[56:59], v[100:103]
    v_cvt_pk_bf16_f32 v63, v46, v47
    v_cvt_pk_bf16_f32 v62, v44, v45
    v_mfma_f32_16x16x32_bf16 v[120:123], v[0:3], v[56:59], v[120:123]
    s_waitcnt lgkmcnt(0)
    v_exp_f32 v34, v34
    v_mfma_f32_16x16x32_bf16 v[108:111], a[12:15], v[60:63], v[108:111]
    v_exp_f32 v33, v33
    v_exp_f32 v32, v32
    v_mfma_f32_16x16x32_bf16 v[104:107], a[8:11], v[60:63], v[104:107]
    ds_read_b64_tr_b16 a[60:61], v222 offset:24576
    ds_read_b64_tr_b16 a[62:63], v222 offset:28672
    v_mfma_f32_16x16x32_bf16 a[240:243], a[56:59], v[144:147], 0
    v_exp_f32 v36, v36
    v_mfma_f32_16x16x32_bf16 a[244:247], a[56:59], v[148:151], 0
    v_exp_f32 v35, v35
    v_mfma_f32_16x16x32_bf16 a[248:251], a[56:59], v[152:155], 0
    v_exp_f32 v38, v38
    v_mfma_f32_16x16x32_bf16 v[40:43], a[224:227], v[188:191], v[40:43]
    v_cvt_pk_bf16_f32 v56, v32, v33
    v_cvt_pk_bf16_f32 v58, v36, v37
    v_cvt_pk_bf16_f32 v57, v34, v35
    v_exp_f32 v39, v39
    v_mfma_f32_16x16x32_bf16 v[124:127], v[0:3], v[60:63], v[124:127]
    v_cvt_pk_bf16_f32 v59, v38, v39
    v_mov_b64 v[62:63], 0
    s_nop 0
    v_mfma_f32_16x16x32_bf16 v[104:107], a[16:19], v[56:59], v[104:107]
    s_mov_b32 s64, 0x8000
    v_exp_f32 v40, v40
    v_exp_f32 v42, v42
    v_mfma_f32_16x16x32_bf16 v[108:111], a[20:23], v[56:59], v[108:111]
    v_exp_f32 v41, v41
    v_mfma_f32_16x16x32_bf16 v[124:127], v[0:3], v[56:59], v[124:127]
    v_exp_f32 v43, v43
    v_mfma_f32_16x16x32_bf16 a[252:255], a[56:59], v[156:159], 0
    s_waitcnt lgkmcnt(0)
    v_cvt_pk_bf16_f32 v60, v40, v41
    v_cvt_pk_bf16_f32 v61, v42, v43
    v_mfma_f32_16x16x32_bf16 a[244:247], a[60:63], v[132:135], a[244:247]
    s_nop 0
    v_mfma_f32_16x16x32_bf16 v[108:111], a[4:7], v[60:63], v[108:111]
    ds_read_b64_tr_b16 a[32:33], v222 offset:32768
    v_mfma_f32_16x16x32_bf16 a[240:243], a[60:63], v[128:131], a[240:243]
    ds_read_b64_tr_b16 a[34:35], v222 offset:36864
    v_mfma_f32_16x16x32_bf16 v[104:107], a[0:3], v[60:63], v[104:107]
    s_waitcnt vmcnt(8)
    ds_write_b128 v234, a[144:147] offset:0
    v_mfma_f32_16x16x32_bf16 a[252:255], a[60:63], v[140:143], a[252:255]
    ds_write_b128 v234, a[148:151] offset:4096
    v_mfma_f32_16x16x32_bf16 a[248:251], a[60:63], v[136:139], a[248:251]
    ds_write_b128 v234, a[152:155] offset:8192
    ds_write_b128 v234, a[156:159] offset:12288
    v_mfma_f32_16x16x32_bf16 v[124:127], v[0:3], v[60:63], v[124:127]
    s_waitcnt vmcnt(4)
    ds_write2st64_b64 v235, a[160:161], a[162:163] offset0:64 offset1:65
    ds_write2st64_b64 v235, a[164:165], a[166:167] offset0:72 offset1:73
    ds_write2st64_b64 v235, a[168:169], a[170:171] offset0:80 offset1:81
    ds_write2st64_b64 v235, a[172:173], a[174:175] offset0:88 offset1:89
    s_waitcnt vmcnt(2)
L_sp_g:
    v_cmp_ne_u32 vcc, s88, v245
    v_cmp_ne_u32 s[4:5], s88, v247
    v_cmp_ne_u32 s[6:7], s88, v249
    v_cmp_ne_u32 s[100:101], s88, v251
    s_sub_u32 s64, s64, 1
    s_cbranch_scc1 L_sg_g
    s_or_b64 vcc, vcc, s[4:5]
    s_or_b64 s[6:7], s[6:7], s[100:101]
    s_or_b64 vcc, vcc, s[6:7]
    s_cbranch_scc0 L_sg_g
    buffer_load_dwordx4 v[244:247], v243, s[44:47], s91 offen offset:0 sc1
    buffer_load_dwordx4 v[248:251], v243, s[44:47], s91 offen offset:16 sc1
    s_waitcnt vmcnt(0)
    s_branch L_sp_g
L_sg_g:
    v_sub_f32 v251, 1.0, v250
    v_sub_f32 v245, 1.0, v244
    v_sub_f32 v247, 1.0, v246
    v_cvt_pk_bf16_f32 v247, v247, v247
    v_sub_f32 v249, 1.0, v248
    v_cvt_pk_bf16_f32 v251, v251, v251
    v_cvt_pk_bf16_f32 v245, v245, v245
    v_cvt_pk_bf16_f32 v249, v249, v249
    v_and_b32 v245, 0xffff0000, v245
    v_and_b32 v247, 0xffff0000, v247
    s_waitcnt lgkmcnt(0)
    v_mfma_f32_16x16x32_bf16 a[244:247], a[32:35], v[164:167], a[244:247]
    v_and_b32 v249, 0xffff0000, v249
    v_and_b32 v251, 0xffff0000, v251
    v_mfma_f32_16x16x32_bf16 a[252:255], a[32:35], v[172:175], a[252:255]
    ds_read_b64_tr_b16 a[4:5], v223 offset:16384
    ds_read_b64_tr_b16 a[6:7], v223 offset:20480
    v_mfma_f32_16x16x32_bf16 a[248:251], a[32:35], v[168:171], a[248:251]
    ds_read_b64_tr_b16 a[8:9], v223 offset:24576
    ds_read_b64_tr_b16 a[10:11], v223 offset:28672
    v_mfma_f32_16x16x32_bf16 a[240:243], a[32:35], v[160:163], a[240:243]
    s_waitcnt lgkmcnt(0)
    s_barrier
    s_cmp_eq_u32 s48, 0
    s_cbranch_scc1 L_att_z
    ds_read_b128 a[236:239], v234 offset:15360
    ds_read_b128 a[232:235], v234 offset:14336
    ds_read_b128 a[228:231], v234 offset:13312
    ds_read_b128 a[224:227], v234 offset:12288
    ds_read_b128 a[220:223], v234 offset:11264
    ds_read_b128 a[216:219], v234 offset:10240
    v_mov_b32 v22, v18
    v_mov_b32 v20, v16
    s_waitcnt lgkmcnt(5)
    v_mfma_f32_16x16x32_bf16 v[32:35], a[236:239], v[188:191], 0
    ds_read_b128 a[212:215], v234 offset:9216
    v_mov_b32 v21, v17
    v_mfma_f32_16x16x32_bf16 v[40:43], a[236:239], v[184:187], 0
    v_mov_b32 v23, v19
    s_waitcnt lgkmcnt(5)
    v_mfma_f32_16x16x32_bf16 v[36:39], a[232:235], v[188:191], 0
    ds_read_b128 a[208:211], v234 offset:8192
    ds_read_b128 a[204:207], v234 offset:7168
    v_mfma_f32_16x16x32_bf16 v[44:47], a[232:235], v[184:187], 0
    s_add_u32 m0, s61, 0x18000
    v_max3_f32 v19, v19, v32, v33
    v_max3_f32 v19, v19, v34, v35
    v_mfma_f32_16x16x32_bf16 v[48:51], a[236:239], v[180:183], 0
    s_nop 0
    v_max3_f32 v19, v19, v36, v37
    v_max3_f32 v19, v19, v38, v39
    v_mfma_f32_16x16x32_bf16 v[52:55], a[232:235], v[180:183], 0
    v_max3_f32 v18, v18, v40, v41
    v_max3_f32 v18, v18, v42, v43
    v_mfma_f32_16x16x32_bf16 v[32:35], a[236:239], v[176:179], 0
    ds_read_b128 a[200:203], v234 offset:6144
    v_max3_f32 v18, v18, v44, v45
    v_mfma_f32_16x16x32_bf16 v[36:39], a[232:235], v[176:179], 0
    v_max3_f32 v17, v17, v48, v49
    v_max3_f32 v17, v17, v50, v51
    v_max3_f32 v17, v17, v52, v53
    v_max3_f32 v18, v18, v46, v47
    s_waitcnt lgkmcnt(7)
    v_mfma_f32_16x16x32_bf16 v[40:43], a[228:231], v[188:191], 0
    ds_read_b128 a[196:199], v234 offset:5120
    s_waitcnt lgkmcnt(7)
    v_mfma_f32_16x16x32_bf16 v[44:47], a[224:227], v[188:191], v[8:11]
    v_max3_f32 v16, v16, v32, v33
    v_max3_f32 v17, v17, v54, v55
    v_max3_f32 v16, v16, v34, v35
    v_mfma_f32_16x16x32_bf16 v[48:51], a[228:231], v[184:187], 0
    ds_read_b128 a[192:195], v234 offset:4096
    v_max3_f32 v16, v16, v36, v37
    v_mfma_f32_16x16x32_bf16 v[52:55], a[224:227], v[184:187], 0
    v_max3_f32 v19, v19, v40, v41
    v_max3_f32 v19, v19, v42, v43
    v_max3_f32 v16, v16, v38, v39
    v_mfma_f32_16x16x32_bf16 v[32:35], a[228:231], v[180:183], 0
    ds_read_b128 a[188:191], v234 offset:3072
    v_max3_f32 v18, v18, v48, v49
    v_max3_f32 v19, v19, v44, v45
    v_max3_f32 v19, v19, v46, v47
    v_max3_f32 v18, v18, v50, v51
    v_mfma_f32_16x16x32_bf16 v[40:43], a[228:231], v[176:179], 0
    ds_read_b128 a[184:187], v234 offset:2048
    v_max3_f32 v18, v18, v52, v53
    v_max3_f32 v17, v17, v32, v33
    v_mfma_f32_16x16x32_bf16 v[36:39], a[224:227], v[180:183], 0
    buffer_load_dwordx4 v232, s[40:43], s59 offen lds
    buffer_load_dwordx4 v233, s[40:43], s59 offen offset:1024 lds
    s_add_u32 s59, s59, 0x20000
    v_max3_f32 v17, v17, v34, v35
    s_add_u32 s59, s59, s9
    v_max3_f32 v18, v18, v54, v55
    v_mfma_f32_16x16x32_bf16 v[44:47], a[224:227], v[176:179], 0
    s_sub_u32 s3, s59, 0x1c0000
    s_waitcnt lgkmcnt(9)
    s_cmp_ge_u32 s59, s66
    v_mfma_f32_16x16x32_bf16 v[48:51], a[220:223], v[184:187], 0
    s_cselect_b32 s59, s3, s59
    ds_read_b128 a[180:183], v234 offset:1024
    v_max3_f32 v16, v16, v40, v41
    s_waitcnt lgkmcnt(9)
    v_mfma_f32_16x16x32_bf16 v[52:55], a[216:219], v[184:187], 0
    v_max3_f32 v16, v16, v42, v43
    v_max3_f32 v16, v16, v44, v45
    v_mfma_f32_16x16x32_bf16 v[32:35], a[220:223], v[180:183], 0
    ds_read_b128 a[176:179], v234 offset:0
    v_max3_f32 v18, v18, v48, v49
    v_mfma_f32_16x16x32_bf16 v[40:43], a[220:223], v[176:179], 0
    v_max3_f32 v17, v17, v36, v37
    v_max3_f32 v17, v17, v38, v39
    v_mfma_f32_16x16x32_bf16 v[36:39], a[216:219], v[180:183], 0
    s_add_u32 m0, s61, 0x1a000
    v_max3_f32 v16, v16, v46, v47
    v_max3_f32 v18, v18, v50, v51
    v_max3_f32 v18, v18, v52, v53
    v_max3_f32 v18, v18, v54, v55
    v_max3_f32 v17, v17, v32, v33
    v_mfma_f32_16x16x32_bf16 v[44:47], a[216:219], v[176:179], 0
    s_waitcnt lgkmcnt(9)
    v_max3_f32 v17, v17, v34, v35
    v_max3_f32 v17, v17, v36, v37
    v_mfma_f32_16x16x32_bf16 v[32:35], a[212:215], v[180:183], 0
    s_waitcnt lgkmcnt(8)
    v_max3_f32 v16, v16, v40, v41
    v_max3_f32 v17, v17, v38, v39
    v_max3_f32 v16, v16, v42, v43
    v_mfma_f32_16x16x32_bf16 v[48:51], a[212:215], v[184:187], 0
    buffer_load_dwordx4 v232, s[40:43], s59 offen lds
    buffer_load_dwordx4 v233, s[40:43], s59 offen offset:1024 lds
    buffer_load_dword v254, v253, s[44:47], s87 offen offset:4 sc1
    v_mfma_f32_16x16x32_bf16 v[52:55], a[208:211], v[184:187], v[8:11]
    s_add_u32 s59, s59, 0x10000
    v_max3_f32 v16, v16, v44, v45
    v_max3_f32 v16, v16, v46, v47
    v_mfma_f32_16x16x32_bf16 v[36:39], a[208:211], v[180:183], 0
    v_max3_f32 v18, v18, v48, v49
    v_max3_f32 v18, v18, v50, v51
    v_mfma_f32_16x16x32_bf16 v[40:43], a[212:215], v[176:179], 0
    s_nop 0
    v_max3_f32 v18, v18, v52, v53
    v_max3_f32 v18, v18, v54, v55
    v_mfma_f32_16x16x32_bf16 v[44:47], a[208:211], v[176:179], 0
    s_waitcnt lgkmcnt(7)
    v_max3_f32 v17, v17, v32, v33
    v_max3_f32 v17, v17, v34, v35
    v_mfma_f32_16x16x32_bf16 v[48:51], a[204:207], v[180:183], 0
    s_waitcnt lgkmcnt(6)
    v_max3_f32 v17, v17, v36, v37
    v_max3_f32 v16, v16, v40, v41
    v_max3_f32 v16, v16, v42, v43
    v_max3_f32 v16, v16, v44, v45
    v_mfma_f32_16x16x32_bf16 v[32:35], a[204:207], v[176:179], 0
    v_max3_f32 v16, v16, v46, v47
    v_max3_f32 v17, v17, v38, v39
    v_mfma_f32_16x16x32_bf16 v[36:39], a[200:203], v[176:179], 0
    v_max3_f32 v17, v17, v48, v49
    v_max3_f32 v17, v17, v50, v51
    v_mfma_f32_16x16x32_bf16 v[52:55], a[200:203], v[180:183], 0
    s_add_u32 m0, s61, 0x1c000
    s_nop 0
    buffer_load_dwordx4 v232, s[40:43], s59 offen lds
    buffer_load_dwordx4 v233, s[40:43], s59 offen offset:1024 lds
    s_waitcnt lgkmcnt(5)
    v_mfma_f32_16x16x32_bf16 v[40:43], a[196:199], v[180:183], 0
    s_add_u32 s59, s59, 0x30000
    s_waitcnt lgkmcnt(4)
    v_max3_f32 v17, v17, v52, v53
    v_mfma_f32_16x16x32_bf16 v[44:47], a[192:195], v[180:183], v[8:11]
    s_add_u32 m0, s61, 0x1e000
    v_max3_f32 v16, v16, v32, v33
    v_max3_f32 v16, v16, v34, v35
    v_mfma_f32_16x16x32_bf16 v[48:51], a[196:199], v[176:179], 0
    v_max3_f32 v16, v16, v36, v37
    v_max3_f32 v16, v16, v38, v39
    v_max3_f32 v17, v17, v54, v55
    v_mfma_f32_16x16x32_bf16 v[52:55], a[192:195], v[176:179], 0
    s_waitcnt lgkmcnt(3)
    v_max3_f32 v17, v17, v40, v41
    v_max3_f32 v17, v17, v42, v43
    v_mfma_f32_16x16x32_bf16 v[32:35], a[188:191], v[176:179], 0
    s_waitcnt lgkmcnt(2)
    v_max3_f32 v17, v17, v44, v45
    v_max3_f32 v17, v17, v46, v47
    v_max3_f32 v16, v16, v48, v49
    v_mfma_f32_16x16x32_bf16 v[36:39], a[184:187], v[176:179], 0
    s_waitcnt lgkmcnt(1)
    v_max3_f32 v16, v16, v50, v51
    v_max3_f32 v16, v16, v52, v53
    v_mfma_f32_16x16x32_bf16 v[40:43], a[180:183], v[176:179], 0
    s_waitcnt lgkmcnt(0)
    v_max3_f32 v16, v16, v54, v55
    v_max3_f32 v16, v16, v32, v33
    v_mfma_f32_16x16x32_bf16 v[44:47], a[176:179], v[176:179], v[8:11]
    buffer_load_dwordx4 v232, s[40:43], s59 offen lds
    buffer_load_dwordx4 v233, s[40:43], s59 offen offset:1024 lds
    ds_read2st64_b64 a[144:147], v235 offset0:92 offset1:94
    v_max3_f32 v16, v16, v34, v35
    v_max3_f32 v16, v16, v36, v37
    v_max3_f32 v16, v16, v38, v39
    v_max3_f32 v16, v16, v40, v41
    v_max3_f32 v16, v16, v42, v43
    s_add_u32 s59, s59, 0x10000
    ds_read2st64_b64 a[148:151], v235 offset0:93 offset1:95
    ds_read2st64_b64 a[152:155], v235 offset0:88 offset1:90
    ds_read2st64_b64 a[156:159], v235 offset0:89 offset1:91
    v_max3_f32 v16, v16, v44, v45
    v_max3_f32 v16, v16, v46, v47
    v_mov_b32 v25, v17
    v_mov_b32 v24, v16
    v_mov_b32 v27, v19
    v_mov_b32 v26, v18
    v_permlane32_swap_b32 v16, v24
    v_max_f32 v16, v16, v24
    v_permlane32_swap_b32 v17, v25
    v_permlane32_swap_b32 v18, v26
    v_permlane32_swap_b32 v19, v27
    v_max_f32 v17, v17, v25
    v_mov_b32 v25, v17
    v_max_f32 v19, v19, v27
    v_mov_b32 v24, v16
    v_max_f32 v18, v18, v26
    v_mov_b32 v27, v19
    v_permlane16_swap_b32 v16, v24
    v_mov_b32 v26, v18
    v_max_f32 v16, v16, v24
    v_permlane16_swap_b32 v19, v27
    v_permlane16_swap_b32 v18, v26
    v_permlane16_swap_b32 v17, v25
    v_max_f32 v19, v19, v27
    v_sub_f32 v76, 0, v19
    v_max_f32 v17, v17, v25
    v_max_f32 v18, v18, v26
    v_sub_f32 v77, 0, v19
    v_sub_f32 v27, v23, v19
    v_sub_f32 v64, 0, v16
    v_mov_b64 v[78:79], v[76:77]
    v_exp_f32 v27, v27
    v_sub_f32 v65, 0, v16
    v_sub_f32 v69, 0, v17
    v_sub_f32 v68, 0, v17
    v_sub_f32 v73, 0, v18
    v_mov_b64 v[66:67], v[64:65]
    v_sub_f32 v72, 0, v18
    v_mul_f32 v108, v108, v27
    v_mul_f32 v105, v105, v27
    v_mfma_f32_16x16x32_bf16 v[36:39], a[236:239], v[188:191], v[76:79]
    s_mov_b32 s64, 0x8000
    v_mul_f32 v111, v111, v27
    v_mul_f32 v106, v106, v27
    v_mul_f32 v109, v109, v27
    v_mfma_f32_16x16x32_bf16 v[32:35], a[232:235], v[188:191], v[76:79]
    s_add_u32 m0, s61, 0x20000
    v_mov_b64 v[70:71], v[68:69]
    v_mul_f32 v110, v110, v27
    v_mul_f32 v107, v107, v27
    v_exp_f32 v36, v36
    v_exp_f32 v37, v37
    v_exp_f32 v38, v38
    v_mul_f32 v124, v124, v27
    v_exp_f32 v39, v39
    v_exp_f32 v32, v32
    v_mov_b64 v[74:75], v[72:73]
    v_exp_f32 v33, v33
    v_mul_f32 v104, v104, v27
    v_cvt_pk_bf16_f32 v58, v36, v37
    v_exp_f32 v34, v34
    v_exp_f32 v35, v35
    v_cvt_pk_bf16_f32 v59, v38, v39
    v_mfma_f32_16x16x32_bf16 v[44:47], a[236:239], v[184:187], v[72:75]
    ds_read2st64_b64 a[160:163], v235 offset0:84 offset1:86
    ds_read2st64_b64 a[164:167], v235 offset0:85 offset1:87
    buffer_load_dwordx4 v232, s[40:43], s59 offen lds
    buffer_load_dwordx4 v233, s[40:43], s59 offen offset:1024 lds
    s_add_u32 s59, s59, 0x20000
    v_cvt_pk_bf16_f32 v57, v34, v35
    s_sub_u32 s3, s59, 0x1c0000
    v_cvt_pk_bf16_f32 v56, v32, v33
    s_cmp_ge_u32 s59, s66
    v_mfma_f32_16x16x32_bf16 v[40:43], a[232:235], v[184:187], v[72:75]
    s_cselect_b32 s59, s3, s59
    s_waitcnt vmcnt(6)
    s_add_u32 s93, s87, 4
L_sp_hn:
    v_cmp_ne_u32 vcc, s88, v254
    s_sub_u32 s64, s64, 1
    s_cmp_eq_u32 s64, 0
    s_cbranch_scc1 L_sg_hn
    s_nop 1
    s_cbranch_vccz L_sg_hn
    buffer_load_dword v254, v253, s[44:47], s93 offen sc1
    s_waitcnt vmcnt(0)
    s_branch L_sp_hn
L_sg_hn:
    v_sub_f32 v26, v22, v18
    v_mfma_f32_16x16x32_bf16 v[36:39], a[236:239], v[180:183], v[68:71]
    v_exp_f32 v26, v26
    v_exp_f32 v44, v44
    v_exp_f32 v47, v47
    v_exp_f32 v43, v43
    v_mul_f32 v97, v97, v26
    v_mul_f32 v100, v100, v26
    v_mul_f32 v101, v101, v26
    v_mul_f32 v99, v99, v26
    v_mul_f32 v102, v102, v26
    v_mul_f32 v98, v98, v26
    v_mul_f32 v96, v96, v26
    v_mfma_f32_16x16x32_bf16 v[32:35], a[232:235], v[180:183], v[68:71]
    s_waitcnt lgkmcnt(5)
    v_exp_f32 v42, v42
    v_mul_f32 v103, v103, v26
    v_mfma_f32_16x16x32_bf16 v[104:107], a[144:147], v[56:59], v[104:107]
    v_exp_f32 v45, v45
    v_mfma_f32_16x16x32_bf16 v[124:127], v[0:3], v[56:59], v[124:127]
    s_waitcnt lgkmcnt(4)
    v_exp_f32 v46, v46
    v_exp_f32 v40, v40
    v_cvt_pk_bf16_f32 v63, v46, v47
    v_exp_f32 v41, v41
    v_mfma_f32_16x16x32_bf16 v[108:111], a[148:151], v[56:59], v[108:111]
    buffer_load_dwordx4 a[32:35], v252, s[36:39], s58 offen offset:0 sc1
    buffer_load_dwordx4 a[36:39], v252, s[36:39], s58 offen offset:1024 sc1
    v_sub_f32 v25, v21, v17
    v_exp_f32 v25, v25
    v_cvt_pk_bf16_f32 v62, v44, v45
    v_exp_f32 v32, v32
    v_cvt_pk_bf16_f32 v60, v40, v41
    v_mul_f32 v89, v89, v25
    v_mul_f32 v95, v95, v25
    v_exp_f32 v36, v36
    v_cvt_pk_bf16_f32 v61, v42, v43
    v_exp_f32 v34, v34
    v_mul_f32 v88, v88, v25
    v_exp_f32 v33, v33
    v_mul_f32 v120, v120, v26
    v_exp_f32 v35, v35
    v_mul_f32 v116, v116, v25
    v_exp_f32 v38, v38
    v_mul_f32 v90, v90, v25
    v_mfma_f32_16x16x32_bf16 v[100:103], a[148:151], v[60:63], v[100:103]
    v_exp_f32 v37, v37
    v_cvt_pk_bf16_f32 v56, v32, v33
    v_cvt_pk_bf16_f32 v57, v34, v35
    v_exp_f32 v39, v39
    v_mul_f32 v92, v92, v25
    v_mfma_f32_16x16x32_bf16 v[44:47], a[236:239], v[176:179], v[64:67]
    buffer_load_dwordx4 a[40:43], v252, s[36:39], s58 offen offset:2048 sc1
    buffer_load_dwordx4 a[44:47], v252, s[36:39], s58 offen offset:3072 sc1
    v_mfma_f32_16x16x32_bf16 v[40:43], a[232:235], v[176:179], v[64:67]
    v_mul_f32 v93, v93, v25
    v_mul_f32 v94, v94, v25
    v_cndmask_b32 v35, v12, v76, s[24:25]
    v_mfma_f32_16x16x32_bf16 v[120:123], v[0:3], v[60:63], v[120:123]
    v_sub_f32 v24, v20, v16
    v_cndmask_b32 v32, v12, v76, s[16:17]
    v_exp_f32 v45, v45
    v_cvt_pk_bf16_f32 v58, v36, v37
    v_exp_f32 v46, v46
    v_exp_f32 v47, v47
    v_mfma_f32_16x16x32_bf16 v[96:99], a[144:147], v[60:63], v[96:99]
    v_cvt_pk_bf16_f32 v59, v38, v39
    v_exp_f32 v43, v43
    v_cvt_pk_bf16_f32 v63, v46, v47
    v_mfma_f32_16x16x32_bf16 v[36:39], a[228:231], v[188:191], v[76:79]
    s_add_u32 s58, s58, 0x4000
    v_exp_f32 v24, v24
    v_exp_f32 v41, v41
    v_mul_f32 v84, v84, v24
    v_cndmask_b32 v34, v12, v76, s[22:23]
    v_exp_f32 v40, v40
    v_mul_f32 v80, v80, v24
    v_mfma_f32_16x16x32_bf16 v[116:119], v[0:3], v[56:59], v[116:119]
    v_exp_f32 v42, v42
    v_mul_f32 v83, v83, v24
    v_mul_f32 v91, v91, v25
    v_exp_f32 v44, v44
    v_exp_f32 v36, v36
    v_mul_f32 v86, v86, v24
    v_mfma_f32_16x16x32_bf16 v[88:91], a[144:147], v[56:59], v[88:91]
    v_exp_f32 v37, v37
    v_mul_f32 v87, v87, v24
    v_cndmask_b32 v33, v12, v76, s[18:19]
    v_cvt_pk_bf16_f32 v60, v40, v41
    v_mfma_f32_16x16x32_bf16 v[92:95], a[148:151], v[56:59], v[92:95]
    v_cvt_pk_bf16_f32 v62, v44, v45
    v_mul_f32 v81, v81, v24
    v_mul_f32 v112, v112, v24
    v_mfma_f32_16x16x32_bf16 v[32:35], a[224:227], v[188:191], v[32:35]
    buffer_load_dwordx4 a[48:51], v252, s[36:39], s58 offen offset:0 sc1
    buffer_load_dwordx4 a[52:55], v252, s[36:39], s58 offen offset:1024 sc1
    v_exp_f32 v38, v38
    v_cvt_pk_bf16_f32 v61, v42, v43
    v_mul_f32 v82, v82, v24
    v_mfma_f32_16x16x32_bf16 v[40:43], a[224:227], v[184:187], v[72:75]
    v_exp_f32 v39, v39
    v_cvt_pk_bf16_f32 v58, v36, v37
    v_mul_f32 v85, v85, v24
    v_exp_f32 v34, v34
    v_cvt_pk_bf16_f32 v59, v38, v39
    v_mfma_f32_16x16x32_bf16 v[80:83], a[144:147], v[60:63], v[80:83]
    v_exp_f32 v35, v35
    v_mfma_f32_16x16x32_bf16 v[84:87], a[148:151], v[60:63], v[84:87]
    v_exp_f32 v32, v32
    v_mfma_f32_16x16x32_bf16 v[44:47], a[228:231], v[184:187], v[72:75]
    ds_read2st64_b64 a[144:147], v235 offset0:80 offset1:82
    ds_read2st64_b64 a[148:151], v235 offset0:81 offset1:83
    buffer_load_dwordx4 a[56:59], v252, s[36:39], s58 offen offset:2048 sc1
    buffer_load_dwordx4 a[60:63], v252, s[36:39], s58 offen offset:3072 sc1
    s_add_u32 s58, s58, 0x8000
    v_exp_f32 v40, v40
    v_mfma_f32_16x16x32_bf16 v[36:39], a[228:231], v[180:183], v[68:71]
    s_add_u32 s58, s58, s8
    s_sub_u32 s3, s58, 0x70000
    v_exp_f32 v33, v33
    v_exp_f32 v43, v43
    v_exp_f32 v41, v41
    v_cvt_pk_bf16_f32 v56, v32, v33
    v_mfma_f32_16x16x32_bf16 v[112:115], v[0:3], v[60:63], v[112:115]
    s_cmp_ge_u32 s58, s55
    v_exp_f32 v45, v45
    v_cvt_pk_bf16_f32 v57, v34, v35
    v_mfma_f32_16x16x32_bf16 v[32:35], a[224:227], v[180:183], v[68:71]
    s_cselect_b32 s58, s3, s58
    v_exp_f32 v44, v44
    v_exp_f32 v47, v47
    s_waitcnt lgkmcnt(5)
    v_mfma_f32_16x16x32_bf16 v[104:107], a[152:155], v[56:59], v[104:107]
    v_exp_f32 v46, v46
    v_mfma_f32_16x16x32_bf16 v[124:127], v[0:3], v[56:59], v[124:127]
    s_waitcnt lgkmcnt(4)
    v_cvt_pk_bf16_f32 v63, v46, v47
    v_cvt_pk_bf16_f32 v62, v44, v45
    v_exp_f32 v42, v42
    v_cvt_pk_bf16_f32 v60, v40, v41
    v_mfma_f32_16x16x32_bf16 v[108:111], a[156:159], v[56:59], v[108:111]
    buffer_load_dwordx4 a[64:67], v252, s[36:39], s58 offen offset:0 sc1
    buffer_load_dwordx4 a[68:71], v252, s[36:39], s58 offen offset:1024 sc1
    v_exp_f32 v36, v36
    v_cvt_pk_bf16_f32 v61, v42, v43
    v_exp_f32 v37, v37
    v_exp_f32 v33, v33
    v_exp_f32 v32, v32
    v_exp_f32 v39, v39
    v_exp_f32 v35, v35
    v_cvt_pk_bf16_f32 v56, v32, v33
    v_rcp_f32 v31, v124
    v_mfma_f32_16x16x32_bf16 v[44:47], a[228:231], v[176:179], v[64:67]
    v_mul_f32 v31, v31, v250
    v_mul_f32 v107, v107, v31
    v_mul_f32 v108, v108, v31
    v_mfma_f32_16x16x32_bf16 v[120:123], v[0:3], v[60:63], v[120:123]
    v_exp_f32 v38, v38
    v_exp_f32 v34, v34
    v_mul_f32 v109, v109, v31
    v_cvt_pk_bf16_f32 v58, v36, v37
    v_mfma_f32_16x16x32_bf16 v[100:103], a[156:159], v[60:63], v[100:103]
    v_cvt_pk_bf16_f32 v57, v34, v35
    v_mul_f32 v111, v111, v31
    v_cvt_pk_bf16_f32 v59, v38, v39
    v_mul_f32 v105, v105, v31
    v_mfma_f32_16x16x32_bf16 v[40:43], a[224:227], v[176:179], v[64:67]
    buffer_load_dwordx4 a[72:75], v252, s[36:39], s58 offen offset:2048 sc1
    buffer_load_dwordx4 a[76:79], v252, s[36:39], s58 offen offset:3072 sc1
    v_mfma_f32_16x16x32_bf16 v[36:39], a[220:223], v[184:187], v[72:75]
    v_exp_f32 v47, v47
    v_exp_f32 v44, v44
    v_exp_f32 v46, v46
    v_cvt_pk_bf16_f32 v190, v108, v109
    v_exp_f32 v45, v45
    v_mfma_f32_16x16x32_bf16 v[96:99], a[152:155], v[60:63], v[96:99]
    v_exp_f32 v42, v42
    v_cvt_pk_bf16_f32 v63, v46, v47
    v_exp_f32 v40, v40
    v_mfma_f32_16x16x32_bf16 v[88:91], a[152:155], v[56:59], v[88:91]
    s_add_u32 s58, s58, 0x4000
    v_exp_f32 v43, v43
    v_mul_f32 v106, v106, v31
    v_mfma_f32_16x16x32_bf16 v[116:119], v[0:3], v[56:59], v[116:119]
    v_exp_f32 v41, v41
    v_cvt_pk_bf16_f32 v62, v44, v45
    v_cvt_pk_bf16_f32 v60, v40, v41
    v_mfma_f32_16x16x32_bf16 v[92:95], a[156:159], v[56:59], v[92:95]
    v_exp_f32 v37, v37
    v_cvt_pk_bf16_f32 v61, v42, v43
    v_exp_f32 v36, v36
    v_mfma_f32_16x16x32_bf16 v[32:35], a[216:219], v[184:187], v[72:75]
    buffer_load_dwordx4 a[80:83], v252, s[36:39], s58 offen offset:0 sc1
    buffer_load_dwordx4 a[84:87], v252, s[36:39], s58 offen offset:1024 sc1
    v_mfma_f32_16x16x32_bf16 v[84:87], a[156:159], v[60:63], v[84:87]
    v_exp_f32 v38, v38
    v_mul_f32 v110, v110, v31
    v_cvt_pk_bf16_f32 v191, v110, v111
    v_mfma_f32_16x16x32_bf16 v[80:83], a[152:155], v[60:63], v[80:83]
    v_exp_f32 v39, v39
    v_cvt_pk_bf16_f32 v58, v36, v37
    v_exp_f32 v34, v34
    v_exp_f32 v35, v35
    v_exp_f32 v32, v32
    v_exp_f32 v33, v33
    v_mfma_f32_16x16x32_bf16 v[112:115], v[0:3], v[60:63], v[112:115]
    v_cvt_pk_bf16_f32 v56, v32, v33
    v_cvt_pk_bf16_f32 v57, v34, v35
    v_mfma_f32_16x16x32_bf16 v[44:47], a[220:223], v[180:183], v[68:71]
    ds_read2st64_b64 a[152:155], v235 offset0:76 offset1:78
    ds_read2st64_b64 a[156:159], v235 offset0:77 offset1:79
    v_mfma_f32_16x16x32_bf16 v[40:43], a[216:219], v[180:183], v[68:71]
    buffer_load_dwordx4 a[88:91], v252, s[36:39], s58 offen offset:2048 sc1
    buffer_load_dwordx4 a[92:95], v252, s[36:39], s58 offen offset:3072 sc1
    v_cvt_pk_bf16_f32 v59, v38, v39
    v_mfma_f32_16x16x32_bf16 v[36:39], a[220:223], v[176:179], v[64:67]
    s_add_u32 s58, s58, 0xc000
    v_exp_f32 v46, v46
    v_exp_f32 v45, v45
    v_mul_f32 v104, v104, v31
    v_exp_f32 v44, v44
    v_mfma_f32_16x16x32_bf16 v[32:35], a[216:219], v[176:179], v[64:67]
    v_exp_f32 v41, v41
    v_exp_f32 v47, v47
    v_cvt_pk_bf16_f32 v62, v44, v45
    v_mfma_f32_16x16x32_bf16 v[120:123], v[0:3], v[56:59], v[120:123]
    s_waitcnt lgkmcnt(5)
    v_exp_f32 v43, v43
    v_exp_f32 v42, v42
    v_mfma_f32_16x16x32_bf16 v[96:99], a[160:163], v[56:59], v[96:99]
    s_waitcnt lgkmcnt(4)
    v_cvt_pk_bf16_f32 v61, v42, v43
    v_exp_f32 v40, v40
    v_mfma_f32_16x16x32_bf16 v[100:103], a[164:167], v[56:59], v[100:103]
    v_cvt_pk_bf16_f32 v60, v40, v41
    v_cvt_pk_bf16_f32 v63, v46, v47
    v_mfma_f32_16x16x32_bf16 a[224:227], a[4:7], v[144:147], 0
    buffer_load_dwordx4 a[96:99], v252, s[36:39], s58 offen offset:0 sc1
    buffer_load_dwordx4 a[100:103], v252, s[36:39], s58 offen offset:1024 sc1
    v_exp_f32 v33, v33
    v_cndmask_b32 v41, v12, v72, s[18:19]
    v_mfma_f32_16x16x32_bf16 v[88:91], a[160:163], v[60:63], v[88:91]
    v_exp_f32 v38, v38
    v_cndmask_b32 v40, v12, v72, s[16:17]
    v_mfma_f32_16x16x32_bf16 v[44:47], a[212:215], v[184:187], v[72:75]
    v_exp_f32 v36, v36
    v_exp_f32 v32, v32
    v_exp_f32 v37, v37
    v_cndmask_b32 v42, v12, v72, s[22:23]
    v_cndmask_b32 v43, v12, v72, s[24:25]
    v_exp_f32 v39, v39
    v_mfma_f32_16x16x32_bf16 v[92:95], a[164:167], v[60:63], v[92:95]
    v_cvt_pk_bf16_f32 v58, v36, v37
    v_cvt_pk_bf16_f32 v59, v38, v39
    v_mfma_f32_16x16x32_bf16 a[228:231], a[4:7], v[148:151], 0
    buffer_load_dwordx4 a[104:107], v252, s[36:39], s58 offen offset:2048 sc1
    buffer_load_dwordx4 a[108:111], v252, s[36:39], s58 offen offset:3072 sc1
    v_mfma_f32_16x16x32_bf16 v[40:43], a[208:211], v[184:187], v[40:43]
    v_exp_f32 v34, v34
    v_exp_f32 v47, v47
    v_cvt_pk_bf16_f32 v56, v32, v33
    v_mfma_f32_16x16x32_bf16 v[116:119], v[0:3], v[60:63], v[116:119]
    s_add_u32 s58, s58, 0x4000
    v_exp_f32 v46, v46
    v_exp_f32 v44, v44
    v_mfma_f32_16x16x32_bf16 v[36:39], a[212:215], v[180:183], v[68:71]
    v_exp_f32 v35, v35
    v_exp_f32 v41, v41
    v_cvt_pk_bf16_f32 v57, v34, v35
    v_mfma_f32_16x16x32_bf16 v[32:35], a[208:211], v[180:183], v[68:71]
    v_exp_f32 v45, v45
    v_exp_f32 v40, v40
    v_mfma_f32_16x16x32_bf16 v[80:83], a[160:163], v[56:59], v[80:83]
    v_exp_f32 v42, v42
    v_exp_f32 v43, v43
    v_mfma_f32_16x16x32_bf16 v[84:87], a[164:167], v[56:59], v[84:87]
    v_cvt_pk_bf16_f32 v60, v40, v41
    v_exp_f32 v36, v36
    v_cvt_pk_bf16_f32 v62, v44, v45
    v_mfma_f32_16x16x32_bf16 a[232:235], a[4:7], v[152:155], 0
    ds_read2st64_b64 a[160:163], v235 offset0:72 offset1:74
    ds_read2st64_b64 a[164:167], v235 offset0:73 offset1:75
    v_cvt_pk_bf16_f32 v63, v46, v47
    v_exp_f32 v32, v32
    v_mfma_f32_16x16x32_bf16 v[44:47], a[212:215], v[176:179], v[64:67]
    v_exp_f32 v37, v37
    v_mfma_f32_16x16x32_bf16 a[236:239], a[4:7], v[156:159], 0
    v_exp_f32 v39, v39
    v_cvt_pk_bf16_f32 v61, v42, v43
    v_mfma_f32_16x16x32_bf16 v[40:43], a[208:211], v[176:179], v[64:67]
    ds_read_b64_tr_b16 a[12:13], v223 offset:32768
    ds_read_b64_tr_b16 a[14:15], v223 offset:36864
    v_exp_f32 v38, v38
    v_mfma_f32_16x16x32_bf16 v[112:115], v[0:3], v[56:59], v[112:115]
    s_waitcnt lgkmcnt(7)
    v_exp_f32 v47, v47
    v_exp_f32 v33, v33
    v_cvt_pk_bf16_f32 v58, v36, v37
    v_mfma_f32_16x16x32_bf16 v[96:99], a[144:147], v[60:63], v[96:99]
    s_waitcnt lgkmcnt(6)
    v_exp_f32 v34, v34
    v_mfma_f32_16x16x32_bf16 v[120:123], v[0:3], v[60:63], v[120:123]
    v_exp_f32 v46, v46
    v_mfma_f32_16x16x32_bf16 v[100:103], a[148:151], v[60:63], v[100:103]
    v_exp_f32 v40, v40
    v_cvt_pk_bf16_f32 v59, v38, v39
    v_exp_f32 v35, v35
    v_mfma_f32_16x16x32_bf16 v[36:39], a[204:207], v[180:183], v[68:71]
    v_exp_f32 v45, v45
    v_mfma_f32_16x16x32_bf16 a[232:235], a[8:11], v[136:139], a[232:235]
    v_cvt_pk_bf16_f32 v57, v34, v35
    v_cvt_pk_bf16_f32 v56, v32, v33
    v_mfma_f32_16x16x32_bf16 a[224:227], a[8:11], v[128:131], a[224:227]
    v_rcp_f32 v30, v120
    v_mfma_f32_16x16x32_bf16 v[116:119], v[0:3], v[56:59], v[116:119]
    v_exp_f32 v41, v41
    v_exp_f32 v42, v42
    v_mfma_f32_16x16x32_bf16 v[88:91], a[144:147], v[56:59], v[88:91]
    v_exp_f32 v43, v43
    v_mul_f32 v30, v30, v248
    v_exp_f32 v44, v44
    v_cvt_pk_bf16_f32 v63, v46, v47
    v_mfma_f32_16x16x32_bf16 a[228:231], a[8:11], v[132:135], a[228:231]
    v_mul_f32 v101, v101, v30
    v_exp_f32 v38, v38
    v_mfma_f32_16x16x32_bf16 v[32:35], a[200:203], v[180:183], v[68:71]
    v_mul_f32 v100, v100, v30
    v_mul_f32 v102, v102, v30
    v_cvt_pk_bf16_f32 v61, v42, v43
    v_mul_f32 v98, v98, v30
    v_mfma_f32_16x16x32_bf16 v[92:95], a[148:151], v[56:59], v[92:95]
    v_mul_f32 v99, v99, v30
    v_cvt_pk_bf16_f32 v60, v40, v41
    v_mfma_f32_16x16x32_bf16 a[236:239], a[8:11], v[140:143], a[236:239]
    v_mul_f32 v103, v103, v30
    v_cvt_pk_bf16_f32 v62, v44, v45
    v_mfma_f32_16x16x32_bf16 v[44:47], a[204:207], v[176:179], v[64:67]
    v_exp_f32 v36, v36
    v_exp_f32 v37, v37
    v_mfma_f32_16x16x32_bf16 v[40:43], a[200:203], v[176:179], v[64:67]
    ds_read_b64_tr_b16 a[16:17], v220 offset:40960
    ds_read_b64_tr_b16 a[18:19], v220 offset:45056
    v_exp_f32 v34, v34
    v_exp_f32 v33, v33
    v_mfma_f32_16x16x32_bf16 v[80:83], a[144:147], v[60:63], v[80:83]
    v_exp_f32 v39, v39
    v_mfma_f32_16x16x32_bf16 v[84:87], a[148:151], v[60:63], v[84:87]
    s_waitcnt lgkmcnt(2)
    v_exp_f32 v32, v32
    v_exp_f32 v35, v35
    v_mfma_f32_16x16x32_bf16 v[112:115], v[0:3], v[60:63], v[112:115]
    v_cvt_pk_bf16_f32 v56, v32, v33
    v_cndmask_b32 v33, v12, v68, s[18:19]
    v_mfma_f32_16x16x32_bf16 a[232:235], a[12:15], v[168:171], a[232:235]
    ds_read2st64_b64 a[144:147], v235 offset0:68 offset1:70
    ds_read2st64_b64 a[148:151], v235 offset0:69 offset1:71
    v_cvt_pk_bf16_f32 v57, v34, v35
    v_mfma_f32_16x16x32_bf16 a[236:239], a[12:15], v[172:175], a[236:239]
    v_exp_f32 v45, v45
    v_cndmask_b32 v35, v12, v68, s[24:25]
    v_mfma_f32_16x16x32_bf16 a[228:231], a[12:15], v[164:167], a[228:231]
    v_cvt_pk_bf16_f32 v59, v38, v39
    v_exp_f32 v40, v40
    v_mfma_f32_16x16x32_bf16 a[224:227], a[12:15], v[160:163], a[224:227]
    v_cndmask_b32 v34, v12, v68, s[22:23]
    v_cvt_pk_bf16_f32 v58, v36, v37
    v_mfma_f32_16x16x32_bf16 v[36:39], a[196:199], v[180:183], v[68:71]
    v_cndmask_b32 v32, v12, v68, s[16:17]
    v_exp_f32 v46, v46
    v_exp_f32 v44, v44
    v_mfma_f32_16x16x32_bf16 v[32:35], a[192:195], v[180:183], v[32:35]
    ds_read_b64_tr_b16 a[20:21], v221 offset:40960
    ds_read_b64_tr_b16 a[22:23], v221 offset:45056
    v_mfma_f32_16x16x32_bf16 v[92:95], a[156:159], v[56:59], v[92:95]
    s_add_u32 s92, s85, 0x8000
    v_exp_f32 v43, v43
    v_mfma_f32_16x16x32_bf16 v[116:119], v[0:3], v[56:59], v[116:119]
    v_exp_f32 v42, v42
    v_exp_f32 v47, v47
    v_mfma_f32_16x16x32_bf16 v[88:91], a[152:155], v[56:59], v[88:91]
    s_waitcnt vmcnt(19) lgkmcnt(4)
    v_exp_f32 v41, v41
    v_mfma_f32_16x16x32_bf16 a[112:115], a[16:19], a[32:35], a[112:115]
    v_cvt_pk_bf16_f32 v62, v44, v45
    v_cvt_pk_bf16_f32 v63, v46, v47
    s_waitcnt vmcnt(18)
    v_mfma_f32_16x16x32_bf16 a[116:119], a[16:19], a[36:39], a[116:119]
    buffer_store_dwordx4 v[160:163], v252, s[36:39], s92 offen offset:0 sc1
    v_cvt_pk_bf16_f32 v189, v106, v107
    v_cvt_pk_bf16_f32 v61, v42, v43
    v_cvt_pk_bf16_f32 v188, v104, v105
    v_mfma_f32_16x16x32_bf16 v[44:47], a[196:199], v[176:179], v[64:67]
    buffer_store_dwordx4 v[164:167], v252, s[36:39], s92 offen offset:1024 sc1
    v_exp_f32 v36, v36
    v_exp_f32 v39, v39
    v_exp_f32 v37, v37
    v_cvt_pk_bf16_f32 v60, v40, v41
    v_exp_f32 v34, v34
    v_mfma_f32_16x16x32_bf16 v[40:43], a[192:195], v[176:179], v[64:67]
    s_waitcnt vmcnt(19)
    v_exp_f32 v38, v38
    v_mfma_f32_16x16x32_bf16 a[120:123], a[16:19], a[40:43], a[120:123]
    v_exp_f32 v32, v32
    v_mfma_f32_16x16x32_bf16 v[80:83], a[152:155], v[60:63], v[80:83]
    s_waitcnt vmcnt(18)
    v_exp_f32 v33, v33
    v_mfma_f32_16x16x32_bf16 v[84:87], a[156:159], v[60:63], v[84:87]
    v_cvt_pk_bf16_f32 v58, v36, v37
    v_cvt_pk_bf16_f32 v59, v38, v39
    v_mfma_f32_16x16x32_bf16 v[112:115], v[0:3], v[60:63], v[112:115]
    v_exp_f32 v35, v35
    v_mfma_f32_16x16x32_bf16 a[124:127], a[16:19], a[44:47], a[124:127]
    s_waitcnt lgkmcnt(0)
    ds_read2st64_b64 a[152:155], v235 offset0:64 offset1:66
    v_cvt_pk_bf16_f32 v56, v32, v33
    v_mfma_f32_16x16x32_bf16 a[128:131], a[20:23], a[32:35], a[128:131]
    ds_read2st64_b64 a[156:159], v235 offset0:65 offset1:67
    buffer_store_dwordx4 v[168:171], v252, s[36:39], s92 offen offset:2048 sc1
    v_exp_f32 v44, v44
    v_cvt_pk_bf16_f32 v57, v34, v35
    v_mfma_f32_16x16x32_bf16 v[36:39], a[188:191], v[176:179], v[64:67]
    buffer_store_dwordx4 v[172:175], v252, s[36:39], s92 offen offset:3072 sc1
    v_exp_f32 v45, v45
    v_exp_f32 v41, v41
    v_mfma_f32_16x16x32_bf16 v[32:35], a[184:187], v[176:179], v[64:67]
    ds_read_b64_tr_b16 a[24:25], v222 offset:40960
    ds_read_b64_tr_b16 a[26:27], v222 offset:45056
    v_mfma_f32_16x16x32_bf16 v[116:119], v[0:3], v[56:59], v[116:119]
    v_exp_f32 v40, v40
    v_mfma_f32_16x16x32_bf16 v[92:95], a[164:167], v[56:59], v[92:95]
    v_exp_f32 v42, v42
    v_cvt_pk_bf16_f32 v62, v44, v45
    v_mfma_f32_16x16x32_bf16 a[132:135], a[20:23], a[36:39], a[132:135]
    buffer_store_dwordx4 v[192:195], v236, s[36:39], s86 offen offset:0 sc1
    v_exp_f32 v43, v43
    v_cvt_pk_bf16_f32 v60, v40, v41
    v_exp_f32 v47, v47
    v_cvt_pk_bf16_f32 v61, v42, v43
    v_cndmask_b32 v40, v12, v64, s[16:17]
    v_mfma_f32_16x16x32_bf16 a[140:143], a[20:23], a[44:47], a[140:143]
    buffer_store_dwordx4 v[200:203], v236, s[36:39], s86 offen offset:2048 sc1
    v_exp_f32 v46, v46
    v_cndmask_b32 v42, v12, v64, s[22:23]
    v_cndmask_b32 v41, v12, v64, s[18:19]
    v_cvt_pk_bf16_f32 v63, v46, v47
    v_mfma_f32_16x16x32_bf16 v[44:47], a[180:183], v[176:179], v[64:67]
    v_cndmask_b32 v43, v12, v64, s[24:25]
    v_exp_f32 v39, v39
    v_exp_f32 v36, v36
    v_mfma_f32_16x16x32_bf16 v[88:91], a[160:163], v[56:59], v[88:91]
    v_exp_f32 v32, v32
    v_exp_f32 v38, v38
    v_mfma_f32_16x16x32_bf16 a[136:139], a[20:23], a[40:43], a[136:139]
    s_waitcnt lgkmcnt(0)
    v_exp_f32 v37, v37
    v_exp_f32 v33, v33
    v_cvt_pk_bf16_f32 v58, v36, v37
    v_mfma_f32_16x16x32_bf16 v[40:43], a[176:179], v[176:179], v[40:43]
    ds_read_b64_tr_b16 a[28:29], v223 offset:40960
    ds_read_b64_tr_b16 a[30:31], v223 offset:45056
    v_rcp_f32 v29, v116
    v_mfma_f32_16x16x32_bf16 v[80:83], a[160:163], v[60:63], v[80:83]
    v_exp_f32 v34, v34
    v_mfma_f32_16x16x32_bf16 v[112:115], v[0:3], v[60:63], v[112:115]
    v_exp_f32 v35, v35
    v_mul_f32 v29, v29, v246
    v_mul_f32 v88, v88, v29
    v_cvt_pk_bf16_f32 v59, v38, v39
    v_cvt_pk_bf16_f32 v57, v34, v35
    v_mfma_f32_16x16x32_bf16 a[244:247], a[24:27], a[36:39], a[244:247]
    v_mul_f32 v94, v94, v29
    v_exp_f32 v45, v45
    v_mul_f32 v92, v92, v29
    v_mul_f32 v93, v93, v29
    v_cvt_pk_bf16_f32 v56, v32, v33
    v_mul_f32 v95, v95, v29
    v_cvt_pk_bf16_f32 v183, v94, v95
    v_mfma_f32_16x16x32_bf16 v[80:83], a[144:147], v[56:59], v[80:83]
    ds_read_b64_tr_b16 a[0:1], v216 offset:16384
    ds_read_b64_tr_b16 a[2:3], v216 offset:20480
    v_exp_f32 v47, v47
    v_mul_f32 v89, v89, v29
    v_mul_f32 v91, v91, v29
    v_exp_f32 v46, v46
    v_mfma_f32_16x16x32_bf16 a[248:251], a[24:27], a[40:43], a[248:251]
    ds_read_b64_tr_b16 a[4:5], v216 offset:24576
    ds_read_b64_tr_b16 a[6:7], v216 offset:28672
    v_mfma_f32_16x16x32_bf16 v[84:87], a[164:167], v[60:63], v[84:87]
    v_exp_f32 v40, v40
    v_mfma_f32_16x16x32_bf16 a[240:243], a[24:27], a[32:35], a[240:243]
    v_exp_f32 v44, v44
    v_mfma_f32_16x16x32_bf16 v[84:87], a[148:151], v[56:59], v[84:87]
    ds_read_b64_tr_b16 a[8:9], v217 offset:16384
    ds_read_b64_tr_b16 a[10:11], v217 offset:20480
    v_cvt_pk_bf16_f32 v63, v46, v47
    v_exp_f32 v41, v41
    v_cvt_pk_bf16_f32 v182, v92, v93
    v_cvt_pk_bf16_f32 v62, v44, v45
    v_mul_f32 v90, v90, v29
    v_mfma_f32_16x16x32_bf16 v[112:115], v[0:3], v[56:59], v[112:115]
    ds_read_b64_tr_b16 a[12:13], v217 offset:24576
    ds_read_b64_tr_b16 a[14:15], v217 offset:28672
    v_mfma_f32_16x16x32_bf16 a[252:255], a[24:27], a[44:47], a[252:255]
    s_waitcnt lgkmcnt(8)
    v_exp_f32 v42, v42
    v_mfma_f32_16x16x32_bf16 a[236:239], a[28:31], a[44:47], a[236:239]
    v_exp_f32 v43, v43
    v_mfma_f32_16x16x32_bf16 a[232:235], a[28:31], a[40:43], a[232:235]
    v_cvt_pk_bf16_f32 v60, v40, v41
    v_cvt_pk_bf16_f32 v61, v42, v43
    v_mfma_f32_16x16x32_bf16 a[224:227], a[28:31], a[32:35], a[224:227]
    v_cvt_pk_bf16_f32 v185, v98, v99
    v_mul_f32 v96, v96, v30
    v_mfma_f32_16x16x32_bf16 a[228:231], a[28:31], a[36:39], a[228:231]
    v_cvt_pk_bf16_f32 v187, v102, v103
    v_cvt_pk_bf16_f32 v186, v100, v101
    v_mfma_f32_16x16x32_bf16 v[112:115], v[0:3], v[60:63], v[112:115]
    v_mul_f32 v97, v97, v30
    v_cvt_pk_bf16_f32 v180, v88, v89
    v_mfma_f32_16x16x32_bf16 v[84:87], a[156:159], v[60:63], v[84:87]
    v_cvt_pk_bf16_f32 v181, v90, v91
    v_cvt_pk_bf16_f32 v184, v96, v97
    v_mfma_f32_16x16x32_bf16 v[80:83], a[152:155], v[60:63], v[80:83]
L_att_join:
    s_waitcnt lgkmcnt(6)
    ds_read_b64_tr_b16 a[16:17], v218 offset:16384
    ds_read_b64_tr_b16 a[18:19], v218 offset:20480
    v_mfma_f32_16x16x32_bf16 v[0:3], a[0:3], v[144:147], 0
    s_waitcnt lgkmcnt(6)
    ds_read_b64_tr_b16 a[20:21], v218 offset:24576
    ds_read_b64_tr_b16 a[22:23], v218 offset:28672
    v_mfma_f32_16x16x32_bf16 v[0:3], a[4:7], v[128:131], v[0:3]
    ds_read_b64_tr_b16 a[24:25], v219 offset:16384
    ds_read_b64_tr_b16 a[26:27], v219 offset:20480
    v_mfma_f32_16x16x32_bf16 v[4:7], a[0:3], v[148:151], 0
    s_barrier
    buffer_store_dwordx4 v[188:191], v252, s[36:39], s57 offen offset:3072 sc1
    v_mfma_f32_16x16x32_bf16 v[4:7], a[4:7], v[132:135], v[4:7]
    ds_read_b64_tr_b16 a[180:181], v216 offset:40960
    ds_read_b64_tr_b16 a[182:183], v216 offset:45056
    v_mfma_f32_16x16x32_bf16 v[8:11], a[0:3], v[152:155], 0
    v_rcp_f32 v243, v112
    s_nop 0
    v_mul_f32 v243, v243, v244
    v_mfma_f32_16x16x32_bf16 v[8:11], a[4:7], v[136:139], v[8:11]
    v_mul_f32 v80, v80, v243
    v_mul_f32 v81, v81, v243
    v_mfma_f32_16x16x32_bf16 v[12:15], a[0:3], v[156:159], 0
    buffer_store_dwordx4 v[184:187], v252, s[36:39], s57 offen offset:2048 sc1
    v_mul_f32 v82, v82, v243
    v_mul_f32 v83, v83, v243
    v_mul_f32 v84, v84, v243
    v_mfma_f32_16x16x32_bf16 v[12:15], a[4:7], v[140:143], v[12:15]
    s_waitcnt lgkmcnt(10)
    ds_read_b64_tr_b16 a[0:1], v217 offset:32768
    ds_read_b64_tr_b16 a[2:3], v217 offset:36864
    v_mfma_f32_16x16x32_bf16 v[28:31], a[8:11], v[156:159], 0
    s_waitcnt lgkmcnt(10)
    ds_read_b64_tr_b16 a[28:29], v219 offset:24576
    ds_read_b64_tr_b16 a[30:31], v219 offset:28672
    v_mfma_f32_16x16x32_bf16 v[28:31], a[12:15], v[140:143], v[28:31]
    v_mul_f32 v85, v85, v243
    v_mul_f32 v86, v86, v243
    v_mfma_f32_16x16x32_bf16 v[24:27], a[8:11], v[152:155], 0
    buffer_store_dwordx4 v[180:183], v252, s[36:39], s57 offen offset:1024 sc1
    v_mul_f32 v87, v87, v243
    v_cvt_pk_bf16_f32 v176, v80, v81
    v_cvt_pk_bf16_f32 v177, v82, v83
    v_mfma_f32_16x16x32_bf16 v[24:27], a[12:15], v[136:139], v[24:27]
    ds_read_b64_tr_b16 a[4:5], v217 offset:40960
    ds_read_b64_tr_b16 a[6:7], v217 offset:45056
    v_mfma_f32_16x16x32_bf16 v[20:23], a[8:11], v[148:151], 0
    ds_read_b64_tr_b16 a[176:177], v216 offset:32768
    ds_read_b64_tr_b16 a[178:179], v216 offset:36864
    v_mfma_f32_16x16x32_bf16 v[20:23], a[12:15], v[132:135], v[20:23]
    v_cvt_pk_bf16_f32 v178, v84, v85
    v_cvt_pk_bf16_f32 v179, v86, v87
    v_mfma_f32_16x16x32_bf16 v[16:19], a[8:11], v[144:147], 0
    buffer_store_dwordx4 v[176:179], v252, s[36:39], s57 offen offset:0 sc1
    s_add_u32 m0, s61, 0x22000
    v_mfma_f32_16x16x32_bf16 v[16:19], a[12:15], v[128:131], v[16:19]
    s_waitcnt lgkmcnt(14)
    ds_read_b64_tr_b16 a[8:9], v218 offset:32768
    ds_read_b64_tr_b16 a[10:11], v218 offset:36864
    v_mfma_f32_16x16x32_bf16 v[32:35], a[16:19], v[144:147], 0
    s_waitcnt lgkmcnt(14)
    v_accvgpr_read_b32 v64, a112
    v_accvgpr_read_b32 v65, a113
    v_mfma_f32_16x16x32_bf16 v[32:35], a[20:23], v[128:131], v[32:35]
    v_accvgpr_read_b32 v66, a114
    v_accvgpr_read_b32 v67, a115
    v_mfma_f32_16x16x32_bf16 v[36:39], a[16:19], v[148:151], 0
    v_accvgpr_read_b32 v68, a116
    v_accvgpr_read_b32 v69, a117
    v_mfma_f32_16x16x32_bf16 v[36:39], a[20:23], v[132:135], v[36:39]
    ds_read_b64_tr_b16 a[12:13], v218 offset:40960
    ds_read_b64_tr_b16 a[14:15], v218 offset:45056
    v_mfma_f32_16x16x32_bf16 v[40:43], a[16:19], v[152:155], 0
    buffer_load_dword v214, v215, s[96:99], 0 offen sc1
    v_mfma_f32_16x16x32_bf16 v[40:43], a[20:23], v[136:139], v[40:43]
    buffer_load_dwordx4 v232, s[40:43], s59 offen lds
    v_mfma_f32_16x16x32_bf16 v[44:47], a[16:19], v[156:159], 0
    v_accvgpr_read_b32 v70, a118
    v_accvgpr_read_b32 v71, a119
    v_mfma_f32_16x16x32_bf16 v[44:47], a[20:23], v[140:143], v[44:47]
    s_waitcnt lgkmcnt(14)
    ds_read_b64_tr_b16 a[16:17], v219 offset:32768
    ds_read_b64_tr_b16 a[18:19], v219 offset:36864
    v_mfma_f32_16x16x32_bf16 v[60:63], a[24:27], v[156:159], 0
    s_waitcnt lgkmcnt(10)
    v_accvgpr_read_b32 v72, a120
    v_accvgpr_read_b32 v73, a121
    v_mfma_f32_16x16x32_bf16 v[60:63], a[28:31], v[140:143], v[60:63]
    buffer_load_dwordx4 v233, s[40:43], s59 offen offset:1024 lds
    s_add_u32 m0, s61, 0x24000
    v_mfma_f32_16x16x32_bf16 v[56:59], a[24:27], v[152:155], 0
    s_add_u32 s59, s59, 0x10000
    v_accvgpr_read_b32 v74, a122
    v_accvgpr_read_b32 v75, a123
    v_mfma_f32_16x16x32_bf16 v[56:59], a[28:31], v[136:139], v[56:59]
    ds_read_b64_tr_b16 a[20:21], v219 offset:40960
    ds_read_b64_tr_b16 a[22:23], v219 offset:45056
    v_mfma_f32_16x16x32_bf16 v[52:55], a[24:27], v[148:151], 0
    v_accvgpr_read_b32 v76, a124
    v_accvgpr_read_b32 v77, a125
    v_mfma_f32_16x16x32_bf16 v[52:55], a[28:31], v[132:135], v[52:55]
    buffer_load_dwordx4 v232, s[40:43], s59 offen lds
    v_mfma_f32_16x16x32_bf16 v[48:51], a[24:27], v[144:147], 0
    v_accvgpr_read_b32 v78, a126
    v_accvgpr_read_b32 v79, a127
    v_mfma_f32_16x16x32_bf16 v[48:51], a[28:31], v[128:131], v[48:51]
    s_waitcnt lgkmcnt(8)
    ds_read_b64_tr_b16 a[24:25], v216 offset:49152
    ds_read_b64_tr_b16 a[26:27], v216 offset:53248
    v_mfma_f32_16x16x32_bf16 v[0:3], a[176:179], v[160:163], v[0:3]
    v_accvgpr_read_b32 v80, a128
    v_accvgpr_read_b32 v81, a129
    v_mfma_f32_16x16x32_bf16 v[0:3], a[180:183], a[32:35], v[0:3]
    buffer_load_dwordx4 v233, s[40:43], s59 offen offset:1024 lds
    s_add_u32 m0, s61, 0x26000
    v_mfma_f32_16x16x32_bf16 v[4:7], a[176:179], v[164:167], v[4:7]
    s_add_u32 s59, s59, 0x30000
    v_accvgpr_read_b32 v82, a130
    v_accvgpr_read_b32 v83, a131
    v_mfma_f32_16x16x32_bf16 v[4:7], a[180:183], a[36:39], v[4:7]
    ds_read_b64_tr_b16 a[28:29], v216 offset:57344
    ds_read_b64_tr_b16 a[30:31], v216 offset:61440
    v_mfma_f32_16x16x32_bf16 v[8:11], a[176:179], v[168:171], v[8:11]
    v_accvgpr_read_b32 v84, a132
    v_accvgpr_read_b32 v85, a133
    v_mfma_f32_16x16x32_bf16 v[8:11], a[180:183], a[40:43], v[8:11]
    buffer_load_dwordx4 a[112:115], v252, s[36:39], s58 offen offset:0 sc1
    v_mfma_f32_16x16x32_bf16 v[12:15], a[176:179], v[172:175], v[12:15]
    v_accvgpr_read_b32 v86, a134
    v_accvgpr_read_b32 v87, a135
    v_mfma_f32_16x16x32_bf16 v[12:15], a[180:183], a[44:47], v[12:15]
    ds_read_b64_tr_b16 a[176:177], v217 offset:49152
    ds_read_b64_tr_b16 a[178:179], v217 offset:53248
    v_mfma_f32_16x16x32_bf16 v[28:31], a[0:3], v[172:175], v[28:31]
    v_accvgpr_read_b32 v88, a136
    v_accvgpr_read_b32 v89, a137
    v_mfma_f32_16x16x32_bf16 v[28:31], a[4:7], a[44:47], v[28:31]
    buffer_load_dwordx4 a[116:119], v252, s[36:39], s58 offen offset:1024 sc1
    v_mfma_f32_16x16x32_bf16 v[24:27], a[0:3], v[168:171], v[24:27]
    v_accvgpr_read_b32 v90, a138
    v_accvgpr_read_b32 v91, a139
    v_mfma_f32_16x16x32_bf16 v[24:27], a[4:7], a[40:43], v[24:27]
    ds_read_b64_tr_b16 a[180:181], v217 offset:57344
    ds_read_b64_tr_b16 a[182:183], v217 offset:61440
    v_mfma_f32_16x16x32_bf16 v[20:23], a[0:3], v[164:167], v[20:23]
    v_accvgpr_read_b32 v92, a140
    v_accvgpr_read_b32 v93, a141
    v_mfma_f32_16x16x32_bf16 v[20:23], a[4:7], a[36:39], v[20:23]
    buffer_load_dwordx4 a[120:123], v252, s[36:39], s58 offen offset:2048 sc1
    v_mfma_f32_16x16x32_bf16 v[16:19], a[0:3], v[160:163], v[16:19]
    v_accvgpr_read_b32 v94, a142
    v_accvgpr_read_b32 v95, a143
    v_mfma_f32_16x16x32_bf16 v[16:19], a[4:7], a[32:35], v[16:19]
    s_waitcnt lgkmcnt(14)
    ds_read_b64_tr_b16 a[0:1], v218 offset:49152
    ds_read_b64_tr_b16 a[2:3], v218 offset:53248
    v_mfma_f32_16x16x32_bf16 v[32:35], a[8:11], v[160:163], v[32:35]
    s_waitcnt lgkmcnt(14)
    v_accvgpr_read_b32 v96, a240
    v_accvgpr_read_b32 v97, a241
    v_mfma_f32_16x16x32_bf16 v[32:35], a[12:15], a[32:35], v[32:35]
    buffer_load_dwordx4 a[124:127], v252, s[36:39], s58 offen offset:3072 sc1
    s_add_u32 s58, s58, 0x8000
    v_mfma_f32_16x16x32_bf16 v[36:39], a[8:11], v[164:167], v[36:39]
    v_accvgpr_read_b32 v98, a242
    v_accvgpr_read_b32 v99, a243
    v_mfma_f32_16x16x32_bf16 v[36:39], a[12:15], a[36:39], v[36:39]
    ds_read_b64_tr_b16 a[4:5], v218 offset:57344
    ds_read_b64_tr_b16 a[6:7], v218 offset:61440
    v_mfma_f32_16x16x32_bf16 v[40:43], a[8:11], v[168:171], v[40:43]
    v_accvgpr_read_b32 v100, a244
    v_accvgpr_read_b32 v101, a245
    v_mfma_f32_16x16x32_bf16 v[40:43], a[12:15], a[40:43], v[40:43]
    s_sub_u32 s3, s58, 0x70000
    s_cmp_ge_u32 s58, s55
    s_cselect_b32 s58, s3, s58
    buffer_load_dwordx4 a[128:131], v252, s[36:39], s58 offen offset:0 sc1
    v_mfma_f32_16x16x32_bf16 v[44:47], a[8:11], v[172:175], v[44:47]
    v_accvgpr_read_b32 v102, a246
    v_accvgpr_read_b32 v103, a247
    v_mfma_f32_16x16x32_bf16 v[44:47], a[12:15], a[44:47], v[44:47]
    s_waitcnt lgkmcnt(14)
    ds_read_b64_tr_b16 a[8:9], v219 offset:49152
    ds_read_b64_tr_b16 a[10:11], v219 offset:53248
    v_mfma_f32_16x16x32_bf16 v[60:63], a[16:19], v[172:175], v[60:63]
    s_waitcnt lgkmcnt(14)
    v_accvgpr_read_b32 v104, a248
    v_accvgpr_read_b32 v105, a249
    v_mfma_f32_16x16x32_bf16 v[60:63], a[20:23], a[44:47], v[60:63]
    buffer_load_dwordx4 a[132:135], v252, s[36:39], s58 offen offset:1024 sc1
    v_mfma_f32_16x16x32_bf16 v[56:59], a[16:19], v[168:171], v[56:59]
    v_accvgpr_read_b32 v106, a250
    v_accvgpr_read_b32 v107, a251
    v_mfma_f32_16x16x32_bf16 v[56:59], a[20:23], a[40:43], v[56:59]
    ds_read_b64_tr_b16 a[12:13], v219 offset:57344
    ds_read_b64_tr_b16 a[14:15], v219 offset:61440
    v_mfma_f32_16x16x32_bf16 v[52:55], a[16:19], v[164:167], v[52:55]
    v_accvgpr_read_b32 v108, a252
    v_accvgpr_read_b32 v109, a253
    v_mfma_f32_16x16x32_bf16 v[52:55], a[20:23], a[36:39], v[52:55]
    buffer_load_dwordx4 a[136:139], v252, s[36:39], s58 offen offset:2048 sc1
    v_mfma_f32_16x16x32_bf16 v[48:51], a[16:19], v[160:163], v[48:51]
    v_accvgpr_read_b32 v110, a254
    v_accvgpr_read_b32 v111, a255
    v_mfma_f32_16x16x32_bf16 v[48:51], a[20:23], a[32:35], v[48:51]
    s_waitcnt vmcnt(37) lgkmcnt(14)
    ds_read_b64_tr_b16 a[16:17], v220 offset:49152
    ds_read_b64_tr_b16 a[18:19], v220 offset:53248
    v_mfma_f32_16x16x32_bf16 v[0:3], a[24:27], a[48:51], v[0:3]
    s_waitcnt vmcnt(33) lgkmcnt(14)
    v_accvgpr_read_b32 v112, a224
    v_accvgpr_read_b32 v113, a225
    v_mfma_f32_16x16x32_bf16 v[0:3], a[28:31], a[64:67], v[0:3]
    buffer_load_dwordx4 a[140:143], v252, s[36:39], s58 offen offset:3072 sc1
    s_add_u32 s58, s58, 0x4000
    v_mfma_f32_16x16x32_bf16 v[4:7], a[24:27], a[52:55], v[4:7]
    s_waitcnt vmcnt(33)
    s_waitcnt vmcnt(13)
    s_barrier
    s_cmp_eq_u32 s50, 0
    s_cbranch_scc0 L_nf_o
    v_mov_b32 v255, s88
    s_mov_b64 exec, 1
    buffer_store_dword v255, v252, s[44:47], s15 offen offset:8 sc1
    s_mov_b64 exec, -1
L_nf_o:
    v_mfma_f32_16x16x32_bf16 v[4:7], a[28:31], a[68:71], v[4:7]
    ds_read_b64_tr_b16 a[20:21], v220 offset:57344
    ds_read_b64_tr_b16 a[22:23], v220 offset:61440
    v_mfma_f32_16x16x32_bf16 v[8:11], a[24:27], a[56:59], v[8:11]
    v_accvgpr_read_b32 v114, a226
    v_accvgpr_read_b32 v115, a227
    v_mfma_f32_16x16x32_bf16 v[8:11], a[28:31], a[72:75], v[8:11]
    buffer_load_dwordx4 a[144:147], v252, s[36:39], s58 offen offset:0 sc1
    v_mfma_f32_16x16x32_bf16 v[12:15], a[24:27], a[60:63], v[12:15]
    v_accvgpr_read_b32 v116, a228
    v_accvgpr_read_b32 v117, a229
    v_mfma_f32_16x16x32_bf16 v[12:15], a[28:31], a[76:79], v[12:15]
    s_waitcnt lgkmcnt(14)
    ds_read_b64_tr_b16 a[24:25], v221 offset:49152
    ds_read_b64_tr_b16 a[26:27], v221 offset:53248
    v_mfma_f32_16x16x32_bf16 v[28:31], a[176:179], a[60:63], v[28:31]
    s_waitcnt lgkmcnt(14)
    v_accvgpr_read_b32 v118, a230
    v_accvgpr_read_b32 v119, a231
    v_mfma_f32_16x16x32_bf16 v[28:31], a[180:183], a[76:79], v[28:31]
    buffer_load_dwordx4 a[148:151], v252, s[36:39], s58 offen offset:1024 sc1
    v_mfma_f32_16x16x32_bf16 v[24:27], a[176:179], a[56:59], v[24:27]
    v_accvgpr_read_b32 v120, a232
    v_accvgpr_read_b32 v121, a233
    v_mfma_f32_16x16x32_bf16 v[24:27], a[180:183], a[72:75], v[24:27]
    ds_read_b64_tr_b16 a[28:29], v221 offset:57344
    ds_read_b64_tr_b16 a[30:31], v221 offset:61440
    v_mfma_f32_16x16x32_bf16 v[20:23], a[176:179], a[52:55], v[20:23]
    v_accvgpr_read_b32 v122, a234
    v_accvgpr_read_b32 v123, a235
    v_mfma_f32_16x16x32_bf16 v[20:23], a[180:183], a[68:71], v[20:23]
    buffer_load_dwordx4 a[152:155], v252, s[36:39], s58 offen offset:2048 sc1
    v_mfma_f32_16x16x32_bf16 v[16:19], a[176:179], a[48:51], v[16:19]
    v_accvgpr_read_b32 v124, a236
    v_accvgpr_read_b32 v125, a237
    v_mfma_f32_16x16x32_bf16 v[16:19], a[180:183], a[64:67], v[16:19]
    s_waitcnt lgkmcnt(14)
    ds_read_b64_tr_b16 a[176:177], v222 offset:49152
    ds_read_b64_tr_b16 a[178:179], v222 offset:53248
    v_mfma_f32_16x16x32_bf16 v[32:35], a[0:3], a[48:51], v[32:35]
    s_waitcnt lgkmcnt(14)
    v_accvgpr_read_b32 v126, a238
    v_accvgpr_read_b32 v127, a239
    v_mfma_f32_16x16x32_bf16 v[32:35], a[4:7], a[64:67], v[32:35]
    buffer_load_dwordx4 a[156:159], v252, s[36:39], s58 offen offset:3072 sc1
    s_add_u32 s58, s58, 0xc000
    v_mfma_f32_16x16x32_bf16 v[36:39], a[0:3], a[52:55], v[36:39]
    v_mfma_f32_16x16x32_bf16 v[36:39], a[4:7], a[68:71], v[36:39]
    ds_read_b64_tr_b16 a[180:181], v222 offset:57344
    ds_read_b64_tr_b16 a[182:183], v222 offset:61440
    v_mfma_f32_16x16x32_bf16 v[40:43], a[0:3], a[56:59], v[40:43]
    v_mfma_f32_16x16x32_bf16 v[40:43], a[4:7], a[72:75], v[40:43]
    buffer_load_dwordx4 v232, s[40:43], s59 offen lds
    v_mfma_f32_16x16x32_bf16 v[44:47], a[0:3], a[60:63], v[44:47]
    v_mfma_f32_16x16x32_bf16 v[44:47], a[4:7], a[76:79], v[44:47]
    s_waitcnt lgkmcnt(14)
    ds_read_b64_tr_b16 a[0:1], v223 offset:49152
    ds_read_b64_tr_b16 a[2:3], v223 offset:53248
    v_mfma_f32_16x16x32_bf16 v[60:63], a[8:11], a[60:63], v[60:63]
    s_waitcnt lgkmcnt(14)
    v_mfma_f32_16x16x32_bf16 v[60:63], a[12:15], a[76:79], v[60:63]
    buffer_load_dwordx4 v233, s[40:43], s59 offen offset:1024 lds
    s_add_u32 m0, s61, 0xc000
    v_mfma_f32_16x16x32_bf16 v[56:59], a[8:11], a[56:59], v[56:59]
    s_add_u32 s59, s59, 0x10000
    v_mfma_f32_16x16x32_bf16 v[56:59], a[12:15], a[72:75], v[56:59]
    ds_read_b64_tr_b16 a[4:5], v223 offset:57344
    ds_read_b64_tr_b16 a[6:7], v223 offset:61440
    v_mfma_f32_16x16x32_bf16 v[52:55], a[8:11], a[52:55], v[52:55]
    v_mfma_f32_16x16x32_bf16 v[52:55], a[12:15], a[68:71], v[52:55]
    buffer_load_dwordx4 a[160:163], v252, s[36:39], s58 offen offset:0 sc1
    v_mfma_f32_16x16x32_bf16 v[48:51], a[8:11], a[48:51], v[48:51]
    v_mfma_f32_16x16x32_bf16 v[48:51], a[12:15], a[64:67], v[48:51]
    s_waitcnt lgkmcnt(14)
    ds_read_b64_tr_b16 a[8:9], v224 offset:0
    ds_read_b64_tr_b16 a[10:11], v224 offset:4096
    v_mfma_f32_16x16x32_bf16 v[64:67], a[16:19], a[48:51], v[64:67]
    s_waitcnt lgkmcnt(14)
    v_mfma_f32_16x16x32_bf16 v[64:67], a[20:23], a[64:67], v[64:67]
    buffer_load_dwordx4 a[164:167], v252, s[36:39], s58 offen offset:1024 sc1
    v_mfma_f32_16x16x32_bf16 v[68:71], a[16:19], a[52:55], v[68:71]
    v_mfma_f32_16x16x32_bf16 v[68:71], a[20:23], a[68:71], v[68:71]
    ds_read_b64_tr_b16 a[12:13], v224 offset:8192
    ds_read_b64_tr_b16 a[14:15], v224 offset:12288
    v_mfma_f32_16x16x32_bf16 v[72:75], a[16:19], a[56:59], v[72:75]
    v_mov_b32 v244, v245
    v_mfma_f32_16x16x32_bf16 v[72:75], a[20:23], a[72:75], v[72:75]
    buffer_load_dwordx4 a[168:171], v252, s[36:39], s58 offen offset:2048 sc1
    v_mfma_f32_16x16x32_bf16 v[76:79], a[16:19], a[60:63], v[76:79]
    v_mfma_f32_16x16x32_bf16 v[76:79], a[20:23], a[76:79], v[76:79]
    s_waitcnt lgkmcnt(14)
    ds_read_b64_tr_b16 a[16:17], v225 offset:0
    ds_read_b64_tr_b16 a[18:19], v225 offset:4096
    v_mfma_f32_16x16x32_bf16 v[92:95], a[24:27], a[60:63], v[92:95]
    s_waitcnt lgkmcnt(14)
    v_mov_b32 v246, v247
    v_mfma_f32_16x16x32_bf16 v[92:95], a[28:31], a[76:79], v[92:95]
    buffer_load_dwordx4 a[172:175], v252, s[36:39], s58 offen offset:3072 sc1
    s_add_u32 s58, s58, 0x4000
    v_mfma_f32_16x16x32_bf16 v[88:91], a[24:27], a[56:59], v[88:91]
    v_mfma_f32_16x16x32_bf16 v[88:91], a[28:31], a[72:75], v[88:91]
    ds_read_b64_tr_b16 a[20:21], v225 offset:8192
    ds_read_b64_tr_b16 a[22:23], v225 offset:12288
    v_mfma_f32_16x16x32_bf16 v[84:87], a[24:27], a[52:55], v[84:87]
    v_mov_b32 v248, v249
    v_mfma_f32_16x16x32_bf16 v[84:87], a[28:31], a[68:71], v[84:87]
    buffer_load_dwordx4 v232, s[40:43], s59 offen lds
    v_mfma_f32_16x16x32_bf16 v[80:83], a[24:27], a[48:51], v[80:83]
    v_mfma_f32_16x16x32_bf16 v[80:83], a[28:31], a[64:67], v[80:83]
    s_waitcnt lgkmcnt(14)
    ds_read_b64_tr_b16 a[24:25], v226 offset:0
    ds_read_b64_tr_b16 a[26:27], v226 offset:4096
    v_mfma_f32_16x16x32_bf16 v[96:99], a[176:179], a[48:51], v[96:99]
    s_waitcnt lgkmcnt(14)
    v_mov_b32 v250, v251
    v_mfma_f32_16x16x32_bf16 v[96:99], a[180:183], a[64:67], v[96:99]
    buffer_load_dwordx4 v233, s[40:43], s59 offen offset:1024 lds
    s_add_u32 m0, s61, 0xe000
    v_mfma_f32_16x16x32_bf16 v[100:103], a[176:179], a[52:55], v[100:103]
    s_add_u32 s59, s59, 0x20000
    v_mfma_f32_16x16x32_bf16 v[100:103], a[180:183], a[68:71], v[100:103]
    ds_read_b64_tr_b16 a[28:29], v226 offset:8192
    ds_read_b64_tr_b16 a[30:31], v226 offset:12288
    v_mfma_f32_16x16x32_bf16 v[104:107], a[176:179], a[56:59], v[104:107]
    s_sub_u32 s3, s59, 0x1c0000
    s_cmp_ge_u32 s59, s66
    s_cselect_b32 s59, s3, s59
    v_mfma_f32_16x16x32_bf16 v[104:107], a[180:183], a[72:75], v[104:107]
    buffer_load_dwordx4 a[184:187], v252, s[36:39], s58 offen offset:0 sc1
    v_mfma_f32_16x16x32_bf16 v[108:111], a[176:179], a[60:63], v[108:111]
    v_mfma_f32_16x16x32_bf16 v[108:111], a[180:183], a[76:79], v[108:111]
    s_waitcnt lgkmcnt(14)
    ds_read_b64_tr_b16 a[176:177], v227 offset:0
    ds_read_b64_tr_b16 a[178:179], v227 offset:4096
    v_mfma_f32_16x16x32_bf16 v[124:127], a[0:3], a[60:63], v[124:127]
    s_waitcnt lgkmcnt(14)
    v_mfma_f32_16x16x32_bf16 v[124:127], a[4:7], a[76:79], v[124:127]
    buffer_load_dwordx4 a[188:191], v252, s[36:39], s58 offen offset:1024 sc1
    v_mfma_f32_16x16x32_bf16 v[120:123], a[0:3], a[56:59], v[120:123]
    v_mfma_f32_16x16x32_bf16 v[120:123], a[4:7], a[72:75], v[120:123]
    ds_read_b64_tr_b16 a[180:181], v227 offset:8192
    ds_read_b64_tr_b16 a[182:183], v227 offset:12288
    v_mfma_f32_16x16x32_bf16 v[116:119], a[0:3], a[52:55], v[116:119]
    v_mfma_f32_16x16x32_bf16 v[116:119], a[4:7], a[68:71], v[116:119]
    buffer_load_dwordx4 a[192:195], v252, s[36:39], s58 offen offset:2048 sc1
    v_mfma_f32_16x16x32_bf16 v[112:115], a[0:3], a[48:51], v[112:115]
    v_mfma_f32_16x16x32_bf16 v[112:115], a[4:7], a[64:67], v[112:115]
    s_waitcnt lgkmcnt(14)
    ds_read_b64_tr_b16 a[0:1], v228 offset:0
    ds_read_b64_tr_b16 a[2:3], v228 offset:4096
    v_mfma_f32_16x16x32_bf16 v[0:3], a[8:11], a[80:83], v[0:3]
    s_waitcnt lgkmcnt(14)
    v_mfma_f32_16x16x32_bf16 v[0:3], a[12:15], a[96:99], v[0:3]
    buffer_load_dwordx4 a[196:199], v252, s[36:39], s58 offen offset:3072 sc1
    s_add_u32 s58, s58, 0x8000
    v_mfma_f32_16x16x32_bf16 v[4:7], a[8:11], a[84:87], v[4:7]
    s_waitcnt vmcnt(26)
    s_barrier
    v_mfma_f32_16x16x32_bf16 v[4:7], a[12:15], a[100:103], v[4:7]
    ds_read_b64_tr_b16 a[4:5], v228 offset:8192
    ds_read_b64_tr_b16 a[6:7], v228 offset:12288
    v_mfma_f32_16x16x32_bf16 v[8:11], a[8:11], a[88:91], v[8:11]
    s_sub_u32 s3, s58, 0x70000
    s_cmp_ge_u32 s58, s55
    s_cselect_b32 s58, s3, s58
    v_mfma_f32_16x16x32_bf16 v[8:11], a[12:15], a[104:107], v[8:11]
    buffer_load_dwordx4 v232, s[40:43], s59 offen lds
    v_mfma_f32_16x16x32_bf16 v[12:15], a[8:11], a[92:95], v[12:15]
    v_mfma_f32_16x16x32_bf16 v[12:15], a[12:15], a[108:111], v[12:15]
    s_waitcnt lgkmcnt(14)
    ds_read_b64_tr_b16 a[8:9], v229 offset:0
    ds_read_b64_tr_b16 a[10:11], v229 offset:4096
    v_mfma_f32_16x16x32_bf16 v[28:31], a[16:19], a[92:95], v[28:31]
    s_waitcnt lgkmcnt(14)
    v_mfma_f32_16x16x32_bf16 v[28:31], a[20:23], a[108:111], v[28:31]
    buffer_load_dwordx4 v233, s[40:43], s59 offen offset:1024 lds
    s_add_u32 m0, s61, 0x10000
    v_mfma_f32_16x16x32_bf16 v[24:27], a[16:19], a[88:91], v[24:27]
    s_add_u32 s59, s59, 0x10000
    v_mfma_f32_16x16x32_bf16 v[24:27], a[20:23], a[104:107], v[24:27]
    ds_read_b64_tr_b16 a[12:13], v229 offset:8192
    ds_read_b64_tr_b16 a[14:15], v229 offset:12288
    v_mfma_f32_16x16x32_bf16 v[20:23], a[16:19], a[84:87], v[20:23]
    v_mfma_f32_16x16x32_bf16 v[20:23], a[20:23], a[100:103], v[20:23]
    buffer_load_dwordx4 a[200:203], v252, s[36:39], s58 offen offset:0 sc1
    v_mfma_f32_16x16x32_bf16 v[16:19], a[16:19], a[80:83], v[16:19]
    v_mfma_f32_16x16x32_bf16 v[16:19], a[20:23], a[96:99], v[16:19]
    s_waitcnt lgkmcnt(14)
    ds_read_b64_tr_b16 a[16:17], v230 offset:0
    ds_read_b64_tr_b16 a[18:19], v230 offset:4096
    v_mfma_f32_16x16x32_bf16 v[32:35], a[24:27], a[80:83], v[32:35]
    s_waitcnt lgkmcnt(14)
    v_mfma_f32_16x16x32_bf16 v[32:35], a[28:31], a[96:99], v[32:35]
    buffer_load_dwordx4 a[204:207], v252, s[36:39], s58 offen offset:1024 sc1
    v_mfma_f32_16x16x32_bf16 v[36:39], a[24:27], a[84:87], v[36:39]
    v_mfma_f32_16x16x32_bf16 v[36:39], a[28:31], a[100:103], v[36:39]
    ds_read_b64_tr_b16 a[20:21], v230 offset:8192
    ds_read_b64_tr_b16 a[22:23], v230 offset:12288
    v_mfma_f32_16x16x32_bf16 v[40:43], a[24:27], a[88:91], v[40:43]
    v_mfma_f32_16x16x32_bf16 v[40:43], a[28:31], a[104:107], v[40:43]
    buffer_load_dwordx4 a[208:211], v252, s[36:39], s58 offen offset:2048 sc1
    v_mfma_f32_16x16x32_bf16 v[44:47], a[24:27], a[92:95], v[44:47]
    v_mfma_f32_16x16x32_bf16 v[44:47], a[28:31], a[108:111], v[44:47]
    s_waitcnt lgkmcnt(14)
    ds_read_b64_tr_b16 a[24:25], v231 offset:0
    ds_read_b64_tr_b16 a[26:27], v231 offset:4096
    v_mfma_f32_16x16x32_bf16 v[60:63], a[176:179], a[92:95], v[60:63]
    s_waitcnt lgkmcnt(14)
    v_mfma_f32_16x16x32_bf16 v[60:63], a[180:183], a[108:111], v[60:63]
    buffer_load_dwordx4 a[212:215], v252, s[36:39], s58 offen offset:3072 sc1
    s_add_u32 s58, s58, 0x4000
    v_mfma_f32_16x16x32_bf16 v[56:59], a[176:179], a[88:91], v[56:59]
    v_mfma_f32_16x16x32_bf16 v[56:59], a[180:183], a[104:107], v[56:59]
    ds_read_b64_tr_b16 a[28:29], v231 offset:8192
    ds_read_b64_tr_b16 a[30:31], v231 offset:12288
    v_mfma_f32_16x16x32_bf16 v[52:55], a[176:179], a[84:87], v[52:55]
    v_mfma_f32_16x16x32_bf16 v[52:55], a[180:183], a[100:103], v[52:55]
    buffer_load_dwordx4 v232, s[40:43], s59 offen lds
    v_mfma_f32_16x16x32_bf16 v[48:51], a[176:179], a[80:83], v[48:51]
    v_mfma_f32_16x16x32_bf16 v[48:51], a[180:183], a[96:99], v[48:51]
    s_waitcnt lgkmcnt(14)
    ds_read_b64_tr_b16 a[176:177], v224 offset:16384
    ds_read_b64_tr_b16 a[178:179], v224 offset:20480
    v_mfma_f32_16x16x32_bf16 v[64:67], a[0:3], a[80:83], v[64:67]
    s_waitcnt lgkmcnt(14)
    v_mfma_f32_16x16x32_bf16 v[64:67], a[4:7], a[96:99], v[64:67]
    buffer_load_dwordx4 v233, s[40:43], s59 offen offset:1024 lds
    s_add_u32 m0, s61, 0x12000
    v_mfma_f32_16x16x32_bf16 v[68:71], a[0:3], a[84:87], v[68:71]
    s_add_u32 s59, s59, 0x30000
    v_mfma_f32_16x16x32_bf16 v[68:71], a[4:7], a[100:103], v[68:71]
    ds_read_b64_tr_b16 a[180:181], v224 offset:24576
    ds_read_b64_tr_b16 a[182:183], v224 offset:28672
    v_mfma_f32_16x16x32_bf16 v[72:75], a[0:3], a[88:91], v[72:75]
    v_mfma_f32_16x16x32_bf16 v[72:75], a[4:7], a[104:107], v[72:75]
    buffer_load_dwordx4 v[144:147], v252, s[36:39], s58 offen offset:0 sc1
    v_mfma_f32_16x16x32_bf16 v[76:79], a[0:3], a[92:95], v[76:79]
    v_mfma_f32_16x16x32_bf16 v[76:79], a[4:7], a[108:111], v[76:79]
    s_waitcnt lgkmcnt(14)
    ds_read_b64_tr_b16 a[0:1], v225 offset:16384
    ds_read_b64_tr_b16 a[2:3], v225 offset:20480
    v_mfma_f32_16x16x32_bf16 v[92:95], a[8:11], a[92:95], v[92:95]
    s_waitcnt lgkmcnt(14)
    v_mfma_f32_16x16x32_bf16 v[92:95], a[12:15], a[108:111], v[92:95]
    buffer_load_dwordx4 v[148:151], v252, s[36:39], s58 offen offset:1024 sc1
    v_mfma_f32_16x16x32_bf16 v[88:91], a[8:11], a[88:91], v[88:91]
    v_mfma_f32_16x16x32_bf16 v[88:91], a[12:15], a[104:107], v[88:91]
    ds_read_b64_tr_b16 a[4:5], v225 offset:24576
    ds_read_b64_tr_b16 a[6:7], v225 offset:28672
    v_mfma_f32_16x16x32_bf16 v[84:87], a[8:11], a[84:87], v[84:87]
    v_mfma_f32_16x16x32_bf16 v[84:87], a[12:15], a[100:103], v[84:87]
    buffer_load_dwordx4 v[152:155], v252, s[36:39], s58 offen offset:2048 sc1
    v_mfma_f32_16x16x32_bf16 v[80:83], a[8:11], a[80:83], v[80:83]
    v_mfma_f32_16x16x32_bf16 v[80:83], a[12:15], a[96:99], v[80:83]
    s_waitcnt lgkmcnt(14)
    ds_read_b64_tr_b16 a[8:9], v226 offset:16384
    ds_read_b64_tr_b16 a[10:11], v226 offset:20480
    v_mfma_f32_16x16x32_bf16 v[96:99], a[16:19], a[80:83], v[96:99]
    s_waitcnt lgkmcnt(14)
    v_mfma_f32_16x16x32_bf16 v[96:99], a[20:23], a[96:99], v[96:99]
    buffer_load_dwordx4 v[156:159], v252, s[36:39], s58 offen offset:3072 sc1
    s_add_u32 s58, s58, 0xc000
    v_mfma_f32_16x16x32_bf16 v[100:103], a[16:19], a[84:87], v[100:103]
    v_mfma_f32_16x16x32_bf16 v[100:103], a[20:23], a[100:103], v[100:103]
    ds_read_b64_tr_b16 a[12:13], v226 offset:24576
    ds_read_b64_tr_b16 a[14:15], v226 offset:28672
    v_mfma_f32_16x16x32_bf16 v[104:107], a[16:19], a[88:91], v[104:107]
    v_mfma_f32_16x16x32_bf16 v[104:107], a[20:23], a[104:107], v[104:107]
    buffer_load_dwordx4 v232, s[40:43], s59 offen lds
    v_mfma_f32_16x16x32_bf16 v[108:111], a[16:19], a[92:95], v[108:111]
    v_mfma_f32_16x16x32_bf16 v[108:111], a[20:23], a[108:111], v[108:111]
    s_waitcnt lgkmcnt(14)
    ds_read_b64_tr_b16 a[16:17], v227 offset:16384
    ds_read_b64_tr_b16 a[18:19], v227 offset:20480
    v_mfma_f32_16x16x32_bf16 v[124:127], a[24:27], a[92:95], v[124:127]
    s_waitcnt lgkmcnt(14)
    v_mfma_f32_16x16x32_bf16 v[124:127], a[28:31], a[108:111], v[124:127]
    buffer_load_dwordx4 v233, s[40:43], s59 offen offset:1024 lds
    s_add_u32 m0, s61, 0x14000
    v_mfma_f32_16x16x32_bf16 v[120:123], a[24:27], a[88:91], v[120:123]
    s_add_u32 s59, s59, 0x10000
    v_mfma_f32_16x16x32_bf16 v[120:123], a[28:31], a[104:107], v[120:123]
    ds_read_b64_tr_b16 a[20:21], v227 offset:24576
    ds_read_b64_tr_b16 a[22:23], v227 offset:28672
    v_mfma_f32_16x16x32_bf16 v[116:119], a[24:27], a[84:87], v[116:119]
    v_mfma_f32_16x16x32_bf16 v[116:119], a[28:31], a[100:103], v[116:119]
    buffer_load_dwordx4 v[128:131], v252, s[36:39], s58 offen offset:0 sc1
    v_mfma_f32_16x16x32_bf16 v[112:115], a[24:27], a[80:83], v[112:115]
    v_mfma_f32_16x16x32_bf16 v[112:115], a[28:31], a[96:99], v[112:115]
    s_waitcnt vmcnt(38) lgkmcnt(14)
    ds_read_b64_tr_b16 a[24:25], v228 offset:16384
    ds_read_b64_tr_b16 a[26:27], v228 offset:20480
    v_mfma_f32_16x16x32_bf16 v[0:3], a[176:179], a[112:115], v[0:3]
    s_waitcnt vmcnt(34) lgkmcnt(14)
    buffer_load_dword v214, v215, s[96:99], 0 offen sc1
    v_mfma_f32_16x16x32_bf16 v[0:3], a[180:183], a[128:131], v[0:3]
    buffer_load_dwordx4 v[132:135], v252, s[36:39], s58 offen offset:1024 sc1
    v_mfma_f32_16x16x32_bf16 v[4:7], a[176:179], a[116:119], v[4:7]
    s_waitcnt vmcnt(35)
    s_waitcnt vmcnt(27)
    s_barrier
    v_mfma_f32_16x16x32_bf16 v[4:7], a[180:183], a[132:135], v[4:7]
    ds_read_b64_tr_b16 a[28:29], v228 offset:24576
    ds_read_b64_tr_b16 a[30:31], v228 offset:28672
    v_mfma_f32_16x16x32_bf16 v[8:11], a[176:179], a[120:123], v[8:11]
    v_mfma_f32_16x16x32_bf16 v[8:11], a[180:183], a[136:139], v[8:11]
    buffer_load_dwordx4 v[136:139], v252, s[36:39], s58 offen offset:2048 sc1
    v_mfma_f32_16x16x32_bf16 v[12:15], a[176:179], a[124:127], v[12:15]
    v_mfma_f32_16x16x32_bf16 v[12:15], a[180:183], a[140:143], v[12:15]
    s_waitcnt lgkmcnt(14)
    ds_read_b64_tr_b16 a[176:177], v229 offset:16384
    ds_read_b64_tr_b16 a[178:179], v229 offset:20480
    v_mfma_f32_16x16x32_bf16 v[28:31], a[0:3], a[124:127], v[28:31]
    s_waitcnt lgkmcnt(14)
    v_mfma_f32_16x16x32_bf16 v[28:31], a[4:7], a[140:143], v[28:31]
    buffer_load_dwordx4 v[140:143], v252, s[36:39], s58 offen offset:3072 sc1
    s_add_u32 s58, s58, 0x4000
    v_mfma_f32_16x16x32_bf16 v[24:27], a[0:3], a[120:123], v[24:27]
    v_mfma_f32_16x16x32_bf16 v[24:27], a[4:7], a[136:139], v[24:27]
    ds_read_b64_tr_b16 a[180:181], v229 offset:24576
    ds_read_b64_tr_b16 a[182:183], v229 offset:28672
    v_mfma_f32_16x16x32_bf16 v[20:23], a[0:3], a[116:119], v[20:23]
    v_mfma_f32_16x16x32_bf16 v[20:23], a[4:7], a[132:135], v[20:23]
    buffer_load_dwordx4 v232, s[40:43], s59 offen lds
    v_mfma_f32_16x16x32_bf16 v[16:19], a[0:3], a[112:115], v[16:19]
    v_mfma_f32_16x16x32_bf16 v[16:19], a[4:7], a[128:131], v[16:19]
    s_waitcnt lgkmcnt(14)
    ds_read_b64_tr_b16 a[0:1], v230 offset:16384
    ds_read_b64_tr_b16 a[2:3], v230 offset:20480
    v_mfma_f32_16x16x32_bf16 v[32:35], a[8:11], a[112:115], v[32:35]
    s_waitcnt lgkmcnt(14)
    v_mfma_f32_16x16x32_bf16 v[32:35], a[12:15], a[128:131], v[32:35]
    buffer_load_dwordx4 v233, s[40:43], s59 offen offset:1024 lds
    s_add_u32 m0, s61, 0x16000
    v_mfma_f32_16x16x32_bf16 v[36:39], a[8:11], a[116:119], v[36:39]
    s_add_u32 s59, s59, 0x50000
    v_mfma_f32_16x16x32_bf16 v[36:39], a[12:15], a[132:135], v[36:39]
    ds_read_b64_tr_b16 a[4:5], v230 offset:24576
    ds_read_b64_tr_b16 a[6:7], v230 offset:28672
    v_mfma_f32_16x16x32_bf16 v[40:43], a[8:11], a[120:123], v[40:43]
    s_sub_u32 s3, s59, 0x1c0000
    s_cmp_ge_u32 s59, s66
    s_cselect_b32 s59, s3, s59
    v_mfma_f32_16x16x32_bf16 v[40:43], a[12:15], a[136:139], v[40:43]
    s_add_u32 s59, s59, s10
    buffer_load_dwordx4 v[160:163], v252, s[36:39], s58 offen offset:0 sc1
    v_mfma_f32_16x16x32_bf16 v[44:47], a[8:11], a[124:127], v[44:47]
    v_mfma_f32_16x16x32_bf16 v[44:47], a[12:15], a[140:143], v[44:47]
    s_waitcnt lgkmcnt(14)
    ds_read_b64_tr_b16 a[8:9], v231 offset:16384
    ds_read_b64_tr_b16 a[10:11], v231 offset:20480
    v_mfma_f32_16x16x32_bf16 v[60:63], a[16:19], a[124:127], v[60:63]
    s_waitcnt lgkmcnt(14)
    v_mfma_f32_16x16x32_bf16 v[60:63], a[20:23], a[140:143], v[60:63]
    buffer_load_dwordx4 v[164:167], v252, s[36:39], s58 offen offset:1024 sc1
    v_mfma_f32_16x16x32_bf16 v[56:59], a[16:19], a[120:123], v[56:59]
    v_mfma_f32_16x16x32_bf16 v[56:59], a[20:23], a[136:139], v[56:59]
    ds_read_b64_tr_b16 a[12:13], v231 offset:24576
    ds_read_b64_tr_b16 a[14:15], v231 offset:28672
    v_mfma_f32_16x16x32_bf16 v[52:55], a[16:19], a[116:119], v[52:55]
    v_mfma_f32_16x16x32_bf16 v[52:55], a[20:23], a[132:135], v[52:55]
    buffer_load_dwordx4 v[168:171], v252, s[36:39], s58 offen offset:2048 sc1
    v_mfma_f32_16x16x32_bf16 v[48:51], a[16:19], a[112:115], v[48:51]
    v_mfma_f32_16x16x32_bf16 v[48:51], a[20:23], a[128:131], v[48:51]
    s_waitcnt lgkmcnt(14)
    ds_read_b64_tr_b16 a[16:17], v224 offset:32768
    ds_read_b64_tr_b16 a[18:19], v224 offset:36864
    v_mfma_f32_16x16x32_bf16 v[64:67], a[24:27], a[112:115], v[64:67]
    s_waitcnt lgkmcnt(14)
    v_mfma_f32_16x16x32_bf16 v[64:67], a[28:31], a[128:131], v[64:67]
    buffer_load_dwordx4 v[172:175], v252, s[36:39], s58 offen offset:3072 sc1
    s_add_u32 s58, s58, 0x14000
    v_mfma_f32_16x16x32_bf16 v[68:71], a[24:27], a[116:119], v[68:71]
    s_sub_u32 s3, s58, 0x70000
    s_cmp_ge_u32 s58, s55
    s_cselect_b32 s58, s3, s58
    v_mfma_f32_16x16x32_bf16 v[68:71], a[28:31], a[132:135], v[68:71]
    ds_read_b64_tr_b16 a[20:21], v224 offset:40960
    ds_read_b64_tr_b16 a[22:23], v224 offset:45056
    v_mfma_f32_16x16x32_bf16 v[72:75], a[24:27], a[120:123], v[72:75]
    v_mfma_f32_16x16x32_bf16 v[72:75], a[28:31], a[136:139], v[72:75]
    buffer_load_dwordx4 v232, s[40:43], s59 offen lds
    v_mfma_f32_16x16x32_bf16 v[76:79], a[24:27], a[124:127], v[76:79]
    v_mfma_f32_16x16x32_bf16 v[76:79], a[28:31], a[140:143], v[76:79]
    s_waitcnt lgkmcnt(14)
    ds_read_b64_tr_b16 a[24:25], v225 offset:32768
    ds_read_b64_tr_b16 a[26:27], v225 offset:36864
    v_mfma_f32_16x16x32_bf16 v[92:95], a[176:179], a[124:127], v[92:95]
    s_waitcnt lgkmcnt(14)
    v_mfma_f32_16x16x32_bf16 v[92:95], a[180:183], a[140:143], v[92:95]
    buffer_load_dwordx4 v233, s[40:43], s59 offen offset:1024 lds
    s_add_u32 s93, s87, 8
    buffer_load_dword v254, v253, s[44:47], s93 offen sc1
    v_mfma_f32_16x16x32_bf16 v[88:91], a[176:179], a[120:123], v[88:91]
    s_add_u32 m0, s61, 0x18000
    s_sub_u32 s59, s59, s10
    s_add_u32 s59, s59, 0x30000
    v_mfma_f32_16x16x32_bf16 v[88:91], a[180:183], a[136:139], v[88:91]
    s_sub_u32 s59, s59, s9
    ds_read_b64_tr_b16 a[28:29], v225 offset:40960
    ds_read_b64_tr_b16 a[30:31], v225 offset:45056
    v_mfma_f32_16x16x32_bf16 v[84:87], a[176:179], a[116:119], v[84:87]
    v_mfma_f32_16x16x32_bf16 v[84:87], a[180:183], a[132:135], v[84:87]
    buffer_load_dwordx4 v232, s[40:43], s59 offen lds
    v_mfma_f32_16x16x32_bf16 v[80:83], a[176:179], a[112:115], v[80:83]
    v_mfma_f32_16x16x32_bf16 v[80:83], a[180:183], a[128:131], v[80:83]
    s_waitcnt lgkmcnt(14)
    ds_read_b64_tr_b16 a[176:177], v226 offset:32768
    ds_read_b64_tr_b16 a[178:179], v226 offset:36864
    v_mfma_f32_16x16x32_bf16 v[96:99], a[0:3], a[112:115], v[96:99]
    s_waitcnt lgkmcnt(14)
    v_mfma_f32_16x16x32_bf16 v[96:99], a[4:7], a[128:131], v[96:99]
    buffer_load_dwordx4 v233, s[40:43], s59 offen offset:1024 lds
    s_add_u32 m0, s61, 0x1a000
    v_mfma_f32_16x16x32_bf16 v[100:103], a[0:3], a[116:119], v[100:103]
    s_add_u32 s59, s59, 0x30000
    s_add_u32 s59, s59, s9
    v_mfma_f32_16x16x32_bf16 v[100:103], a[4:7], a[132:135], v[100:103]
    ds_read_b64_tr_b16 a[180:181], v226 offset:40960
    ds_read_b64_tr_b16 a[182:183], v226 offset:45056
    v_mfma_f32_16x16x32_bf16 v[104:107], a[0:3], a[120:123], v[104:107]
    s_sub_u32 s3, s59, 0x1c0000
    s_cmp_ge_u32 s59, s66
    s_cselect_b32 s59, s3, s59
    v_mfma_f32_16x16x32_bf16 v[104:107], a[4:7], a[136:139], v[104:107]
    buffer_load_dwordx4 v232, s[40:43], s59 offen lds
    v_mfma_f32_16x16x32_bf16 v[108:111], a[0:3], a[124:127], v[108:111]
    v_mfma_f32_16x16x32_bf16 v[108:111], a[4:7], a[140:143], v[108:111]
    s_waitcnt lgkmcnt(14)
    ds_read_b64_tr_b16 a[0:1], v227 offset:32768
    ds_read_b64_tr_b16 a[2:3], v227 offset:36864
    v_mfma_f32_16x16x32_bf16 v[124:127], a[8:11], a[124:127], v[124:127]
    s_waitcnt lgkmcnt(14)
    v_mfma_f32_16x16x32_bf16 v[124:127], a[12:15], a[140:143], v[124:127]
    buffer_load_dwordx4 v233, s[40:43], s59 offen offset:1024 lds
    s_add_u32 m0, s61, 0x1c000
    v_mfma_f32_16x16x32_bf16 v[120:123], a[8:11], a[120:123], v[120:123]
    s_add_u32 s59, s59, 0x10000
    s_add_u32 s59, s59, s10
    v_mfma_f32_16x16x32_bf16 v[120:123], a[12:15], a[136:139], v[120:123]
    ds_read_b64_tr_b16 a[4:5], v227 offset:40960
    ds_read_b64_tr_b16 a[6:7], v227 offset:45056
    v_mfma_f32_16x16x32_bf16 v[116:119], a[8:11], a[116:119], v[116:119]
    v_mfma_f32_16x16x32_bf16 v[116:119], a[12:15], a[132:135], v[116:119]
    buffer_load_dwordx4 v232, s[40:43], s59 offen lds
    v_mfma_f32_16x16x32_bf16 v[112:115], a[8:11], a[112:115], v[112:115]
    v_mfma_f32_16x16x32_bf16 v[112:115], a[12:15], a[128:131], v[112:115]
    s_waitcnt lgkmcnt(14)
    ds_read_b64_tr_b16 a[8:9], v228 offset:32768
    ds_read_b64_tr_b16 a[10:11], v228 offset:36864
    v_mfma_f32_16x16x32_bf16 v[0:3], a[16:19], a[144:147], v[0:3]
    s_waitcnt vmcnt(42) lgkmcnt(14)
    v_mfma_f32_16x16x32_bf16 v[0:3], a[20:23], a[160:163], v[0:3]
    buffer_load_dwordx4 v233, s[40:43], s59 offen offset:1024 lds
    s_add_u32 m0, s61, 0x1e000
    v_mfma_f32_16x16x32_bf16 v[4:7], a[16:19], a[148:151], v[4:7]
    s_waitcnt vmcnt(42)
    s_waitcnt vmcnt(32)
    s_barrier
    v_mfma_f32_16x16x32_bf16 v[4:7], a[20:23], a[164:167], v[4:7]
    s_sub_u32 s59, s59, s10
    ds_read_b64_tr_b16 a[12:13], v228 offset:40960
    ds_read_b64_tr_b16 a[14:15], v228 offset:45056
    v_mfma_f32_16x16x32_bf16 v[8:11], a[16:19], a[152:155], v[8:11]
    s_add_u32 s59, s59, 0x30000
    v_mfma_f32_16x16x32_bf16 v[8:11], a[20:23], a[168:171], v[8:11]
    buffer_load_dwordx4 v232, s[40:43], s59 offen lds
    v_mfma_f32_16x16x32_bf16 v[12:15], a[16:19], a[156:159], v[12:15]
    v_mfma_f32_16x16x32_bf16 v[12:15], a[20:23], a[172:175], v[12:15]
    s_waitcnt lgkmcnt(14)
    ds_read_b64_tr_b16 a[16:17], v229 offset:32768
    ds_read_b64_tr_b16 a[18:19], v229 offset:36864
    v_mfma_f32_16x16x32_bf16 v[28:31], a[24:27], a[156:159], v[28:31]
    s_waitcnt lgkmcnt(14)
    v_mfma_f32_16x16x32_bf16 v[28:31], a[28:31], a[172:175], v[28:31]
    buffer_load_dwordx4 v233, s[40:43], s59 offen offset:1024 lds
    s_add_u32 m0, s61, 0x20000
    v_mfma_f32_16x16x32_bf16 v[24:27], a[24:27], a[152:155], v[24:27]
    s_add_u32 s59, s59, 0x30000
    v_mfma_f32_16x16x32_bf16 v[24:27], a[28:31], a[168:171], v[24:27]
    ds_read_b64_tr_b16 a[20:21], v229 offset:40960
    ds_read_b64_tr_b16 a[22:23], v229 offset:45056
    v_mfma_f32_16x16x32_bf16 v[20:23], a[24:27], a[148:151], v[20:23]
    s_sub_u32 s3, s59, 0x1c0000
    s_cmp_ge_u32 s59, s66
    s_cselect_b32 s59, s3, s59
    v_mfma_f32_16x16x32_bf16 v[20:23], a[28:31], a[164:167], v[20:23]
    buffer_load_dwordx4 v232, s[40:43], s59 offen lds
    v_mfma_f32_16x16x32_bf16 v[16:19], a[24:27], a[144:147], v[16:19]
    v_mfma_f32_16x16x32_bf16 v[16:19], a[28:31], a[160:163], v[16:19]
    s_waitcnt lgkmcnt(14)
    ds_read_b64_tr_b16 a[24:25], v230 offset:32768
    ds_read_b64_tr_b16 a[26:27], v230 offset:36864
    v_mfma_f32_16x16x32_bf16 v[32:35], a[176:179], a[144:147], v[32:35]
    s_waitcnt lgkmcnt(14)
    v_mfma_f32_16x16x32_bf16 v[32:35], a[180:183], a[160:163], v[32:35]
    buffer_load_dwordx4 v233, s[40:43], s59 offen offset:1024 lds
    s_add_u32 m0, s61, 0x22000
    v_mfma_f32_16x16x32_bf16 v[36:39], a[176:179], a[148:151], v[36:39]
    s_add_u32 s59, s59, 0x10000
    s_add_u32 s59, s59, s10
    v_mfma_f32_16x16x32_bf16 v[36:39], a[180:183], a[164:167], v[36:39]
    ds_read_b64_tr_b16 a[28:29], v230 offset:40960
    ds_read_b64_tr_b16 a[30:31], v230 offset:45056
    v_mfma_f32_16x16x32_bf16 v[40:43], a[176:179], a[152:155], v[40:43]
    v_mfma_f32_16x16x32_bf16 v[40:43], a[180:183], a[168:171], v[40:43]
    buffer_load_dwordx4 v232, s[40:43], s59 offen lds
    v_mfma_f32_16x16x32_bf16 v[44:47], a[176:179], a[156:159], v[44:47]
    v_mfma_f32_16x16x32_bf16 v[44:47], a[180:183], a[172:175], v[44:47]
    s_waitcnt lgkmcnt(14)
    ds_read_b64_tr_b16 a[176:177], v231 offset:32768
    ds_read_b64_tr_b16 a[178:179], v231 offset:36864
    v_mfma_f32_16x16x32_bf16 v[60:63], a[0:3], a[156:159], v[60:63]
    s_waitcnt lgkmcnt(14)
    v_mfma_f32_16x16x32_bf16 v[60:63], a[4:7], a[172:175], v[60:63]
    buffer_load_dwordx4 v233, s[40:43], s59 offen offset:1024 lds
    s_add_u32 m0, s61, 0x24000
    v_mfma_f32_16x16x32_bf16 v[56:59], a[0:3], a[152:155], v[56:59]
    s_sub_u32 s59, s59, s10
    s_add_u32 s59, s59, 0x30000
    v_mfma_f32_16x16x32_bf16 v[56:59], a[4:7], a[168:171], v[56:59]
    ds_read_b64_tr_b16 a[180:181], v231 offset:40960
    ds_read_b64_tr_b16 a[182:183], v231 offset:45056
    v_mfma_f32_16x16x32_bf16 v[52:55], a[0:3], a[148:151], v[52:55]
    v_mfma_f32_16x16x32_bf16 v[52:55], a[4:7], a[164:167], v[52:55]
    v_mfma_f32_16x16x32_bf16 v[48:51], a[0:3], a[144:147], v[48:51]
    v_mfma_f32_16x16x32_bf16 v[48:51], a[4:7], a[160:163], v[48:51]
    s_waitcnt lgkmcnt(14)
    ds_read_b64_tr_b16 a[0:1], v216 offset:0
    ds_read_b64_tr_b16 a[2:3], v216 offset:4096
    v_mfma_f32_16x16x32_bf16 v[64:67], a[8:11], a[144:147], v[64:67]
    s_waitcnt lgkmcnt(14)
    v_mfma_f32_16x16x32_bf16 v[64:67], a[12:15], a[160:163], v[64:67]
    s_mov_b32 s64, 0x8000
    s_waitcnt vmcnt(12)
L_sp_o:
    v_cmp_ne_u32 vcc, s88, v254
    s_sub_u32 s64, s64, 1
    s_cmp_eq_u32 s64, 0
    s_cbranch_scc1 L_sg_o
    s_nop 1
    s_cbranch_vccz L_sg_o
    buffer_load_dword v254, v253, s[44:47], s93 offen sc1
    s_waitcnt vmcnt(0)
    s_branch L_sp_o
L_sg_o:
    buffer_load_dwordx4 a[32:35], v252, s[36:39], s58 offen offset:0 sc1
    v_mfma_f32_16x16x32_bf16 v[68:71], a[8:11], a[148:151], v[68:71]
    v_mfma_f32_16x16x32_bf16 v[68:71], a[12:15], a[164:167], v[68:71]
    ds_read_b64_tr_b16 a[4:5], v216 offset:8192
    ds_read_b64_tr_b16 a[6:7], v216 offset:12288
    v_mfma_f32_16x16x32_bf16 v[72:75], a[8:11], a[152:155], v[72:75]
    v_mfma_f32_16x16x32_bf16 v[72:75], a[12:15], a[168:171], v[72:75]
    buffer_load_dwordx4 a[36:39], v252, s[36:39], s58 offen offset:1024 sc1
    v_mfma_f32_16x16x32_bf16 v[76:79], a[8:11], a[156:159], v[76:79]
    v_mfma_f32_16x16x32_bf16 v[76:79], a[12:15], a[172:175], v[76:79]
    s_waitcnt lgkmcnt(14)
    ds_read_b64_tr_b16 a[8:9], v217 offset:0
    ds_read_b64_tr_b16 a[10:11], v217 offset:4096
    v_mfma_f32_16x16x32_bf16 v[92:95], a[16:19], a[156:159], v[92:95]
    s_waitcnt lgkmcnt(14)
    v_mfma_f32_16x16x32_bf16 v[92:95], a[20:23], a[172:175], v[92:95]
    buffer_load_dwordx4 a[40:43], v252, s[36:39], s58 offen offset:2048 sc1
    v_mfma_f32_16x16x32_bf16 v[88:91], a[16:19], a[152:155], v[88:91]
    v_mfma_f32_16x16x32_bf16 v[88:91], a[20:23], a[168:171], v[88:91]
    ds_read_b64_tr_b16 a[12:13], v217 offset:8192
    ds_read_b64_tr_b16 a[14:15], v217 offset:12288
    v_mfma_f32_16x16x32_bf16 v[84:87], a[16:19], a[148:151], v[84:87]
    v_mfma_f32_16x16x32_bf16 v[84:87], a[20:23], a[164:167], v[84:87]
    buffer_load_dwordx4 a[44:47], v252, s[36:39], s58 offen offset:3072 sc1
    s_add_u32 s58, s58, 0xc000
    v_mfma_f32_16x16x32_bf16 v[80:83], a[16:19], a[144:147], v[80:83]
    s_sub_u32 s58, s58, s8
    v_mfma_f32_16x16x32_bf16 v[80:83], a[20:23], a[160:163], v[80:83]
    s_waitcnt lgkmcnt(14)
    ds_read_b64_tr_b16 a[16:17], v218 offset:0
    ds_read_b64_tr_b16 a[18:19], v218 offset:4096
    v_mfma_f32_16x16x32_bf16 v[96:99], a[24:27], a[144:147], v[96:99]
    s_waitcnt lgkmcnt(14)
    v_mfma_f32_16x16x32_bf16 v[96:99], a[28:31], a[160:163], v[96:99]
    buffer_load_dwordx4 a[48:51], v252, s[36:39], s58 offen offset:0 sc1
    v_mfma_f32_16x16x32_bf16 v[100:103], a[24:27], a[148:151], v[100:103]
    v_mfma_f32_16x16x32_bf16 v[100:103], a[28:31], a[164:167], v[100:103]
    ds_read_b64_tr_b16 a[20:21], v218 offset:8192
    ds_read_b64_tr_b16 a[22:23], v218 offset:12288
    v_mfma_f32_16x16x32_bf16 v[104:107], a[24:27], a[152:155], v[104:107]
    v_mfma_f32_16x16x32_bf16 v[104:107], a[28:31], a[168:171], v[104:107]
    buffer_load_dwordx4 a[52:55], v252, s[36:39], s58 offen offset:1024 sc1
    v_mfma_f32_16x16x32_bf16 v[108:111], a[24:27], a[156:159], v[108:111]
    v_mfma_f32_16x16x32_bf16 v[108:111], a[28:31], a[172:175], v[108:111]
    s_waitcnt lgkmcnt(14)
    ds_read_b64_tr_b16 a[24:25], v219 offset:0
    ds_read_b64_tr_b16 a[26:27], v219 offset:4096
    v_mfma_f32_16x16x32_bf16 v[124:127], a[176:179], a[156:159], v[124:127]
    s_waitcnt lgkmcnt(14)
    v_mfma_f32_16x16x32_bf16 v[124:127], a[180:183], a[172:175], v[124:127]
    buffer_load_dwordx4 a[56:59], v252, s[36:39], s58 offen offset:2048 sc1
    v_mfma_f32_16x16x32_bf16 v[120:123], a[176:179], a[152:155], v[120:123]
    v_mfma_f32_16x16x32_bf16 v[120:123], a[180:183], a[168:171], v[120:123]
    ds_read_b64_tr_b16 a[28:29], v219 offset:8192
    ds_read_b64_tr_b16 a[30:31], v219 offset:12288
    v_mfma_f32_16x16x32_bf16 v[116:119], a[176:179], a[148:151], v[116:119]
    v_mfma_f32_16x16x32_bf16 v[116:119], a[180:183], a[164:167], v[116:119]
    buffer_load_dwordx4 a[60:63], v252, s[36:39], s58 offen offset:3072 sc1
    s_add_u32 s58, s58, 0xc000
    v_mfma_f32_16x16x32_bf16 v[112:115], a[176:179], a[144:147], v[112:115]
    s_add_u32 s58, s58, s8
    v_mfma_f32_16x16x32_bf16 v[112:115], a[180:183], a[160:163], v[112:115]
    s_waitcnt lgkmcnt(14)
    ds_read_b64_tr_b16 a[176:177], v220 offset:0
    ds_read_b64_tr_b16 a[178:179], v220 offset:4096
    v_mfma_f32_16x16x32_bf16 v[0:3], a[0:3], a[184:187], v[0:3]
    s_waitcnt lgkmcnt(14)
    v_mfma_f32_16x16x32_bf16 v[0:3], a[4:7], a[200:203], v[0:3]
    s_sub_u32 s3, s58, 0x70000
    s_cmp_ge_u32 s58, s55
    s_cselect_b32 s58, s3, s58
    buffer_load_dwordx4 a[64:67], v252, s[36:39], s58 offen offset:0 sc1
    v_mfma_f32_16x16x32_bf16 v[4:7], a[0:3], a[188:191], v[4:7]
    s_barrier
    v_mfma_f32_16x16x32_bf16 v[4:7], a[4:7], a[204:207], v[4:7]
    ds_read_b64_tr_b16 a[180:181], v220 offset:8192
    ds_read_b64_tr_b16 a[182:183], v220 offset:12288
    v_mfma_f32_16x16x32_bf16 v[8:11], a[0:3], a[192:195], v[8:11]
    v_mfma_f32_16x16x32_bf16 v[8:11], a[4:7], a[208:211], v[8:11]
    buffer_load_dwordx4 a[68:71], v252, s[36:39], s58 offen offset:1024 sc1
    v_mfma_f32_16x16x32_bf16 v[12:15], a[0:3], a[196:199], v[12:15]
    v_mfma_f32_16x16x32_bf16 v[12:15], a[4:7], a[212:215], v[12:15]
    s_waitcnt lgkmcnt(14)
    ds_read_b64_tr_b16 a[0:1], v221 offset:0
    ds_read_b64_tr_b16 a[2:3], v221 offset:4096
    v_mfma_f32_16x16x32_bf16 v[28:31], a[8:11], a[196:199], v[28:31]
    s_waitcnt lgkmcnt(14)
    v_mfma_f32_16x16x32_bf16 v[28:31], a[12:15], a[212:215], v[28:31]
    buffer_load_dwordx4 a[72:75], v252, s[36:39], s58 offen offset:2048 sc1
    v_mfma_f32_16x16x32_bf16 v[24:27], a[8:11], a[192:195], v[24:27]
    v_mfma_f32_16x16x32_bf16 v[24:27], a[12:15], a[208:211], v[24:27]
    ds_read_b64_tr_b16 a[4:5], v221 offset:8192
    ds_read_b64_tr_b16 a[6:7], v221 offset:12288
    v_mfma_f32_16x16x32_bf16 v[20:23], a[8:11], a[188:191], v[20:23]
    v_mfma_f32_16x16x32_bf16 v[20:23], a[12:15], a[204:207], v[20:23]
    buffer_load_dwordx4 a[76:79], v252, s[36:39], s58 offen offset:3072 sc1
    s_add_u32 s58, s58, 0x4000
    v_mfma_f32_16x16x32_bf16 v[16:19], a[8:11], a[184:187], v[16:19]
    v_mfma_f32_16x16x32_bf16 v[16:19], a[12:15], a[200:203], v[16:19]
    s_waitcnt lgkmcnt(14)
    ds_read_b64_tr_b16 a[8:9], v222 offset:0
    ds_read_b64_tr_b16 a[10:11], v222 offset:4096
    v_mfma_f32_16x16x32_bf16 v[32:35], a[16:19], a[184:187], v[32:35]
    s_waitcnt lgkmcnt(14)
    v_mfma_f32_16x16x32_bf16 v[32:35], a[20:23], a[200:203], v[32:35]
    buffer_load_dwordx4 a[80:83], v252, s[36:39], s58 offen offset:0 sc1
    v_mfma_f32_16x16x32_bf16 v[36:39], a[16:19], a[188:191], v[36:39]
    v_mfma_f32_16x16x32_bf16 v[36:39], a[20:23], a[204:207], v[36:39]
    ds_read_b64_tr_b16 a[12:13], v222 offset:8192
    ds_read_b64_tr_b16 a[14:15], v222 offset:12288
    v_mfma_f32_16x16x32_bf16 v[40:43], a[16:19], a[192:195], v[40:43]
    v_mfma_f32_16x16x32_bf16 v[40:43], a[20:23], a[208:211], v[40:43]
    buffer_load_dwordx4 a[84:87], v252, s[36:39], s58 offen offset:1024 sc1
    v_mfma_f32_16x16x32_bf16 v[44:47], a[16:19], a[196:199], v[44:47]
    v_mfma_f32_16x16x32_bf16 v[44:47], a[20:23], a[212:215], v[44:47]
    s_waitcnt lgkmcnt(14)
    ds_read_b64_tr_b16 a[16:17], v223 offset:0
    ds_read_b64_tr_b16 a[18:19], v223 offset:4096
    v_mfma_f32_16x16x32_bf16 v[60:63], a[24:27], a[196:199], v[60:63]
    s_waitcnt lgkmcnt(14)
    v_mfma_f32_16x16x32_bf16 v[60:63], a[28:31], a[212:215], v[60:63]
    buffer_load_dwordx4 a[88:91], v252, s[36:39], s58 offen offset:2048 sc1
    v_mfma_f32_16x16x32_bf16 v[56:59], a[24:27], a[192:195], v[56:59]
    v_mfma_f32_16x16x32_bf16 v[56:59], a[28:31], a[208:211], v[56:59]
    ds_read_b64_tr_b16 a[20:21], v223 offset:8192
    ds_read_b64_tr_b16 a[22:23], v223 offset:12288
    v_mfma_f32_16x16x32_bf16 v[52:55], a[24:27], a[188:191], v[52:55]
    v_mfma_f32_16x16x32_bf16 v[52:55], a[28:31], a[204:207], v[52:55]
    buffer_load_dwordx4 a[92:95], v252, s[36:39], s58 offen offset:3072 sc1
    s_add_u32 s58, s58, 0xc000
    v_mfma_f32_16x16x32_bf16 v[48:51], a[24:27], a[184:187], v[48:51]
    v_mfma_f32_16x16x32_bf16 v[48:51], a[28:31], a[200:203], v[48:51]
    s_waitcnt lgkmcnt(14)
    ds_read_b64_tr_b16 a[24:25], v216 offset:16384
    ds_read_b64_tr_b16 a[26:27], v216 offset:20480
    v_mfma_f32_16x16x32_bf16 v[64:67], a[176:179], a[184:187], v[64:67]
    s_waitcnt lgkmcnt(14)
    v_mfma_f32_16x16x32_bf16 v[64:67], a[180:183], a[200:203], v[64:67]
    buffer_load_dwordx4 a[96:99], v252, s[36:39], s58 offen offset:0 sc1
    v_mfma_f32_16x16x32_bf16 v[68:71], a[176:179], a[188:191], v[68:71]
    v_mfma_f32_16x16x32_bf16 v[68:71], a[180:183], a[204:207], v[68:71]
    ds_read_b64_tr_b16 a[28:29], v216 offset:24576
    ds_read_b64_tr_b16 a[30:31], v216 offset:28672
    v_mfma_f32_16x16x32_bf16 v[72:75], a[176:179], a[192:195], v[72:75]
    v_mfma_f32_16x16x32_bf16 v[72:75], a[180:183], a[208:211], v[72:75]
    buffer_load_dwordx4 a[100:103], v252, s[36:39], s58 offen offset:1024 sc1
    v_mfma_f32_16x16x32_bf16 v[76:79], a[176:179], a[196:199], v[76:79]
    v_mfma_f32_16x16x32_bf16 v[76:79], a[180:183], a[212:215], v[76:79]
    s_waitcnt lgkmcnt(14)
    ds_read_b64_tr_b16 a[176:177], v217 offset:16384
    ds_read_b64_tr_b16 a[178:179], v217 offset:20480
    v_mfma_f32_16x16x32_bf16 v[92:95], a[0:3], a[196:199], v[92:95]
    s_waitcnt lgkmcnt(14)
    v_mfma_f32_16x16x32_bf16 v[92:95], a[4:7], a[212:215], v[92:95]
    buffer_load_dwordx4 a[104:107], v252, s[36:39], s58 offen offset:2048 sc1
    v_mfma_f32_16x16x32_bf16 v[88:91], a[0:3], a[192:195], v[88:91]
    v_mfma_f32_16x16x32_bf16 v[88:91], a[4:7], a[208:211], v[88:91]
    ds_read_b64_tr_b16 a[180:181], v217 offset:24576
    ds_read_b64_tr_b16 a[182:183], v217 offset:28672
    v_mfma_f32_16x16x32_bf16 v[84:87], a[0:3], a[188:191], v[84:87]
    v_mfma_f32_16x16x32_bf16 v[84:87], a[4:7], a[204:207], v[84:87]
    buffer_load_dwordx4 a[108:111], v252, s[36:39], s58 offen offset:3072 sc1
    s_add_u32 s58, s58, 0xc000
    v_mfma_f32_16x16x32_bf16 v[80:83], a[0:3], a[184:187], v[80:83]
    s_sub_u32 s3, s58, 0x70000
    s_cmp_ge_u32 s58, s55
    s_cselect_b32 s58, s3, s58
    v_mfma_f32_16x16x32_bf16 v[80:83], a[4:7], a[200:203], v[80:83]
    s_waitcnt lgkmcnt(14)
    ds_read_b64_tr_b16 a[0:1], v218 offset:16384
    ds_read_b64_tr_b16 a[2:3], v218 offset:20480
    v_mfma_f32_16x16x32_bf16 v[96:99], a[8:11], a[184:187], v[96:99]
    s_waitcnt lgkmcnt(14)
    v_mfma_f32_16x16x32_bf16 v[96:99], a[12:15], a[200:203], v[96:99]
    buffer_load_dwordx4 a[112:115], v252, s[36:39], s58 offen offset:0 sc1
    v_mfma_f32_16x16x32_bf16 v[100:103], a[8:11], a[188:191], v[100:103]
    v_mfma_f32_16x16x32_bf16 v[100:103], a[12:15], a[204:207], v[100:103]
    ds_read_b64_tr_b16 a[4:5], v218 offset:24576
    ds_read_b64_tr_b16 a[6:7], v218 offset:28672
    v_mfma_f32_16x16x32_bf16 v[104:107], a[8:11], a[192:195], v[104:107]
    v_mfma_f32_16x16x32_bf16 v[104:107], a[12:15], a[208:211], v[104:107]
    buffer_load_dwordx4 a[116:119], v252, s[36:39], s58 offen offset:1024 sc1
    v_mfma_f32_16x16x32_bf16 v[108:111], a[8:11], a[196:199], v[108:111]
    v_mfma_f32_16x16x32_bf16 v[108:111], a[12:15], a[212:215], v[108:111]
    s_waitcnt lgkmcnt(14)
    ds_read_b64_tr_b16 a[8:9], v219 offset:16384
    ds_read_b64_tr_b16 a[10:11], v219 offset:20480
    v_mfma_f32_16x16x32_bf16 v[124:127], a[16:19], a[196:199], v[124:127]
    s_waitcnt lgkmcnt(14)
    v_mfma_f32_16x16x32_bf16 v[124:127], a[20:23], a[212:215], v[124:127]
    buffer_load_dwordx4 a[120:123], v252, s[36:39], s58 offen offset:2048 sc1
    v_mfma_f32_16x16x32_bf16 v[120:123], a[16:19], a[192:195], v[120:123]
    v_mfma_f32_16x16x32_bf16 v[120:123], a[20:23], a[208:211], v[120:123]
    ds_read_b64_tr_b16 a[12:13], v219 offset:24576
    ds_read_b64_tr_b16 a[14:15], v219 offset:28672
    v_mfma_f32_16x16x32_bf16 v[116:119], a[16:19], a[188:191], v[116:119]
    v_mfma_f32_16x16x32_bf16 v[116:119], a[20:23], a[204:207], v[116:119]
    buffer_load_dwordx4 a[124:127], v252, s[36:39], s58 offen offset:3072 sc1
    s_add_u32 s58, s58, 0x4000
    v_mfma_f32_16x16x32_bf16 v[112:115], a[16:19], a[184:187], v[112:115]
    v_mfma_f32_16x16x32_bf16 v[112:115], a[20:23], a[200:203], v[112:115]
    s_waitcnt lgkmcnt(14)
    ds_read_b64_tr_b16 a[16:17], v220 offset:16384
    ds_read_b64_tr_b16 a[18:19], v220 offset:20480
    v_mfma_f32_16x16x32_bf16 v[0:3], a[24:27], v[144:147], v[0:3]
    s_waitcnt lgkmcnt(14)
    v_mfma_f32_16x16x32_bf16 v[0:3], a[28:31], v[128:131], v[0:3]
    buffer_load_dwordx4 a[128:131], v252, s[36:39], s58 offen offset:0 sc1
    v_mfma_f32_16x16x32_bf16 v[4:7], a[24:27], v[148:151], v[4:7]
    s_barrier
    v_mfma_f32_16x16x32_bf16 v[4:7], a[28:31], v[132:135], v[4:7]
    ds_read_b64_tr_b16 a[20:21], v220 offset:24576
    ds_read_b64_tr_b16 a[22:23], v220 offset:28672
    v_mfma_f32_16x16x32_bf16 v[8:11], a[24:27], v[152:155], v[8:11]
    v_mfma_f32_16x16x32_bf16 v[8:11], a[28:31], v[136:139], v[8:11]
    buffer_load_dwordx4 a[132:135], v252, s[36:39], s58 offen offset:1024 sc1
    v_mfma_f32_16x16x32_bf16 v[12:15], a[24:27], v[156:159], v[12:15]
    v_mfma_f32_16x16x32_bf16 v[12:15], a[28:31], v[140:143], v[12:15]
    s_waitcnt lgkmcnt(14)
    ds_read_b64_tr_b16 a[24:25], v221 offset:16384
    ds_read_b64_tr_b16 a[26:27], v221 offset:20480
    v_mfma_f32_16x16x32_bf16 v[28:31], a[176:179], v[156:159], v[28:31]
    s_waitcnt lgkmcnt(14)
    v_mfma_f32_16x16x32_bf16 v[28:31], a[180:183], v[140:143], v[28:31]
    buffer_load_dwordx4 a[136:139], v252, s[36:39], s58 offen offset:2048 sc1
    v_mfma_f32_16x16x32_bf16 v[24:27], a[176:179], v[152:155], v[24:27]
    v_mfma_f32_16x16x32_bf16 v[24:27], a[180:183], v[136:139], v[24:27]
    ds_read_b64_tr_b16 a[28:29], v221 offset:24576
    ds_read_b64_tr_b16 a[30:31], v221 offset:28672
    v_mfma_f32_16x16x32_bf16 v[20:23], a[176:179], v[148:151], v[20:23]
    v_mfma_f32_16x16x32_bf16 v[20:23], a[180:183], v[132:135], v[20:23]
    buffer_load_dwordx4 a[140:143], v252, s[36:39], s58 offen offset:3072 sc1
    s_add_u32 s58, s58, 0xc000
    v_mfma_f32_16x16x32_bf16 v[16:19], a[176:179], v[144:147], v[16:19]
    v_mfma_f32_16x16x32_bf16 v[16:19], a[180:183], v[128:131], v[16:19]
    s_waitcnt lgkmcnt(14)
    ds_read_b64_tr_b16 a[176:177], v222 offset:16384
    ds_read_b64_tr_b16 a[178:179], v222 offset:20480
    v_mfma_f32_16x16x32_bf16 v[32:35], a[0:3], v[144:147], v[32:35]
    s_waitcnt lgkmcnt(14)
    v_mfma_f32_16x16x32_bf16 v[32:35], a[4:7], v[128:131], v[32:35]
    buffer_load_dwordx4 v232, s[40:43], s59 offen lds
    v_mfma_f32_16x16x32_bf16 v[36:39], a[0:3], v[148:151], v[36:39]
    v_mfma_f32_16x16x32_bf16 v[36:39], a[4:7], v[132:135], v[36:39]
    ds_read_b64_tr_b16 a[180:181], v222 offset:24576
    ds_read_b64_tr_b16 a[182:183], v222 offset:28672
    v_mfma_f32_16x16x32_bf16 v[40:43], a[0:3], v[152:155], v[40:43]
    v_mfma_f32_16x16x32_bf16 v[40:43], a[4:7], v[136:139], v[40:43]
    buffer_load_dwordx4 v233, s[40:43], s59 offen offset:1024 lds
    s_add_u32 m0, s61, 0x26000
    v_mfma_f32_16x16x32_bf16 v[44:47], a[0:3], v[156:159], v[44:47]
    s_add_u32 s59, s59, 0x30000
    v_mfma_f32_16x16x32_bf16 v[44:47], a[4:7], v[140:143], v[44:47]
    s_waitcnt lgkmcnt(14)
    ds_read_b64_tr_b16 a[0:1], v223 offset:16384
    ds_read_b64_tr_b16 a[2:3], v223 offset:20480
    v_mfma_f32_16x16x32_bf16 v[60:63], a[8:11], v[156:159], v[60:63]
    s_waitcnt lgkmcnt(14)
    v_mfma_f32_16x16x32_bf16 v[60:63], a[12:15], v[140:143], v[60:63]
    buffer_load_dwordx4 a[144:147], v252, s[36:39], s58 offen offset:0 sc1
    v_mfma_f32_16x16x32_bf16 v[56:59], a[8:11], v[152:155], v[56:59]
    s_sub_u32 s3, s59, 0x1c0000
    s_cmp_ge_u32 s59, s66
    s_cselect_b32 s59, s3, s59
    v_mfma_f32_16x16x32_bf16 v[56:59], a[12:15], v[136:139], v[56:59]
    ds_read_b64_tr_b16 a[4:5], v223 offset:24576
    ds_read_b64_tr_b16 a[6:7], v223 offset:28672
    v_mfma_f32_16x16x32_bf16 v[52:55], a[8:11], v[148:151], v[52:55]
    v_mfma_f32_16x16x32_bf16 v[52:55], a[12:15], v[132:135], v[52:55]
    buffer_load_dwordx4 a[148:151], v252, s[36:39], s58 offen offset:1024 sc1
    v_mfma_f32_16x16x32_bf16 v[48:51], a[8:11], v[144:147], v[48:51]
    v_mfma_f32_16x16x32_bf16 v[48:51], a[12:15], v[128:131], v[48:51]
    s_waitcnt lgkmcnt(14)
    ds_read_b64_tr_b16 a[8:9], v216 offset:32768
    ds_read_b64_tr_b16 a[10:11], v216 offset:36864
    v_mfma_f32_16x16x32_bf16 v[64:67], a[16:19], v[144:147], v[64:67]
    s_waitcnt lgkmcnt(14)
    v_mfma_f32_16x16x32_bf16 v[64:67], a[20:23], v[128:131], v[64:67]
    buffer_load_dwordx4 a[152:155], v252, s[36:39], s58 offen offset:2048 sc1
    v_mfma_f32_16x16x32_bf16 v[68:71], a[16:19], v[148:151], v[68:71]
    v_mfma_f32_16x16x32_bf16 v[68:71], a[20:23], v[132:135], v[68:71]
    ds_read_b64_tr_b16 a[12:13], v216 offset:40960
    ds_read_b64_tr_b16 a[14:15], v216 offset:45056
    v_mfma_f32_16x16x32_bf16 v[72:75], a[16:19], v[152:155], v[72:75]
    v_mfma_f32_16x16x32_bf16 v[72:75], a[20:23], v[136:139], v[72:75]
    buffer_load_dwordx4 a[156:159], v252, s[36:39], s58 offen offset:3072 sc1
    s_add_u32 s58, s58, 0xc000
    v_mfma_f32_16x16x32_bf16 v[76:79], a[16:19], v[156:159], v[76:79]
    s_sub_u32 s3, s58, 0x70000
    s_cmp_ge_u32 s58, s55
    s_cselect_b32 s58, s3, s58
    v_mfma_f32_16x16x32_bf16 v[76:79], a[20:23], v[140:143], v[76:79]
    s_waitcnt lgkmcnt(14)
    ds_read_b64_tr_b16 a[16:17], v217 offset:32768
    ds_read_b64_tr_b16 a[18:19], v217 offset:36864
    v_mfma_f32_16x16x32_bf16 v[92:95], a[24:27], v[156:159], v[92:95]
    s_waitcnt lgkmcnt(14)
    v_mfma_f32_16x16x32_bf16 v[92:95], a[28:31], v[140:143], v[92:95]
    buffer_load_dwordx4 v232, s[40:43], s59 offen lds
    v_mfma_f32_16x16x32_bf16 v[88:91], a[24:27], v[152:155], v[88:91]
    v_mfma_f32_16x16x32_bf16 v[88:91], a[28:31], v[136:139], v[88:91]
    ds_read_b64_tr_b16 a[20:21], v217 offset:40960
    ds_read_b64_tr_b16 a[22:23], v217 offset:45056
    v_mfma_f32_16x16x32_bf16 v[84:87], a[24:27], v[148:151], v[84:87]
    v_mfma_f32_16x16x32_bf16 v[84:87], a[28:31], v[132:135], v[84:87]
    buffer_load_dwordx4 v233, s[40:43], s59 offen offset:1024 lds
    s_add_u32 m0, s61, 0xc000
    v_mfma_f32_16x16x32_bf16 v[80:83], a[24:27], v[144:147], v[80:83]
    s_add_u32 s59, s59, 0x10000
    s_add_u32 s59, s59, s10
    v_mfma_f32_16x16x32_bf16 v[80:83], a[28:31], v[128:131], v[80:83]
    s_waitcnt lgkmcnt(14)
    ds_read_b64_tr_b16 a[24:25], v218 offset:32768
    ds_read_b64_tr_b16 a[26:27], v218 offset:36864
    v_mfma_f32_16x16x32_bf16 v[96:99], a[176:179], v[144:147], v[96:99]
    s_waitcnt lgkmcnt(14)
    v_mfma_f32_16x16x32_bf16 v[96:99], a[180:183], v[128:131], v[96:99]
    buffer_load_dwordx4 a[160:163], v252, s[36:39], s58 offen offset:0 sc1
    v_mfma_f32_16x16x32_bf16 v[100:103], a[176:179], v[148:151], v[100:103]
    v_mfma_f32_16x16x32_bf16 v[100:103], a[180:183], v[132:135], v[100:103]
    ds_read_b64_tr_b16 a[28:29], v218 offset:40960
    ds_read_b64_tr_b16 a[30:31], v218 offset:45056
    v_mfma_f32_16x16x32_bf16 v[104:107], a[176:179], v[152:155], v[104:107]
    v_mfma_f32_16x16x32_bf16 v[104:107], a[180:183], v[136:139], v[104:107]
    buffer_load_dwordx4 a[164:167], v252, s[36:39], s58 offen offset:1024 sc1
    v_mfma_f32_16x16x32_bf16 v[108:111], a[176:179], v[156:159], v[108:111]
    v_mfma_f32_16x16x32_bf16 v[108:111], a[180:183], v[140:143], v[108:111]
    s_waitcnt lgkmcnt(14)
    ds_read_b64_tr_b16 a[176:177], v219 offset:32768
    ds_read_b64_tr_b16 a[178:179], v219 offset:36864
    v_mfma_f32_16x16x32_bf16 v[124:127], a[0:3], v[156:159], v[124:127]
    s_waitcnt lgkmcnt(14)
    v_mfma_f32_16x16x32_bf16 v[124:127], a[4:7], v[140:143], v[124:127]
    buffer_load_dwordx4 a[168:171], v252, s[36:39], s58 offen offset:2048 sc1
    v_mfma_f32_16x16x32_bf16 v[120:123], a[0:3], v[152:155], v[120:123]
    v_mfma_f32_16x16x32_bf16 v[120:123], a[4:7], v[136:139], v[120:123]
    ds_read_b64_tr_b16 a[180:181], v219 offset:40960
    ds_read_b64_tr_b16 a[182:183], v219 offset:45056
    v_mfma_f32_16x16x32_bf16 v[116:119], a[0:3], v[148:151], v[116:119]
    v_mfma_f32_16x16x32_bf16 v[116:119], a[4:7], v[132:135], v[116:119]
    buffer_load_dwordx4 a[172:175], v252, s[36:39], s58 offen offset:3072 sc1
    s_add_u32 s58, s58, 0x4000
    v_mfma_f32_16x16x32_bf16 v[112:115], a[0:3], v[144:147], v[112:115]
    v_mfma_f32_16x16x32_bf16 v[112:115], a[4:7], v[128:131], v[112:115]
    s_waitcnt lgkmcnt(14)
    ds_read_b64_tr_b16 a[0:1], v220 offset:32768
    ds_read_b64_tr_b16 a[2:3], v220 offset:36864
    v_mfma_f32_16x16x32_bf16 v[0:3], a[8:11], v[160:163], v[0:3]
    s_waitcnt vmcnt(39) lgkmcnt(14)
    buffer_load_dword v214, v215, s[96:99], 0 offen sc1
    v_mfma_f32_16x16x32_bf16 v[0:3], a[12:15], a[32:35], v[0:3]
    buffer_load_dwordx4 v232, s[40:43], s59 offen lds
    v_mfma_f32_16x16x32_bf16 v[4:7], a[8:11], v[164:167], v[4:7]
    s_waitcnt vmcnt(40)
    s_barrier
    v_mfma_f32_16x16x32_bf16 v[4:7], a[12:15], a[36:39], v[4:7]
    ds_read_b64_tr_b16 a[4:5], v220 offset:40960
    ds_read_b64_tr_b16 a[6:7], v220 offset:45056
    v_mfma_f32_16x16x32_bf16 v[8:11], a[8:11], v[168:171], v[8:11]
    s_waitcnt vmcnt(39)
    v_mfma_f32_16x16x32_bf16 v[8:11], a[12:15], a[40:43], v[8:11]
    buffer_load_dwordx4 v233, s[40:43], s59 offen offset:1024 lds
    s_add_u32 m0, s61, 0xe000
    v_mfma_f32_16x16x32_bf16 v[12:15], a[8:11], v[172:175], v[12:15]
    s_waitcnt vmcnt(39)
    s_sub_u32 s59, s59, s10
    s_add_u32 s59, s59, 0x30000
    v_mfma_f32_16x16x32_bf16 v[12:15], a[12:15], a[44:47], v[12:15]
    s_waitcnt lgkmcnt(14)
    ds_read_b64_tr_b16 a[8:9], v221 offset:32768
    ds_read_b64_tr_b16 a[10:11], v221 offset:36864
    v_mfma_f32_16x16x32_bf16 v[28:31], a[16:19], v[172:175], v[28:31]
    s_waitcnt lgkmcnt(14)
    v_mfma_f32_16x16x32_bf16 v[28:31], a[20:23], a[44:47], v[28:31]
    buffer_load_dwordx4 a[184:187], v252, s[36:39], s58 offen offset:0 sc1
    v_mfma_f32_16x16x32_bf16 v[24:27], a[16:19], v[168:171], v[24:27]
    v_mfma_f32_16x16x32_bf16 v[24:27], a[20:23], a[40:43], v[24:27]
    ds_read_b64_tr_b16 a[12:13], v221 offset:40960
    ds_read_b64_tr_b16 a[14:15], v221 offset:45056
    v_mfma_f32_16x16x32_bf16 v[20:23], a[16:19], v[164:167], v[20:23]
    v_mfma_f32_16x16x32_bf16 v[20:23], a[20:23], a[36:39], v[20:23]
    buffer_load_dwordx4 a[188:191], v252, s[36:39], s58 offen offset:1024 sc1
    v_mfma_f32_16x16x32_bf16 v[16:19], a[16:19], v[160:163], v[16:19]
    v_mfma_f32_16x16x32_bf16 v[16:19], a[20:23], a[32:35], v[16:19]
    s_waitcnt lgkmcnt(14)
    ds_read_b64_tr_b16 a[16:17], v222 offset:32768
    ds_read_b64_tr_b16 a[18:19], v222 offset:36864
    v_mfma_f32_16x16x32_bf16 v[32:35], a[24:27], v[160:163], v[32:35]
    s_waitcnt lgkmcnt(14)
    v_mfma_f32_16x16x32_bf16 v[32:35], a[28:31], a[32:35], v[32:35]
    buffer_load_dwordx4 a[192:195], v252, s[36:39], s58 offen offset:2048 sc1
    v_mfma_f32_16x16x32_bf16 v[36:39], a[24:27], v[164:167], v[36:39]
    v_mfma_f32_16x16x32_bf16 v[36:39], a[28:31], a[36:39], v[36:39]
    ds_read_b64_tr_b16 a[20:21], v222 offset:40960
    ds_read_b64_tr_b16 a[22:23], v222 offset:45056
    v_mfma_f32_16x16x32_bf16 v[40:43], a[24:27], v[168:171], v[40:43]
    v_mfma_f32_16x16x32_bf16 v[40:43], a[28:31], a[40:43], v[40:43]
    buffer_load_dwordx4 a[196:199], v252, s[36:39], s58 offen offset:3072 sc1
    s_add_u32 s58, s58, 0xc000
    v_mfma_f32_16x16x32_bf16 v[44:47], a[24:27], v[172:175], v[44:47]
    v_mfma_f32_16x16x32_bf16 v[44:47], a[28:31], a[44:47], v[44:47]
    s_waitcnt lgkmcnt(14)
    ds_read_b64_tr_b16 a[24:25], v223 offset:32768
    ds_read_b64_tr_b16 a[26:27], v223 offset:36864
    v_mfma_f32_16x16x32_bf16 v[60:63], a[176:179], v[172:175], v[60:63]
    s_waitcnt lgkmcnt(14)
    v_mfma_f32_16x16x32_bf16 v[60:63], a[180:183], a[44:47], v[60:63]
    buffer_load_dwordx4 v232, s[40:43], s59 offen lds
    v_mfma_f32_16x16x32_bf16 v[56:59], a[176:179], v[168:171], v[56:59]
    v_mfma_f32_16x16x32_bf16 v[56:59], a[180:183], a[40:43], v[56:59]
    ds_read_b64_tr_b16 a[28:29], v223 offset:40960
    ds_read_b64_tr_b16 a[30:31], v223 offset:45056
    v_mfma_f32_16x16x32_bf16 v[52:55], a[176:179], v[164:167], v[52:55]
    v_mfma_f32_16x16x32_bf16 v[52:55], a[180:183], a[36:39], v[52:55]
    buffer_load_dwordx4 v233, s[40:43], s59 offen offset:1024 lds
    s_add_u32 m0, s61, 0x10000
    v_mfma_f32_16x16x32_bf16 v[48:51], a[176:179], v[160:163], v[48:51]
    v_mfma_f32_16x16x32_bf16 v[48:51], a[180:183], a[32:35], v[48:51]
    s_waitcnt lgkmcnt(14)
    ds_read_b64_tr_b16 a[176:177], v216 offset:49152
    ds_read_b64_tr_b16 a[178:179], v216 offset:53248
    v_mfma_f32_16x16x32_bf16 v[64:67], a[0:3], v[160:163], v[64:67]
    s_waitcnt lgkmcnt(14)
    v_mfma_f32_16x16x32_bf16 v[64:67], a[4:7], a[32:35], v[64:67]
    buffer_load_dwordx4 a[200:203], v252, s[36:39], s58 offen offset:0 sc1
    v_mfma_f32_16x16x32_bf16 v[68:71], a[0:3], v[164:167], v[68:71]
    v_mfma_f32_16x16x32_bf16 v[68:71], a[4:7], a[36:39], v[68:71]
    ds_read_b64_tr_b16 a[180:181], v216 offset:57344
    ds_read_b64_tr_b16 a[182:183], v216 offset:61440
    v_mfma_f32_16x16x32_bf16 v[72:75], a[0:3], v[168:171], v[72:75]
    v_mfma_f32_16x16x32_bf16 v[72:75], a[4:7], a[40:43], v[72:75]
    buffer_load_dwordx4 a[204:207], v252, s[36:39], s58 offen offset:1024 sc1
    v_mfma_f32_16x16x32_bf16 v[76:79], a[0:3], v[172:175], v[76:79]
    v_mfma_f32_16x16x32_bf16 v[76:79], a[4:7], a[44:47], v[76:79]
    s_waitcnt lgkmcnt(14)
    ds_read_b64_tr_b16 a[0:1], v217 offset:49152
    ds_read_b64_tr_b16 a[2:3], v217 offset:53248
    v_mfma_f32_16x16x32_bf16 v[92:95], a[8:11], v[172:175], v[92:95]
    s_waitcnt lgkmcnt(14)
    v_mfma_f32_16x16x32_bf16 v[92:95], a[12:15], a[44:47], v[92:95]
    buffer_load_dwordx4 a[208:211], v252, s[36:39], s58 offen offset:2048 sc1
    v_mfma_f32_16x16x32_bf16 v[88:91], a[8:11], v[168:171], v[88:91]
    v_mfma_f32_16x16x32_bf16 v[88:91], a[12:15], a[40:43], v[88:91]
    ds_read_b64_tr_b16 a[4:5], v217 offset:57344
    ds_read_b64_tr_b16 a[6:7], v217 offset:61440
    v_mfma_f32_16x16x32_bf16 v[84:87], a[8:11], v[164:167], v[84:87]
    v_mfma_f32_16x16x32_bf16 v[84:87], a[12:15], a[36:39], v[84:87]
    buffer_load_dwordx4 a[212:215], v252, s[36:39], s58 offen offset:3072 sc1
    v_mfma_f32_16x16x32_bf16 v[80:83], a[8:11], v[160:163], v[80:83]
    v_mfma_f32_16x16x32_bf16 v[80:83], a[12:15], a[32:35], v[80:83]
    s_waitcnt lgkmcnt(14)
    ds_read_b64_tr_b16 a[8:9], v218 offset:49152
    ds_read_b64_tr_b16 a[10:11], v218 offset:53248
    v_mfma_f32_16x16x32_bf16 v[96:99], a[16:19], v[160:163], v[96:99]
    s_waitcnt lgkmcnt(14)
    s_lshl_b32 s59, s52, 16
    s_add_u32 s40, s20, s62
    s_addc_u32 s41, s21, 0
    s_and_b32 s41, s41, 0xffff
    s_sub_u32 s42, 0x200000, s62
    v_mfma_f32_16x16x32_bf16 v[96:99], a[20:23], a[32:35], v[96:99]
    buffer_load_dwordx4 v232, s[40:43], s59 offen lds
    v_mfma_f32_16x16x32_bf16 v[100:103], a[16:19], v[164:167], v[100:103]
    v_mfma_f32_16x16x32_bf16 v[100:103], a[20:23], a[36:39], v[100:103]
    ds_read_b64_tr_b16 a[12:13], v218 offset:57344
    ds_read_b64_tr_b16 a[14:15], v218 offset:61440
    v_mfma_f32_16x16x32_bf16 v[104:107], a[16:19], v[168:171], v[104:107]
    v_mfma_f32_16x16x32_bf16 v[104:107], a[20:23], a[40:43], v[104:107]
    buffer_load_dwordx4 v233, s[40:43], s59 offen offset:1024 lds
    s_add_u32 m0, s61, 0x12000
    v_mfma_f32_16x16x32_bf16 v[108:111], a[16:19], v[172:175], v[108:111]
    s_xor_b32 s59, s59, 0x10000
    v_mfma_f32_16x16x32_bf16 v[108:111], a[20:23], a[44:47], v[108:111]
    s_waitcnt lgkmcnt(14)
    ds_read_b64_tr_b16 a[16:17], v219 offset:49152
    ds_read_b64_tr_b16 a[18:19], v219 offset:53248
    v_mfma_f32_16x16x32_bf16 v[124:127], a[24:27], v[172:175], v[124:127]
    s_waitcnt lgkmcnt(14)
    v_mfma_f32_16x16x32_bf16 v[124:127], a[28:31], a[44:47], v[124:127]
    s_mov_b32 s58, s57
    buffer_load_dwordx4 v[144:147], v252, s[36:39], s58 offen offset:0 sc1
    v_mfma_f32_16x16x32_bf16 v[120:123], a[24:27], v[168:171], v[120:123]
    v_mfma_f32_16x16x32_bf16 v[120:123], a[28:31], a[40:43], v[120:123]
    ds_read_b64_tr_b16 a[20:21], v219 offset:57344
    ds_read_b64_tr_b16 a[22:23], v219 offset:61440
    v_mfma_f32_16x16x32_bf16 v[116:119], a[24:27], v[164:167], v[116:119]
    v_mfma_f32_16x16x32_bf16 v[116:119], a[28:31], a[36:39], v[116:119]
    buffer_load_dwordx4 v[148:151], v252, s[36:39], s58 offen offset:1024 sc1
    v_mfma_f32_16x16x32_bf16 v[112:115], a[24:27], v[160:163], v[112:115]
    v_mfma_f32_16x16x32_bf16 v[112:115], a[28:31], a[32:35], v[112:115]
    s_waitcnt vmcnt(52) lgkmcnt(14)
    ds_read_b64_tr_b16 a[24:25], v220 offset:49152
    ds_read_b64_tr_b16 a[26:27], v220 offset:53248
    v_mfma_f32_16x16x32_bf16 v[0:3], a[176:179], a[48:51], v[0:3]
    s_waitcnt vmcnt(48) lgkmcnt(14)
    v_mfma_f32_16x16x32_bf16 v[0:3], a[180:183], a[64:67], v[0:3]
    buffer_load_dwordx4 v[152:155], v252, s[36:39], s58 offen offset:2048 sc1
    v_mfma_f32_16x16x32_bf16 v[4:7], a[176:179], a[52:55], v[4:7]
    s_waitcnt vmcnt(48)
    s_barrier
    v_mfma_f32_16x16x32_bf16 v[4:7], a[180:183], a[68:71], v[4:7]
    ds_read_b64_tr_b16 a[28:29], v220 offset:57344
    ds_read_b64_tr_b16 a[30:31], v220 offset:61440
    v_mfma_f32_16x16x32_bf16 v[8:11], a[176:179], a[56:59], v[8:11]
    s_waitcnt vmcnt(47)
    v_mfma_f32_16x16x32_bf16 v[8:11], a[180:183], a[72:75], v[8:11]
    buffer_load_dwordx4 v[156:159], v252, s[36:39], s58 offen offset:3072 sc1
    s_xor_b32 s58, s58, 0x4000
    v_mfma_f32_16x16x32_bf16 v[12:15], a[176:179], a[60:63], v[12:15]
    s_waitcnt vmcnt(47)
    v_mfma_f32_16x16x32_bf16 v[12:15], a[180:183], a[76:79], v[12:15]
    s_waitcnt lgkmcnt(14)
    ds_read_b64_tr_b16 a[176:177], v221 offset:49152
    ds_read_b64_tr_b16 a[178:179], v221 offset:53248
    v_mfma_f32_16x16x32_bf16 v[28:31], a[0:3], a[60:63], v[28:31]
    s_waitcnt lgkmcnt(14)
    v_mfma_f32_16x16x32_bf16 v[28:31], a[4:7], a[76:79], v[28:31]
    buffer_load_dwordx4 v232, s[40:43], s59 offen lds
    v_mfma_f32_16x16x32_bf16 v[24:27], a[0:3], a[56:59], v[24:27]
    v_mfma_f32_16x16x32_bf16 v[24:27], a[4:7], a[72:75], v[24:27]
    ds_read_b64_tr_b16 a[180:181], v221 offset:57344
    ds_read_b64_tr_b16 a[182:183], v221 offset:61440
    v_mfma_f32_16x16x32_bf16 v[20:23], a[0:3], a[52:55], v[20:23]
    v_mfma_f32_16x16x32_bf16 v[20:23], a[4:7], a[68:71], v[20:23]
    buffer_load_dwordx4 v233, s[40:43], s59 offen offset:1024 lds
    s_add_u32 m0, s61, 0x14000
    v_mfma_f32_16x16x32_bf16 v[16:19], a[0:3], a[48:51], v[16:19]
    s_xor_b32 s59, s59, 0x30000
    v_mfma_f32_16x16x32_bf16 v[16:19], a[4:7], a[64:67], v[16:19]
    s_waitcnt lgkmcnt(14)
    ds_read_b64_tr_b16 a[0:1], v222 offset:49152
    ds_read_b64_tr_b16 a[2:3], v222 offset:53248
    v_mfma_f32_16x16x32_bf16 v[32:35], a[8:11], a[48:51], v[32:35]
    s_waitcnt lgkmcnt(14)
    v_mfma_f32_16x16x32_bf16 v[32:35], a[12:15], a[64:67], v[32:35]
    buffer_load_dwordx4 v232, s[40:43], s59 offen lds
    v_mfma_f32_16x16x32_bf16 v[36:39], a[8:11], a[52:55], v[36:39]
    v_mfma_f32_16x16x32_bf16 v[36:39], a[12:15], a[68:71], v[36:39]
    ds_read_b64_tr_b16 a[4:5], v222 offset:57344
    ds_read_b64_tr_b16 a[6:7], v222 offset:61440
    v_mfma_f32_16x16x32_bf16 v[40:43], a[8:11], a[56:59], v[40:43]
    v_mfma_f32_16x16x32_bf16 v[40:43], a[12:15], a[72:75], v[40:43]
    buffer_load_dwordx4 v233, s[40:43], s59 offen offset:1024 lds
    s_add_u32 m0, s61, 0x16000
    v_mfma_f32_16x16x32_bf16 v[44:47], a[8:11], a[60:63], v[44:47]
    s_xor_b32 s59, s59, 0x10000
    v_mfma_f32_16x16x32_bf16 v[44:47], a[12:15], a[76:79], v[44:47]
    s_waitcnt lgkmcnt(14)
    ds_read_b64_tr_b16 a[8:9], v223 offset:49152
    ds_read_b64_tr_b16 a[10:11], v223 offset:53248
    v_mfma_f32_16x16x32_bf16 v[60:63], a[16:19], a[60:63], v[60:63]
    s_waitcnt lgkmcnt(14)
    v_mfma_f32_16x16x32_bf16 v[60:63], a[20:23], a[76:79], v[60:63]
    buffer_load_dwordx4 v232, s[40:43], s59 offen lds
    v_mfma_f32_16x16x32_bf16 v[56:59], a[16:19], a[56:59], v[56:59]
    v_mfma_f32_16x16x32_bf16 v[56:59], a[20:23], a[72:75], v[56:59]
    ds_read_b64_tr_b16 a[12:13], v223 offset:57344
    ds_read_b64_tr_b16 a[14:15], v223 offset:61440
    v_mfma_f32_16x16x32_bf16 v[52:55], a[16:19], a[52:55], v[52:55]
    v_mfma_f32_16x16x32_bf16 v[52:55], a[20:23], a[68:71], v[52:55]
    buffer_load_dwordx4 v233, s[40:43], s59 offen offset:1024 lds
    s_add_u32 m0, s61, 0x18000
    v_mfma_f32_16x16x32_bf16 v[48:51], a[16:19], a[48:51], v[48:51]
    s_xor_b32 s59, s59, 0x70000
    v_mfma_f32_16x16x32_bf16 v[48:51], a[20:23], a[64:67], v[48:51]
    s_waitcnt lgkmcnt(14)
    ds_read_b64_tr_b16 a[16:17], v224 offset:0
    ds_read_b64_tr_b16 a[18:19], v224 offset:4096
    v_mfma_f32_16x16x32_bf16 v[64:67], a[24:27], a[48:51], v[64:67]
    s_waitcnt lgkmcnt(14)
    v_mfma_f32_16x16x32_bf16 v[64:67], a[28:31], a[64:67], v[64:67]
    buffer_load_dwordx4 v[128:131], v252, s[36:39], s58 offen offset:0 sc1
    v_mfma_f32_16x16x32_bf16 v[68:71], a[24:27], a[52:55], v[68:71]
    v_mfma_f32_16x16x32_bf16 v[68:71], a[28:31], a[68:71], v[68:71]
    ds_read_b64_tr_b16 a[20:21], v224 offset:8192
    ds_read_b64_tr_b16 a[22:23], v224 offset:12288
    v_mfma_f32_16x16x32_bf16 v[72:75], a[24:27], a[56:59], v[72:75]
    v_mfma_f32_16x16x32_bf16 v[72:75], a[28:31], a[72:75], v[72:75]
    buffer_load_dwordx4 v[132:135], v252, s[36:39], s58 offen offset:1024 sc1
    v_mfma_f32_16x16x32_bf16 v[76:79], a[24:27], a[60:63], v[76:79]
    v_mfma_f32_16x16x32_bf16 v[76:79], a[28:31], a[76:79], v[76:79]
    s_waitcnt lgkmcnt(14)
    ds_read_b64_tr_b16 a[24:25], v225 offset:0
    ds_read_b64_tr_b16 a[26:27], v225 offset:4096
    v_mfma_f32_16x16x32_bf16 v[92:95], a[176:179], a[60:63], v[92:95]
    s_waitcnt lgkmcnt(14)
    v_mfma_f32_16x16x32_bf16 v[92:95], a[180:183], a[76:79], v[92:95]
    buffer_load_dwordx4 v[136:139], v252, s[36:39], s58 offen offset:2048 sc1
    v_mfma_f32_16x16x32_bf16 v[88:91], a[176:179], a[56:59], v[88:91]
    v_mfma_f32_16x16x32_bf16 v[88:91], a[180:183], a[72:75], v[88:91]
    ds_read_b64_tr_b16 a[28:29], v225 offset:8192
    ds_read_b64_tr_b16 a[30:31], v225 offset:12288
    v_mfma_f32_16x16x32_bf16 v[84:87], a[176:179], a[52:55], v[84:87]
    v_mfma_f32_16x16x32_bf16 v[84:87], a[180:183], a[68:71], v[84:87]
    buffer_load_dwordx4 v[140:143], v252, s[36:39], s58 offen offset:3072 sc1
    s_xor_b32 s58, s58, 0xc000
    v_mfma_f32_16x16x32_bf16 v[80:83], a[176:179], a[48:51], v[80:83]
    v_mfma_f32_16x16x32_bf16 v[80:83], a[180:183], a[64:67], v[80:83]
    s_waitcnt lgkmcnt(14)
    ds_read_b64_tr_b16 a[176:177], v226 offset:0
    ds_read_b64_tr_b16 a[178:179], v226 offset:4096
    v_mfma_f32_16x16x32_bf16 v[96:99], a[0:3], a[48:51], v[96:99]
    s_waitcnt lgkmcnt(14)
    v_mfma_f32_16x16x32_bf16 v[96:99], a[4:7], a[64:67], v[96:99]
    buffer_load_dwordx4 v[160:163], v252, s[36:39], s58 offen offset:0 sc1
    v_mfma_f32_16x16x32_bf16 v[100:103], a[0:3], a[52:55], v[100:103]
    v_mfma_f32_16x16x32_bf16 v[100:103], a[4:7], a[68:71], v[100:103]
    ds_read_b64_tr_b16 a[180:181], v226 offset:8192
    ds_read_b64_tr_b16 a[182:183], v226 offset:12288
    v_mfma_f32_16x16x32_bf16 v[104:107], a[0:3], a[56:59], v[104:107]
    v_mfma_f32_16x16x32_bf16 v[104:107], a[4:7], a[72:75], v[104:107]
    buffer_load_dwordx4 v[164:167], v252, s[36:39], s58 offen offset:1024 sc1
    v_mfma_f32_16x16x32_bf16 v[108:111], a[0:3], a[60:63], v[108:111]
    v_mfma_f32_16x16x32_bf16 v[108:111], a[4:7], a[76:79], v[108:111]
    s_waitcnt lgkmcnt(14)
    ds_read_b64_tr_b16 a[0:1], v227 offset:0
    ds_read_b64_tr_b16 a[2:3], v227 offset:4096
    v_mfma_f32_16x16x32_bf16 v[124:127], a[8:11], a[60:63], v[124:127]
    s_waitcnt lgkmcnt(14)
    v_mfma_f32_16x16x32_bf16 v[124:127], a[12:15], a[76:79], v[124:127]
    buffer_load_dwordx4 v[168:171], v252, s[36:39], s58 offen offset:2048 sc1
    v_mfma_f32_16x16x32_bf16 v[120:123], a[8:11], a[56:59], v[120:123]
    v_mfma_f32_16x16x32_bf16 v[120:123], a[12:15], a[72:75], v[120:123]
    ds_read_b64_tr_b16 a[4:5], v227 offset:8192
    ds_read_b64_tr_b16 a[6:7], v227 offset:12288
    v_mfma_f32_16x16x32_bf16 v[116:119], a[8:11], a[52:55], v[116:119]
    v_mfma_f32_16x16x32_bf16 v[116:119], a[12:15], a[68:71], v[116:119]
    buffer_load_dwordx4 v[172:175], v252, s[36:39], s58 offen offset:3072 sc1
    s_xor_b32 s58, s58, 0x4000
    v_mfma_f32_16x16x32_bf16 v[112:115], a[8:11], a[48:51], v[112:115]
    v_mfma_f32_16x16x32_bf16 v[112:115], a[12:15], a[64:67], v[112:115]
    s_waitcnt vmcnt(60) lgkmcnt(14)
    ds_read_b64_tr_b16 a[8:9], v228 offset:0
    ds_read_b64_tr_b16 a[10:11], v228 offset:4096
    v_mfma_f32_16x16x32_bf16 v[0:3], a[16:19], a[80:83], v[0:3]
    s_waitcnt vmcnt(56) lgkmcnt(14)
    v_mfma_f32_16x16x32_bf16 v[0:3], a[20:23], a[96:99], v[0:3]
    buffer_load_dwordx4 a[32:35], v252, s[36:39], s58 offen offset:0 sc1
    v_mfma_f32_16x16x32_bf16 v[4:7], a[16:19], a[84:87], v[4:7]
    s_waitcnt vmcnt(56)
    s_waitcnt vmcnt(21)
    s_barrier
    s_cmp_eq_u32 s50, 0
    s_cbranch_scc0 L_nf_r
    v_mov_b32 v255, s88
    s_mov_b64 exec, 1
    buffer_store_dword v255, v252, s[44:47], s15 offen offset:12 sc1
    s_mov_b64 exec, -1
L_nf_r:
    v_mfma_f32_16x16x32_bf16 v[4:7], a[20:23], a[100:103], v[4:7]
    ds_read_b64_tr_b16 a[12:13], v228 offset:8192
    ds_read_b64_tr_b16 a[14:15], v228 offset:12288
    v_mfma_f32_16x16x32_bf16 v[8:11], a[16:19], a[88:91], v[8:11]
    v_mfma_f32_16x16x32_bf16 v[8:11], a[20:23], a[104:107], v[8:11]
    buffer_load_dwordx4 v232, s[40:43], s59 offen lds
    v_mfma_f32_16x16x32_bf16 v[12:15], a[16:19], a[92:95], v[12:15]
    v_mfma_f32_16x16x32_bf16 v[12:15], a[20:23], a[108:111], v[12:15]
    s_waitcnt lgkmcnt(14)
    ds_read_b64_tr_b16 a[16:17], v229 offset:0
    ds_read_b64_tr_b16 a[18:19], v229 offset:4096
    v_mfma_f32_16x16x32_bf16 v[28:31], a[24:27], a[92:95], v[28:31]
    s_waitcnt lgkmcnt(14)
    v_mfma_f32_16x16x32_bf16 v[28:31], a[28:31], a[108:111], v[28:31]
    buffer_load_dwordx4 v233, s[40:43], s59 offen offset:1024 lds
    s_add_u32 m0, s61, 0x1a000
    v_mfma_f32_16x16x32_bf16 v[24:27], a[24:27], a[88:91], v[24:27]
    s_xor_b32 s59, s59, 0x10000
    v_mfma_f32_16x16x32_bf16 v[24:27], a[28:31], a[104:107], v[24:27]
    ds_read_b64_tr_b16 a[20:21], v229 offset:8192
    ds_read_b64_tr_b16 a[22:23], v229 offset:12288
    v_mfma_f32_16x16x32_bf16 v[20:23], a[24:27], a[84:87], v[20:23]
    v_mfma_f32_16x16x32_bf16 v[20:23], a[28:31], a[100:103], v[20:23]
    buffer_load_dwordx4 v232, s[40:43], s59 offen lds
    v_mfma_f32_16x16x32_bf16 v[16:19], a[24:27], a[80:83], v[16:19]
    v_mfma_f32_16x16x32_bf16 v[16:19], a[28:31], a[96:99], v[16:19]
    s_waitcnt lgkmcnt(14)
    ds_read_b64_tr_b16 a[24:25], v230 offset:0
    ds_read_b64_tr_b16 a[26:27], v230 offset:4096
    v_mfma_f32_16x16x32_bf16 v[32:35], a[176:179], a[80:83], v[32:35]
    s_waitcnt lgkmcnt(14)
    v_mfma_f32_16x16x32_bf16 v[32:35], a[180:183], a[96:99], v[32:35]
    buffer_load_dwordx4 v233, s[40:43], s59 offen offset:1024 lds
    s_add_u32 m0, s61, 0x1c000
    v_mfma_f32_16x16x32_bf16 v[36:39], a[176:179], a[84:87], v[36:39]
    s_xor_b32 s59, s59, 0x30000
    v_mfma_f32_16x16x32_bf16 v[36:39], a[180:183], a[100:103], v[36:39]
    ds_read_b64_tr_b16 a[28:29], v230 offset:8192
    ds_read_b64_tr_b16 a[30:31], v230 offset:12288
    v_mfma_f32_16x16x32_bf16 v[40:43], a[176:179], a[88:91], v[40:43]
    v_mfma_f32_16x16x32_bf16 v[40:43], a[180:183], a[104:107], v[40:43]
    buffer_load_dwordx4 a[36:39], v252, s[36:39], s58 offen offset:1024 sc1
    v_mfma_f32_16x16x32_bf16 v[44:47], a[176:179], a[92:95], v[44:47]
    v_mfma_f32_16x16x32_bf16 v[44:47], a[180:183], a[108:111], v[44:47]
    s_waitcnt lgkmcnt(14)
    ds_read_b64_tr_b16 a[176:177], v231 offset:0
    ds_read_b64_tr_b16 a[178:179], v231 offset:4096
    v_mfma_f32_16x16x32_bf16 v[60:63], a[0:3], a[92:95], v[60:63]
    s_waitcnt lgkmcnt(14)
    v_mfma_f32_16x16x32_bf16 v[60:63], a[4:7], a[108:111], v[60:63]
    buffer_load_dwordx4 a[40:43], v252, s[36:39], s58 offen offset:2048 sc1
    v_mfma_f32_16x16x32_bf16 v[56:59], a[0:3], a[88:91], v[56:59]
    v_mfma_f32_16x16x32_bf16 v[56:59], a[4:7], a[104:107], v[56:59]
    ds_read_b64_tr_b16 a[180:181], v231 offset:8192
    ds_read_b64_tr_b16 a[182:183], v231 offset:12288
    v_mfma_f32_16x16x32_bf16 v[52:55], a[0:3], a[84:87], v[52:55]
    v_mfma_f32_16x16x32_bf16 v[52:55], a[4:7], a[100:103], v[52:55]
    buffer_load_dwordx4 a[44:47], v252, s[36:39], s58 offen offset:3072 sc1
    s_xor_b32 s58, s58, 0x1c000
    v_mfma_f32_16x16x32_bf16 v[48:51], a[0:3], a[80:83], v[48:51]
    v_mfma_f32_16x16x32_bf16 v[48:51], a[4:7], a[96:99], v[48:51]
    s_waitcnt lgkmcnt(14)
    ds_read_b64_tr_b16 a[0:1], v226 offset:16384
    ds_read_b64_tr_b16 a[2:3], v226 offset:20480
    v_mfma_f32_16x16x32_bf16 v[64:67], a[8:11], a[80:83], v[64:67]
    s_waitcnt lgkmcnt(14)
    v_mfma_f32_16x16x32_bf16 v[64:67], a[12:15], a[96:99], v[64:67]
    buffer_load_dwordx4 a[48:51], v252, s[36:39], s58 offen offset:0 sc1
    v_mfma_f32_16x16x32_bf16 v[68:71], a[8:11], a[84:87], v[68:71]
    v_mfma_f32_16x16x32_bf16 v[68:71], a[12:15], a[100:103], v[68:71]
    ds_read_b64_tr_b16 a[4:5], v226 offset:24576
    ds_read_b64_tr_b16 a[6:7], v226 offset:28672
    v_mfma_f32_16x16x32_bf16 v[72:75], a[8:11], a[88:91], v[72:75]
    v_mfma_f32_16x16x32_bf16 v[72:75], a[12:15], a[104:107], v[72:75]
    buffer_load_dwordx4 a[52:55], v252, s[36:39], s58 offen offset:1024 sc1
    v_mfma_f32_16x16x32_bf16 v[76:79], a[8:11], a[92:95], v[76:79]
    v_mfma_f32_16x16x32_bf16 v[76:79], a[12:15], a[108:111], v[76:79]
    s_waitcnt lgkmcnt(14)
    ds_read_b64_tr_b16 a[8:9], v227 offset:16384
    ds_read_b64_tr_b16 a[10:11], v227 offset:20480
    v_mfma_f32_16x16x32_bf16 v[92:95], a[16:19], a[92:95], v[92:95]
    s_waitcnt lgkmcnt(14)
    v_mfma_f32_16x16x32_bf16 v[92:95], a[20:23], a[108:111], v[92:95]
    buffer_load_dwordx4 a[56:59], v252, s[36:39], s58 offen offset:2048 sc1
    v_mfma_f32_16x16x32_bf16 v[88:91], a[16:19], a[88:91], v[88:91]
    v_mfma_f32_16x16x32_bf16 v[88:91], a[20:23], a[104:107], v[88:91]
    ds_read_b64_tr_b16 a[12:13], v227 offset:24576
    ds_read_b64_tr_b16 a[14:15], v227 offset:28672
    v_mfma_f32_16x16x32_bf16 v[84:87], a[16:19], a[84:87], v[84:87]
    v_mfma_f32_16x16x32_bf16 v[84:87], a[20:23], a[100:103], v[84:87]
    buffer_load_dwordx4 a[60:63], v252, s[36:39], s58 offen offset:3072 sc1
    s_xor_b32 s58, s58, 0x4000
    v_mfma_f32_16x16x32_bf16 v[80:83], a[16:19], a[80:83], v[80:83]
    v_mfma_f32_16x16x32_bf16 v[80:83], a[20:23], a[96:99], v[80:83]
    s_waitcnt lgkmcnt(14)
    ds_read_b64_tr_b16 a[16:17], v228 offset:16384
    ds_read_b64_tr_b16 a[18:19], v228 offset:20480
    v_mfma_f32_16x16x32_bf16 v[96:99], a[24:27], a[80:83], v[96:99]
    s_waitcnt lgkmcnt(14)
    v_mfma_f32_16x16x32_bf16 v[96:99], a[28:31], a[96:99], v[96:99]
    buffer_load_dwordx4 a[64:67], v252, s[36:39], s58 offen offset:0 sc1
    v_mfma_f32_16x16x32_bf16 v[100:103], a[24:27], a[84:87], v[100:103]
    v_mfma_f32_16x16x32_bf16 v[100:103], a[28:31], a[100:103], v[100:103]
    ds_read_b64_tr_b16 a[20:21], v228 offset:24576
    ds_read_b64_tr_b16 a[22:23], v228 offset:28672
    v_mfma_f32_16x16x32_bf16 v[104:107], a[24:27], a[88:91], v[104:107]
    v_mfma_f32_16x16x32_bf16 v[104:107], a[28:31], a[104:107], v[104:107]
    buffer_load_dwordx4 a[68:71], v252, s[36:39], s58 offen offset:1024 sc1
    v_mfma_f32_16x16x32_bf16 v[108:111], a[24:27], a[92:95], v[108:111]
    ds_read_b64_tr_b16 a[216:217], v226 offset:32768
    ds_read_b64_tr_b16 a[218:219], v226 offset:36864
    v_mfma_f32_16x16x32_bf16 v[108:111], a[28:31], a[108:111], v[108:111]
    s_waitcnt lgkmcnt(15)
    ds_read_b64_tr_b16 a[24:25], v229 offset:16384
    ds_read_b64_tr_b16 a[26:27], v229 offset:20480
    v_mfma_f32_16x16x32_bf16 v[124:127], a[176:179], a[92:95], v[124:127]
    s_waitcnt lgkmcnt(15)
    v_mfma_f32_16x16x32_bf16 v[124:127], a[180:183], a[108:111], v[124:127]
    buffer_load_dwordx4 a[72:75], v252, s[36:39], s58 offen offset:2048 sc1
    v_mfma_f32_16x16x32_bf16 v[120:123], a[176:179], a[88:91], v[120:123]
    ds_read_b64_tr_b16 a[220:221], v226 offset:40960
    ds_read_b64_tr_b16 a[222:223], v226 offset:45056
    v_mfma_f32_16x16x32_bf16 v[120:123], a[180:183], a[104:107], v[120:123]
    ds_read_b64_tr_b16 a[28:29], v229 offset:24576
    ds_read_b64_tr_b16 a[30:31], v229 offset:28672
    v_mfma_f32_16x16x32_bf16 v[116:119], a[176:179], a[84:87], v[116:119]
    v_mfma_f32_16x16x32_bf16 v[116:119], a[180:183], a[100:103], v[116:119]
    buffer_load_dwordx4 a[76:79], v252, s[36:39], s58 offen offset:3072 sc1
    s_xor_b32 s58, s58, 0xc000
    v_mfma_f32_16x16x32_bf16 v[112:115], a[176:179], a[80:83], v[112:115]
    ds_read_b64_tr_b16 a[224:225], v218 offset:0
    ds_read_b64_tr_b16 a[226:227], v218 offset:4096
    v_mfma_f32_16x16x32_bf16 v[112:115], a[180:183], a[96:99], v[112:115]
    s_waitcnt lgkmcnt(15)
    ds_read_b64_tr_b16 a[176:177], v230 offset:16384
    ds_read_b64_tr_b16 a[178:179], v230 offset:20480
    v_mfma_f32_16x16x32_bf16 v[32:35], a[0:3], a[112:115], v[32:35]
    ds_read_b64_tr_b16 a[228:229], v218 offset:8192
    ds_read_b64_tr_b16 a[230:231], v218 offset:12288
    v_mfma_f32_16x16x32_bf16 v[32:35], a[4:7], a[128:131], v[32:35]
    buffer_load_dwordx4 a[80:83], v252, s[36:39], s58 offen offset:0 sc1
    v_mfma_f32_16x16x32_bf16 v[36:39], a[0:3], a[116:119], v[36:39]
    s_waitcnt vmcnt(12)
    s_barrier
    v_mfma_f32_16x16x32_bf16 v[36:39], a[4:7], a[132:135], v[36:39]
    ds_read_b64_tr_b16 a[180:181], v230 offset:24576
    ds_read_b64_tr_b16 a[182:183], v230 offset:28672
    v_mfma_f32_16x16x32_bf16 v[40:43], a[0:3], a[120:123], v[40:43]
    v_mfma_f32_16x16x32_bf16 v[40:43], a[4:7], a[136:139], v[40:43]
    buffer_load_dwordx4 v232, s[40:43], s59 offen lds
    v_mfma_f32_16x16x32_bf16 v[44:47], a[0:3], a[124:127], v[44:47]
    ds_read_b64_tr_b16 a[232:233], v227 offset:32768
    ds_read_b64_tr_b16 a[234:235], v227 offset:36864
    v_mfma_f32_16x16x32_bf16 v[44:47], a[4:7], a[140:143], v[44:47]
    ds_read_b64_tr_b16 a[0:1], v231 offset:16384
    ds_read_b64_tr_b16 a[2:3], v231 offset:20480
    v_mfma_f32_16x16x32_bf16 v[60:63], a[8:11], a[124:127], v[60:63]
    s_waitcnt lgkmcnt(15)
    v_mfma_f32_16x16x32_bf16 v[60:63], a[12:15], a[140:143], v[60:63]
    buffer_load_dwordx4 v233, s[40:43], s59 offen offset:1024 lds
    s_add_u32 m0, s61, 0x1e000
    v_mfma_f32_16x16x32_bf16 v[56:59], a[8:11], a[120:123], v[56:59]
    s_xor_b32 s59, s59, 0x10000
    ds_read_b64_tr_b16 a[236:237], v227 offset:40960
    ds_read_b64_tr_b16 a[238:239], v227 offset:45056
    v_mfma_f32_16x16x32_bf16 v[56:59], a[12:15], a[136:139], v[56:59]
    ds_read_b64_tr_b16 a[4:5], v231 offset:24576
    ds_read_b64_tr_b16 a[6:7], v231 offset:28672
    v_mfma_f32_16x16x32_bf16 v[52:55], a[8:11], a[116:119], v[52:55]
    v_mfma_f32_16x16x32_bf16 v[52:55], a[12:15], a[132:135], v[52:55]
    buffer_load_dwordx4 v232, s[40:43], s59 offen lds
    v_mfma_f32_16x16x32_bf16 v[48:51], a[8:11], a[112:115], v[48:51]
    v_mfma_f32_16x16x32_bf16 v[48:51], a[12:15], a[128:131], v[48:51]
    ds_read_b64_tr_b16 a[240:241], v219 offset:0
    ds_read_b64_tr_b16 a[242:243], v219 offset:4096
    v_mfma_f32_16x16x32_bf16 v[64:67], a[16:19], a[112:115], v[64:67]
    v_mfma_f32_16x16x32_bf16 v[64:67], a[20:23], a[128:131], v[64:67]
    buffer_load_dwordx4 v233, s[40:43], s59 offen offset:1024 lds
    v_mfma_f32_16x16x32_bf16 v[68:71], a[16:19], a[116:119], v[68:71]
    v_mfma_f32_16x16x32_bf16 v[68:71], a[20:23], a[132:135], v[68:71]
    ds_read_b64_tr_b16 a[244:245], v219 offset:8192
    ds_read_b64_tr_b16 a[246:247], v219 offset:12288
    v_mfma_f32_16x16x32_bf16 v[72:75], a[16:19], a[120:123], v[72:75]
    v_mfma_f32_16x16x32_bf16 v[72:75], a[20:23], a[136:139], v[72:75]
    buffer_load_dwordx4 a[84:87], v252, s[36:39], s58 offen offset:1024 sc1
    v_mfma_f32_16x16x32_bf16 v[76:79], a[16:19], a[124:127], v[76:79]
    v_mfma_f32_16x16x32_bf16 v[76:79], a[20:23], a[140:143], v[76:79]
    ds_read_b64_tr_b16 a[248:249], v218 offset:16384
    ds_read_b64_tr_b16 a[250:251], v218 offset:20480
    v_mfma_f32_16x16x32_bf16 v[92:95], a[24:27], a[124:127], v[92:95]
    s_waitcnt lgkmcnt(15)
    v_mfma_f32_16x16x32_bf16 v[92:95], a[28:31], a[140:143], v[92:95]
    buffer_load_dwordx4 a[88:91], v252, s[36:39], s58 offen offset:2048 sc1
    v_mfma_f32_16x16x32_bf16 v[88:91], a[24:27], a[120:123], v[88:91]
    v_mfma_f32_16x16x32_bf16 v[88:91], a[28:31], a[136:139], v[88:91]
    ds_read_b64_tr_b16 a[252:253], v218 offset:24576
    ds_read_b64_tr_b16 a[254:255], v218 offset:28672
    v_mfma_f32_16x16x32_bf16 v[84:87], a[24:27], a[116:119], v[84:87]
    v_mfma_f32_16x16x32_bf16 v[84:87], a[28:31], a[132:135], v[84:87]
    buffer_load_dwordx4 a[92:95], v252, s[36:39], s58 offen offset:3072 sc1
    s_xor_b32 s58, s58, 0x4000
    v_mfma_f32_16x16x32_bf16 v[80:83], a[24:27], a[112:115], v[80:83]
    v_mfma_f32_16x16x32_bf16 v[80:83], a[28:31], a[128:131], v[80:83]
    ds_read_b64_tr_b16 v[176:177], v218 offset:32768
    ds_read_b64_tr_b16 v[178:179], v218 offset:36864
    v_mfma_f32_16x16x32_bf16 v[96:99], a[176:179], a[112:115], v[96:99]
    s_waitcnt lgkmcnt(15)
    v_mfma_f32_16x16x32_bf16 v[96:99], a[180:183], a[128:131], v[96:99]
    buffer_load_dwordx4 a[96:99], v252, s[36:39], s58 offen offset:0 sc1
    v_mfma_f32_16x16x32_bf16 v[100:103], a[176:179], a[116:119], v[100:103]
    s_add_u32 s93, s87, 12
    buffer_load_dword v254, v253, s[44:47], s93 offen sc1
    v_mfma_f32_16x16x32_bf16 v[100:103], a[180:183], a[132:135], v[100:103]
    ds_read_b64_tr_b16 v[180:181], v218 offset:40960
    ds_read_b64_tr_b16 v[182:183], v218 offset:45056
    v_mfma_f32_16x16x32_bf16 v[104:107], a[176:179], a[120:123], v[104:107]
    v_mfma_f32_16x16x32_bf16 v[104:107], a[180:183], a[136:139], v[104:107]
    buffer_load_dwordx4 a[100:103], v252, s[36:39], s58 offen offset:1024 sc1
    v_mfma_f32_16x16x32_bf16 v[108:111], a[176:179], a[124:127], v[108:111]
    v_mfma_f32_16x16x32_bf16 v[108:111], a[180:183], a[140:143], v[108:111]
    s_waitcnt lgkmcnt(15)
    ds_read_b64_tr_b16 v[184:185], v218 offset:49152
    ds_read_b64_tr_b16 v[186:187], v218 offset:53248
    v_mfma_f32_16x16x32_bf16 v[124:127], a[0:3], a[124:127], v[124:127]
    s_waitcnt lgkmcnt(14)
    v_mfma_f32_16x16x32_bf16 v[124:127], a[4:7], a[140:143], v[124:127]
    buffer_load_dwordx4 a[104:107], v252, s[36:39], s58 offen offset:2048 sc1
    v_mfma_f32_16x16x32_bf16 v[120:123], a[0:3], a[120:123], v[120:123]
    v_mfma_f32_16x16x32_bf16 v[120:123], a[4:7], a[136:139], v[120:123]
    ds_read_b64_tr_b16 v[188:189], v218 offset:57344
    ds_read_b64_tr_b16 v[190:191], v218 offset:61440
    v_mfma_f32_16x16x32_bf16 v[116:119], a[0:3], a[116:119], v[116:119]
    v_mfma_f32_16x16x32_bf16 v[116:119], a[4:7], a[132:135], v[116:119]
    buffer_load_dwordx4 a[108:111], v252, s[36:39], s58 offen offset:3072 sc1
    v_mfma_f32_16x16x32_bf16 v[112:115], a[0:3], a[112:115], v[112:115]
    v_mfma_f32_16x16x32_bf16 v[112:115], a[4:7], a[128:131], v[112:115]
    ds_read_b64_tr_b16 v[192:193], v219 offset:16384
    ds_read_b64_tr_b16 v[194:195], v219 offset:20480
    s_mul_i32 s3, s51, 0x70000
    v_mfma_f32_16x16x32_bf16 v[32:35], a[216:219], a[144:147], v[32:35]
    s_sub_u32 s67, s85, s3
    v_mfma_f32_16x16x32_bf16 v[32:35], a[220:223], a[160:163], v[32:35]
    s_mov_b32 s40, s30
    v_mfma_f32_16x16x32_bf16 v[32:35], a[224:227], a[184:187], v[32:35]
    s_and_b32 s41, s31, 0xffff
    v_mfma_f32_16x16x32_bf16 v[32:35], a[228:231], a[200:203], v[32:35]
    ds_read_b64_tr_b16 v[196:197], v219 offset:24576
    ds_read_b64_tr_b16 v[198:199], v219 offset:28672
    s_mov_b32 s42, 0x400000
    v_mfma_f32_16x16x32_bf16 v[48:51], a[232:235], a[144:147], v[48:51]
    s_lshl_b32 s7, s48, 19
    v_mfma_f32_16x16x32_bf16 v[48:51], a[236:239], a[160:163], v[48:51]
    s_waitcnt lgkmcnt(15)
    s_lshl_b32 s6, s50, 15
    v_mfma_f32_16x16x32_bf16 v[48:51], a[240:243], a[184:187], v[48:51]
    s_add_u32 s7, s7, s6
    v_mfma_f32_16x16x32_bf16 v[48:51], a[244:247], a[200:203], v[48:51]
    ds_read_b64_tr_b16 v[200:201], v219 offset:32768
    ds_read_b64_tr_b16 v[202:203], v219 offset:36864
    s_add_u32 s7, s7, s62
    v_mfma_f32_16x16x32_bf16 v[36:39], a[216:219], a[148:151], v[36:39]
    s_lshl_b32 s6, s51, 6
    v_mul_f32 v32, v32, v245
    v_mfma_f32_16x16x32_bf16 v[36:39], a[220:223], a[164:167], v[36:39]
    s_add_u32 s7, s7, s6
    v_mul_f32 v33, v33, v245
    v_mfma_f32_16x16x32_bf16 v[36:39], a[224:227], a[188:191], v[36:39]
    v_and_b32 v234, 15, v242
    v_mul_f32 v34, v34, v245
    v_mfma_f32_16x16x32_bf16 v[36:39], a[228:231], a[204:207], v[36:39]
    ds_read_b64_tr_b16 v[204:205], v219 offset:40960
    ds_read_b64_tr_b16 v[206:207], v219 offset:45056
    v_lshlrev_b32 v234, 11, v234
    v_mfma_f32_16x16x32_bf16 v[52:55], a[232:235], a[148:151], v[52:55]
    v_bfe_u32 v243, v242, 4, 1
    v_mul_f32 v35, v35, v245
    v_mfma_f32_16x16x32_bf16 v[52:55], a[236:239], a[164:167], v[52:55]
    v_lshl_add_u32 v234, v243, 5, v234
    v_mul_f32 v48, v48, v245
    v_mfma_f32_16x16x32_bf16 v[52:55], a[240:243], a[188:191], v[52:55]
    v_bfe_u32 v243, v242, 5, 1
    v_mul_f32 v49, v49, v245
    v_mfma_f32_16x16x32_bf16 v[52:55], a[244:247], a[204:207], v[52:55]
    ds_read_b64_tr_b16 v[208:209], v219 offset:49152
    ds_read_b64_tr_b16 v[210:211], v219 offset:53248
    v_lshl_add_u32 v234, v243, 4, v234
    v_mfma_f32_16x16x32_bf16 v[40:43], a[216:219], a[152:155], v[40:43]
    buffer_load_dword v214, v215, s[96:99], 0 offen sc1
    v_mul_f32 v50, v50, v245
    v_mfma_f32_16x16x32_bf16 v[40:43], a[220:223], a[168:171], v[40:43]
    v_mul_f32 v51, v51, v245
    v_mul_f32 v36, v36, v247
    v_mfma_f32_16x16x32_bf16 v[40:43], a[224:227], a[192:195], v[40:43]
    s_waitcnt vmcnt(9)
    s_barrier
    v_mul_f32 v37, v37, v247
    v_mul_f32 v38, v38, v247
    v_mfma_f32_16x16x32_bf16 v[40:43], a[228:231], a[208:211], v[40:43]
    ds_read_b64_tr_b16 a[8:9], v226 offset:0
    ds_read_b64_tr_b16 a[10:11], v226 offset:4096
    v_mfma_f32_16x16x32_bf16 v[56:59], a[232:235], a[152:155], v[56:59]
    v_mul_f32 v39, v39, v247
    v_mul_f32 v52, v52, v247
    v_mfma_f32_16x16x32_bf16 v[56:59], a[236:239], a[168:171], v[56:59]
    v_mul_f32 v53, v53, v247
    v_mul_f32 v54, v54, v247
    v_mfma_f32_16x16x32_bf16 v[56:59], a[240:243], a[192:195], v[56:59]
    v_mul_f32 v55, v55, v247
    v_mfma_f32_16x16x32_bf16 v[56:59], a[244:247], a[208:211], v[56:59]
    ds_read_b64_tr_b16 a[12:13], v226 offset:8192
    ds_read_b64_tr_b16 a[14:15], v226 offset:12288
    v_mfma_f32_16x16x32_bf16 v[44:47], a[216:219], a[156:159], v[44:47]
    v_mul_f32 v40, v40, v249
    v_mul_f32 v41, v41, v249
    v_mfma_f32_16x16x32_bf16 v[44:47], a[220:223], a[172:175], v[44:47]
    v_mul_f32 v42, v42, v249
    v_mul_f32 v43, v43, v249
    v_mfma_f32_16x16x32_bf16 v[44:47], a[224:227], a[196:199], v[44:47]
    v_mfma_f32_16x16x32_bf16 v[44:47], a[228:231], a[212:215], v[44:47]
    ds_read_b64_tr_b16 a[16:17], v219 offset:57344
    ds_read_b64_tr_b16 a[18:19], v219 offset:61440
    v_mfma_f32_16x16x32_bf16 v[60:63], a[232:235], a[156:159], v[60:63]
    v_mul_f32 v56, v56, v249
    v_mul_f32 v57, v57, v249
    v_mfma_f32_16x16x32_bf16 v[60:63], a[236:239], a[172:175], v[60:63]
    v_mul_f32 v58, v58, v249
    v_mul_f32 v59, v59, v249
    v_mfma_f32_16x16x32_bf16 v[60:63], a[240:243], a[196:199], v[60:63]
    v_mfma_f32_16x16x32_bf16 v[60:63], a[244:247], a[212:215], v[60:63]
    s_waitcnt lgkmcnt(15)
    ds_read_b64_tr_b16 a[20:21], v227 offset:0
    ds_read_b64_tr_b16 a[22:23], v227 offset:4096
    v_mfma_f32_16x16x32_bf16 v[32:35], a[248:251], v[144:147], v[32:35]
    v_mul_f32 v44, v44, v251
    v_mul_f32 v45, v45, v251
    v_mfma_f32_16x16x32_bf16 v[32:35], a[252:255], v[128:131], v[32:35]
    v_mul_f32 v46, v46, v251
    v_mul_f32 v47, v47, v251
    v_mfma_f32_16x16x32_bf16 v[32:35], v[176:179], v[160:163], v[32:35]
    v_mfma_f32_16x16x32_bf16 v[32:35], v[180:183], a[32:35], v[32:35]
    ds_read_b64_tr_b16 a[24:25], v227 offset:8192
    ds_read_b64_tr_b16 a[26:27], v227 offset:12288
    v_mfma_f32_16x16x32_bf16 v[32:35], v[184:187], a[48:51], v[32:35]
    v_mul_f32 v60, v60, v251
    v_mul_f32 v61, v61, v251
    v_mfma_f32_16x16x32_bf16 v[32:35], v[188:191], a[64:67], v[32:35]
    s_waitcnt lgkmcnt(8)
    v_mul_f32 v62, v62, v251
    v_mul_f32 v63, v63, v251
    v_mfma_f32_16x16x32_bf16 v[32:35], a[8:11], a[80:83], v[32:35]
    s_waitcnt vmcnt(5) lgkmcnt(6)
    v_mfma_f32_16x16x32_bf16 v[32:35], a[12:15], a[96:99], v[32:35]
    ds_read_b64_tr_b16 a[28:29], v228 offset:32768
    ds_read_b64_tr_b16 a[30:31], v228 offset:36864
    v_mfma_f32_16x16x32_bf16 v[48:51], v[192:195], v[144:147], v[48:51]
    v_mfma_f32_16x16x32_bf16 v[48:51], v[196:199], v[128:131], v[48:51]
    v_mfma_f32_16x16x32_bf16 v[48:51], v[200:203], v[160:163], v[48:51]
    v_mfma_f32_16x16x32_bf16 v[48:51], v[204:207], a[32:35], v[48:51]
    ds_read_b64_tr_b16 a[176:177], v228 offset:40960
    ds_read_b64_tr_b16 a[178:179], v228 offset:45056
    v_mfma_f32_16x16x32_bf16 v[48:51], v[208:211], a[48:51], v[48:51]
    s_waitcnt lgkmcnt(8)
    v_mfma_f32_16x16x32_bf16 v[48:51], a[16:19], a[64:67], v[48:51]
    s_waitcnt lgkmcnt(6)
    v_mfma_f32_16x16x32_bf16 v[48:51], a[20:23], a[80:83], v[48:51]
    s_waitcnt lgkmcnt(4)
    v_mfma_f32_16x16x32_bf16 v[48:51], a[24:27], a[96:99], v[48:51]
    ds_read_b64_tr_b16 a[180:181], v220 offset:0
    ds_read_b64_tr_b16 a[182:183], v220 offset:4096
    v_mfma_f32_16x16x32_bf16 v[36:39], a[248:251], v[148:151], v[36:39]
    v_mfma_f32_16x16x32_bf16 v[36:39], a[252:255], v[132:135], v[36:39]
    v_mfma_f32_16x16x32_bf16 v[36:39], v[176:179], v[164:167], v[36:39]
    s_mov_b32 s64, 0x8000
    s_waitcnt vmcnt(4)
L_sp_x:
    v_cmp_ne_u32 vcc, s88, v254
    s_sub_u32 s64, s64, 1
    s_cmp_eq_u32 s64, 0
    s_cbranch_scc1 L_sg_x
    s_nop 1
    s_cbranch_vccz L_sg_x
    buffer_load_dword v254, v253, s[44:47], s93 offen sc1
    s_waitcnt vmcnt(0)
    s_branch L_sp_x
L_sg_x:
    s_add_u32 s6, s85, 0x0
    v_mfma_f32_16x16x32_bf16 v[36:39], v[180:183], a[36:39], v[36:39]
    ds_read_b64_tr_b16 a[0:1], v220 offset:8192
    ds_read_b64_tr_b16 a[2:3], v220 offset:12288
    v_mfma_f32_16x16x32_bf16 v[36:39], v[184:187], a[52:55], v[36:39]
    v_cvt_pk_f16_f32 v32, v32, v33
    v_cvt_pk_f16_f32 v33, v34, v35
    v_mfma_f32_16x16x32_bf16 v[36:39], v[188:191], a[68:71], v[36:39]
    v_cvt_pk_f16_f32 v34, v48, v49
    v_cvt_pk_f16_f32 v35, v50, v51
    v_mfma_f32_16x16x32_bf16 v[36:39], a[8:11], a[84:87], v[36:39]
    s_waitcnt vmcnt(3)
    v_alignbit_b32 v33, 1, v33, 1
    v_alignbit_b32 v35, 1, v35, 1
    v_mfma_f32_16x16x32_bf16 v[36:39], a[12:15], a[100:103], v[36:39]
    ds_read_b64_tr_b16 a[4:5], v229 offset:32768
    ds_read_b64_tr_b16 a[6:7], v229 offset:36864
    v_mfma_f32_16x16x32_bf16 v[52:55], v[192:195], v[148:151], v[52:55]
    buffer_store_dwordx4 v[32:35], v252, s[36:39], s6 offen offset:0 sc1
    v_mfma_f32_16x16x32_bf16 v[52:55], v[196:199], v[132:135], v[52:55]
    v_mfma_f32_16x16x32_bf16 v[52:55], v[200:203], v[164:167], v[52:55]
    v_mfma_f32_16x16x32_bf16 v[52:55], v[204:207], a[36:39], v[52:55]
    ds_read_b64_tr_b16 a[216:217], v229 offset:40960
    ds_read_b64_tr_b16 a[218:219], v229 offset:45056
    v_mfma_f32_16x16x32_bf16 v[52:55], v[208:211], a[52:55], v[52:55]
    v_mfma_f32_16x16x32_bf16 v[52:55], a[16:19], a[68:71], v[52:55]
    v_mfma_f32_16x16x32_bf16 v[52:55], a[20:23], a[84:87], v[52:55]
    v_mfma_f32_16x16x32_bf16 v[52:55], a[24:27], a[100:103], v[52:55]
    ds_read_b64_tr_b16 a[220:221], v221 offset:0
    ds_read_b64_tr_b16 a[222:223], v221 offset:4096
    v_mfma_f32_16x16x32_bf16 v[40:43], a[248:251], v[152:155], v[40:43]
    v_mfma_f32_16x16x32_bf16 v[40:43], a[252:255], v[136:139], v[40:43]
    v_mfma_f32_16x16x32_bf16 v[40:43], v[176:179], v[168:171], v[40:43]
    v_cvt_pk_f16_f32 v36, v36, v37
    v_cvt_pk_f16_f32 v37, v38, v39
    v_mfma_f32_16x16x32_bf16 v[40:43], v[180:183], a[40:43], v[40:43]
    ds_read_b64_tr_b16 a[224:225], v221 offset:8192
    ds_read_b64_tr_b16 a[226:227], v221 offset:12288
    v_mfma_f32_16x16x32_bf16 v[40:43], v[184:187], a[56:59], v[40:43]
    v_cvt_pk_f16_f32 v38, v52, v53
    v_cvt_pk_f16_f32 v39, v54, v55
    v_mfma_f32_16x16x32_bf16 v[40:43], v[188:191], a[72:75], v[40:43]
    v_alignbit_b32 v37, 1, v37, 1
    v_alignbit_b32 v39, 1, v39, 1
    v_mfma_f32_16x16x32_bf16 v[40:43], a[8:11], a[88:91], v[40:43]
    s_waitcnt vmcnt(3)
    buffer_store_dwordx4 v[36:39], v252, s[36:39], s6 offen offset:1024 sc1
    v_mfma_f32_16x16x32_bf16 v[40:43], a[12:15], a[104:107], v[40:43]
    ds_read_b64_tr_b16 a[228:229], v220 offset:16384
    ds_read_b64_tr_b16 a[230:231], v220 offset:20480
    v_mfma_f32_16x16x32_bf16 v[56:59], v[192:195], v[152:155], v[56:59]
    v_mfma_f32_16x16x32_bf16 v[56:59], v[196:199], v[136:139], v[56:59]
    v_mfma_f32_16x16x32_bf16 v[56:59], v[200:203], v[168:171], v[56:59]
    v_mfma_f32_16x16x32_bf16 v[56:59], v[204:207], a[40:43], v[56:59]
    ds_read_b64_tr_b16 a[232:233], v220 offset:24576
    ds_read_b64_tr_b16 a[234:235], v220 offset:28672
    v_mfma_f32_16x16x32_bf16 v[56:59], v[208:211], a[56:59], v[56:59]
    v_mfma_f32_16x16x32_bf16 v[56:59], a[16:19], a[72:75], v[56:59]
    v_mfma_f32_16x16x32_bf16 v[56:59], a[20:23], a[88:91], v[56:59]
    v_mfma_f32_16x16x32_bf16 v[56:59], a[24:27], a[104:107], v[56:59]
    ds_read_b64_tr_b16 a[236:237], v220 offset:32768
    ds_read_b64_tr_b16 a[238:239], v220 offset:36864
    v_mfma_f32_16x16x32_bf16 v[44:47], a[248:251], v[156:159], v[44:47]
    v_mfma_f32_16x16x32_bf16 v[44:47], a[252:255], v[140:143], v[44:47]
    v_mfma_f32_16x16x32_bf16 v[44:47], v[176:179], v[172:175], v[44:47]
    v_cvt_pk_f16_f32 v40, v40, v41
    v_cvt_pk_f16_f32 v41, v42, v43
    v_mfma_f32_16x16x32_bf16 v[44:47], v[180:183], a[44:47], v[44:47]
    ds_read_b64_tr_b16 a[240:241], v220 offset:40960
    ds_read_b64_tr_b16 a[242:243], v220 offset:45056
    v_mfma_f32_16x16x32_bf16 v[44:47], v[184:187], a[60:63], v[44:47]
    v_cvt_pk_f16_f32 v42, v56, v57
    v_cvt_pk_f16_f32 v43, v58, v59
    v_mfma_f32_16x16x32_bf16 v[44:47], v[188:191], a[76:79], v[44:47]
    v_alignbit_b32 v41, 1, v41, 1
    v_alignbit_b32 v43, 1, v43, 1
    v_mfma_f32_16x16x32_bf16 v[44:47], a[8:11], a[92:95], v[44:47]
    s_waitcnt vmcnt(3)
    buffer_store_dwordx4 v[40:43], v252, s[36:39], s6 offen offset:2048 sc1
    v_mfma_f32_16x16x32_bf16 v[44:47], a[12:15], a[108:111], v[44:47]
    ds_read_b64_tr_b16 a[244:245], v220 offset:49152
    ds_read_b64_tr_b16 a[246:247], v220 offset:53248
    v_mfma_f32_16x16x32_bf16 v[60:63], v[192:195], v[156:159], v[60:63]
    v_mfma_f32_16x16x32_bf16 v[60:63], v[196:199], v[140:143], v[60:63]
    v_mfma_f32_16x16x32_bf16 v[60:63], v[200:203], v[172:175], v[60:63]
    v_mfma_f32_16x16x32_bf16 v[60:63], v[204:207], a[44:47], v[60:63]
    ds_read_b64_tr_b16 a[248:249], v220 offset:57344
    ds_read_b64_tr_b16 a[250:251], v220 offset:61440
    v_mfma_f32_16x16x32_bf16 v[60:63], v[208:211], a[60:63], v[60:63]
    v_mfma_f32_16x16x32_bf16 v[60:63], a[16:19], a[76:79], v[60:63]
    v_mfma_f32_16x16x32_bf16 v[60:63], a[20:23], a[92:95], v[60:63]
    v_mfma_f32_16x16x32_bf16 v[60:63], a[24:27], a[108:111], v[60:63]
    s_waitcnt lgkmcnt(15)
    ds_read_b64_tr_b16 a[252:253], v228 offset:0
    ds_read_b64_tr_b16 a[254:255], v228 offset:4096
    v_mfma_f32_16x16x32_bf16 v[64:67], a[28:31], a[144:147], v[64:67]
    v_mfma_f32_16x16x32_bf16 v[64:67], a[176:179], a[160:163], v[64:67]
    v_mfma_f32_16x16x32_bf16 v[64:67], a[180:183], a[184:187], v[64:67]
    v_cvt_pk_f16_f32 v44, v44, v45
    v_cvt_pk_f16_f32 v45, v46, v47
    v_mfma_f32_16x16x32_bf16 v[64:67], a[0:3], a[200:203], v[64:67]
    ds_read_b64_tr_b16 v[176:177], v228 offset:8192
    ds_read_b64_tr_b16 v[178:179], v228 offset:12288
    v_mfma_f32_16x16x32_bf16 v[80:83], a[4:7], a[144:147], v[80:83]
    v_cvt_pk_f16_f32 v46, v60, v61
    v_cvt_pk_f16_f32 v47, v62, v63
    v_mfma_f32_16x16x32_bf16 v[80:83], a[216:219], a[160:163], v[80:83]
    s_waitcnt lgkmcnt(15)
    v_alignbit_b32 v45, 1, v45, 1
    v_alignbit_b32 v47, 1, v47, 1
    v_mfma_f32_16x16x32_bf16 v[80:83], a[220:223], a[184:187], v[80:83]
    buffer_store_dwordx4 v[44:47], v252, s[36:39], s6 offen offset:3072 sc1
    v_mfma_f32_16x16x32_bf16 v[80:83], a[224:227], a[200:203], v[80:83]
    ds_read_b64_tr_b16 v[180:181], v221 offset:16384
    ds_read_b64_tr_b16 v[182:183], v221 offset:20480
    v_mfma_f32_16x16x32_bf16 v[68:71], a[28:31], a[148:151], v[68:71]
    v_mul_f32 v64, v64, v245
    v_mul_f32 v65, v65, v245
    v_mfma_f32_16x16x32_bf16 v[68:71], a[176:179], a[164:167], v[68:71]
    v_mul_f32 v66, v66, v245
    v_mul_f32 v67, v67, v245
    v_mfma_f32_16x16x32_bf16 v[68:71], a[180:183], a[188:191], v[68:71]
    v_mfma_f32_16x16x32_bf16 v[68:71], a[0:3], a[204:207], v[68:71]
    ds_read_b64_tr_b16 v[184:185], v221 offset:24576
    ds_read_b64_tr_b16 v[186:187], v221 offset:28672
    v_mfma_f32_16x16x32_bf16 v[84:87], a[4:7], a[148:151], v[84:87]
    v_mul_f32 v80, v80, v245
    v_mul_f32 v81, v81, v245
    v_mfma_f32_16x16x32_bf16 v[84:87], a[216:219], a[164:167], v[84:87]
    v_mul_f32 v82, v82, v245
    v_mul_f32 v83, v83, v245
    v_mfma_f32_16x16x32_bf16 v[84:87], a[220:223], a[188:191], v[84:87]
    v_mfma_f32_16x16x32_bf16 v[84:87], a[224:227], a[204:207], v[84:87]
    ds_read_b64_tr_b16 v[188:189], v221 offset:32768
    ds_read_b64_tr_b16 v[190:191], v221 offset:36864
    v_mfma_f32_16x16x32_bf16 v[72:75], a[28:31], a[152:155], v[72:75]
    v_mul_f32 v68, v68, v247
    v_mul_f32 v69, v69, v247
    v_mfma_f32_16x16x32_bf16 v[72:75], a[176:179], a[168:171], v[72:75]
    v_mul_f32 v70, v70, v247
    v_mul_f32 v71, v71, v247
    v_mfma_f32_16x16x32_bf16 v[72:75], a[180:183], a[192:195], v[72:75]
    v_mfma_f32_16x16x32_bf16 v[72:75], a[0:3], a[208:211], v[72:75]
    ds_read_b64_tr_b16 a[8:9], v221 offset:40960
    ds_read_b64_tr_b16 a[10:11], v221 offset:45056
    v_mfma_f32_16x16x32_bf16 v[88:91], a[4:7], a[152:155], v[88:91]
    v_mul_f32 v84, v84, v247
    v_mul_f32 v85, v85, v247
    v_mfma_f32_16x16x32_bf16 v[88:91], a[216:219], a[168:171], v[88:91]
    v_mul_f32 v86, v86, v247
    v_mul_f32 v87, v87, v247
    v_mfma_f32_16x16x32_bf16 v[88:91], a[220:223], a[192:195], v[88:91]
    v_mfma_f32_16x16x32_bf16 v[88:91], a[224:227], a[208:211], v[88:91]
    ds_read_b64_tr_b16 a[12:13], v221 offset:49152
    ds_read_b64_tr_b16 a[14:15], v221 offset:53248
    v_mfma_f32_16x16x32_bf16 v[76:79], a[28:31], a[156:159], v[76:79]
    v_mul_f32 v72, v72, v249
    v_mul_f32 v73, v73, v249
    v_mfma_f32_16x16x32_bf16 v[76:79], a[176:179], a[172:175], v[76:79]
    v_mul_f32 v74, v74, v249
    v_mul_f32 v75, v75, v249
    v_mfma_f32_16x16x32_bf16 v[76:79], a[180:183], a[196:199], v[76:79]
    v_mfma_f32_16x16x32_bf16 v[76:79], a[0:3], a[212:215], v[76:79]
    ds_read_b64_tr_b16 v[192:193], v221 offset:57344
    ds_read_b64_tr_b16 v[194:195], v221 offset:61440
    v_mfma_f32_16x16x32_bf16 v[92:95], a[4:7], a[156:159], v[92:95]
    v_mul_f32 v88, v88, v249
    v_mul_f32 v89, v89, v249
    v_mfma_f32_16x16x32_bf16 v[92:95], a[216:219], a[172:175], v[92:95]
    v_mul_f32 v90, v90, v249
    v_mul_f32 v91, v91, v249
    v_mfma_f32_16x16x32_bf16 v[92:95], a[220:223], a[196:199], v[92:95]
    v_mfma_f32_16x16x32_bf16 v[92:95], a[224:227], a[212:215], v[92:95]
    s_waitcnt lgkmcnt(15)
    ds_read_b64_tr_b16 v[196:197], v229 offset:0
    ds_read_b64_tr_b16 v[198:199], v229 offset:4096
    v_mfma_f32_16x16x32_bf16 v[64:67], a[228:231], v[144:147], v[64:67]
    v_mul_f32 v76, v76, v251
    v_mul_f32 v77, v77, v251
    v_mfma_f32_16x16x32_bf16 v[64:67], a[232:235], v[128:131], v[64:67]
    v_mul_f32 v78, v78, v251
    v_mul_f32 v79, v79, v251
    v_mfma_f32_16x16x32_bf16 v[64:67], a[236:239], v[160:163], v[64:67]
    v_mfma_f32_16x16x32_bf16 v[64:67], a[240:243], a[32:35], v[64:67]
    ds_read_b64_tr_b16 v[200:201], v229 offset:8192
    ds_read_b64_tr_b16 v[202:203], v229 offset:12288
    v_mfma_f32_16x16x32_bf16 v[64:67], a[244:247], a[48:51], v[64:67]
    v_mul_f32 v92, v92, v251
    v_mul_f32 v93, v93, v251
    v_mfma_f32_16x16x32_bf16 v[64:67], a[248:251], a[64:67], v[64:67]
    s_waitcnt lgkmcnt(15)
    v_mul_f32 v94, v94, v251
    v_mul_f32 v95, v95, v251
    v_mfma_f32_16x16x32_bf16 v[64:67], a[252:255], a[80:83], v[64:67]
    v_mfma_f32_16x16x32_bf16 v[64:67], v[176:179], a[96:99], v[64:67]
    s_waitcnt lgkmcnt(14)
    ds_read_b64_tr_b16 v[204:205], v230 offset:32768
    ds_read_b64_tr_b16 v[206:207], v230 offset:36864
    v_mfma_f32_16x16x32_bf16 v[80:83], v[180:183], v[144:147], v[80:83]
    s_waitcnt lgkmcnt(14)
    v_mfma_f32_16x16x32_bf16 v[80:83], v[184:187], v[128:131], v[80:83]
    s_waitcnt lgkmcnt(12)
    v_mfma_f32_16x16x32_bf16 v[80:83], v[188:191], v[160:163], v[80:83]
    s_waitcnt lgkmcnt(10)
    v_mfma_f32_16x16x32_bf16 v[80:83], a[8:11], a[32:35], v[80:83]
    s_waitcnt lgkmcnt(8)
    ds_read_b64_tr_b16 v[208:209], v230 offset:40960
    ds_read_b64_tr_b16 v[210:211], v230 offset:45056
    v_mfma_f32_16x16x32_bf16 v[80:83], a[12:15], a[48:51], v[80:83]
    s_waitcnt lgkmcnt(8)
    v_mfma_f32_16x16x32_bf16 v[80:83], v[192:195], a[64:67], v[80:83]
    s_waitcnt lgkmcnt(6)
    v_mfma_f32_16x16x32_bf16 v[80:83], v[196:199], a[80:83], v[80:83]
    s_waitcnt lgkmcnt(4)
    v_mfma_f32_16x16x32_bf16 v[80:83], v[200:203], a[96:99], v[80:83]
    ds_read_b64_tr_b16 a[16:17], v222 offset:0
    ds_read_b64_tr_b16 a[18:19], v222 offset:4096
    v_mfma_f32_16x16x32_bf16 v[68:71], a[228:231], v[148:151], v[68:71]
    v_mfma_f32_16x16x32_bf16 v[68:71], a[232:235], v[132:135], v[68:71]
    v_mfma_f32_16x16x32_bf16 v[68:71], a[236:239], v[164:167], v[68:71]
    s_add_u32 s6, s85, 0x4000
    v_cvt_pk_f16_f32 v64, v64, v65
    v_mfma_f32_16x16x32_bf16 v[68:71], a[240:243], a[36:39], v[68:71]
    ds_read_b64_tr_b16 a[20:21], v222 offset:8192
    ds_read_b64_tr_b16 a[22:23], v222 offset:12288
    v_mfma_f32_16x16x32_bf16 v[68:71], a[244:247], a[52:55], v[68:71]
    v_cvt_pk_f16_f32 v65, v66, v67
    v_cvt_pk_f16_f32 v66, v80, v81
    v_mfma_f32_16x16x32_bf16 v[68:71], a[248:251], a[68:71], v[68:71]
    v_cvt_pk_f16_f32 v67, v82, v83
    v_alignbit_b32 v65, 1, v65, 1
    v_mfma_f32_16x16x32_bf16 v[68:71], a[252:255], a[84:87], v[68:71]
    v_alignbit_b32 v67, 1, v67, 1
    v_mfma_f32_16x16x32_bf16 v[68:71], v[176:179], a[100:103], v[68:71]
    ds_read_b64_tr_b16 a[24:25], v231 offset:32768
    ds_read_b64_tr_b16 a[26:27], v231 offset:36864
    v_mfma_f32_16x16x32_bf16 v[84:87], v[180:183], v[148:151], v[84:87]
    buffer_store_dwordx4 v[64:67], v252, s[36:39], s6 offen offset:0 sc1
    v_mfma_f32_16x16x32_bf16 v[84:87], v[184:187], v[132:135], v[84:87]
    v_mfma_f32_16x16x32_bf16 v[84:87], v[188:191], v[164:167], v[84:87]
    v_mfma_f32_16x16x32_bf16 v[84:87], a[8:11], a[36:39], v[84:87]
    ds_read_b64_tr_b16 a[28:29], v231 offset:40960
    ds_read_b64_tr_b16 a[30:31], v231 offset:45056
    v_mfma_f32_16x16x32_bf16 v[84:87], a[12:15], a[52:55], v[84:87]
    v_mfma_f32_16x16x32_bf16 v[84:87], v[192:195], a[68:71], v[84:87]
    v_mfma_f32_16x16x32_bf16 v[84:87], v[196:199], a[84:87], v[84:87]
    v_mfma_f32_16x16x32_bf16 v[84:87], v[200:203], a[100:103], v[84:87]
    ds_read_b64_tr_b16 a[176:177], v223 offset:0
    ds_read_b64_tr_b16 a[178:179], v223 offset:4096
    v_mfma_f32_16x16x32_bf16 v[72:75], a[228:231], v[152:155], v[72:75]
    v_mfma_f32_16x16x32_bf16 v[72:75], a[232:235], v[136:139], v[72:75]
    v_mfma_f32_16x16x32_bf16 v[72:75], a[236:239], v[168:171], v[72:75]
    v_cvt_pk_f16_f32 v68, v68, v69
    v_cvt_pk_f16_f32 v69, v70, v71
    v_mfma_f32_16x16x32_bf16 v[72:75], a[240:243], a[40:43], v[72:75]
    ds_read_b64_tr_b16 a[180:181], v223 offset:8192
    ds_read_b64_tr_b16 a[182:183], v223 offset:12288
    v_mfma_f32_16x16x32_bf16 v[72:75], a[244:247], a[56:59], v[72:75]
    v_cvt_pk_f16_f32 v70, v84, v85
    v_cvt_pk_f16_f32 v71, v86, v87
    v_mfma_f32_16x16x32_bf16 v[72:75], a[248:251], a[72:75], v[72:75]
    v_alignbit_b32 v69, 1, v69, 1
    v_alignbit_b32 v71, 1, v71, 1
    v_mfma_f32_16x16x32_bf16 v[72:75], a[252:255], a[88:91], v[72:75]
    buffer_store_dwordx4 v[68:71], v252, s[36:39], s6 offen offset:1024 sc1
    v_mfma_f32_16x16x32_bf16 v[72:75], v[176:179], a[104:107], v[72:75]
    ds_read_b64_tr_b16 a[0:1], v222 offset:16384
    ds_read_b64_tr_b16 a[2:3], v222 offset:20480
    v_mfma_f32_16x16x32_bf16 v[88:91], v[180:183], v[152:155], v[88:91]
    v_mfma_f32_16x16x32_bf16 v[88:91], v[184:187], v[136:139], v[88:91]
    v_mfma_f32_16x16x32_bf16 v[88:91], v[188:191], v[168:171], v[88:91]
    v_mfma_f32_16x16x32_bf16 v[88:91], a[8:11], a[40:43], v[88:91]
    ds_read_b64_tr_b16 a[4:5], v222 offset:24576
    ds_read_b64_tr_b16 a[6:7], v222 offset:28672
    v_mfma_f32_16x16x32_bf16 v[88:91], a[12:15], a[56:59], v[88:91]
    v_mfma_f32_16x16x32_bf16 v[88:91], v[192:195], a[72:75], v[88:91]
    v_mfma_f32_16x16x32_bf16 v[88:91], v[196:199], a[88:91], v[88:91]
    v_mfma_f32_16x16x32_bf16 v[88:91], v[200:203], a[104:107], v[88:91]
    ds_read_b64_tr_b16 a[216:217], v222 offset:32768
    ds_read_b64_tr_b16 a[218:219], v222 offset:36864
    v_mfma_f32_16x16x32_bf16 v[76:79], a[228:231], v[156:159], v[76:79]
    v_mfma_f32_16x16x32_bf16 v[76:79], a[232:235], v[140:143], v[76:79]
    v_mfma_f32_16x16x32_bf16 v[76:79], a[236:239], v[172:175], v[76:79]
    v_cvt_pk_f16_f32 v72, v72, v73
    v_cvt_pk_f16_f32 v73, v74, v75
    v_mfma_f32_16x16x32_bf16 v[76:79], a[240:243], a[44:47], v[76:79]
    ds_read_b64_tr_b16 a[220:221], v222 offset:40960
    ds_read_b64_tr_b16 a[222:223], v222 offset:45056
    v_mfma_f32_16x16x32_bf16 v[76:79], a[244:247], a[60:63], v[76:79]
    v_cvt_pk_f16_f32 v74, v88, v89
    v_cvt_pk_f16_f32 v75, v90, v91
    v_mfma_f32_16x16x32_bf16 v[76:79], a[248:251], a[76:79], v[76:79]
    v_alignbit_b32 v73, 1, v73, 1
    v_alignbit_b32 v75, 1, v75, 1
    v_mfma_f32_16x16x32_bf16 v[76:79], a[252:255], a[92:95], v[76:79]
    buffer_store_dwordx4 v[72:75], v252, s[36:39], s6 offen offset:2048 sc1
    v_mfma_f32_16x16x32_bf16 v[76:79], v[176:179], a[108:111], v[76:79]
    ds_read_b64_tr_b16 a[224:225], v222 offset:49152
    ds_read_b64_tr_b16 a[226:227], v222 offset:53248
    v_mfma_f32_16x16x32_bf16 v[92:95], v[180:183], v[156:159], v[92:95]
    v_mfma_f32_16x16x32_bf16 v[92:95], v[184:187], v[140:143], v[92:95]
    v_mfma_f32_16x16x32_bf16 v[92:95], v[188:191], v[172:175], v[92:95]
    v_mfma_f32_16x16x32_bf16 v[92:95], a[8:11], a[44:47], v[92:95]
    ds_read_b64_tr_b16 a[228:229], v222 offset:57344
    ds_read_b64_tr_b16 a[230:231], v222 offset:61440
    v_mfma_f32_16x16x32_bf16 v[92:95], a[12:15], a[60:63], v[92:95]
    v_mfma_f32_16x16x32_bf16 v[92:95], v[192:195], a[76:79], v[92:95]
    v_mfma_f32_16x16x32_bf16 v[92:95], v[196:199], a[92:95], v[92:95]
    v_mfma_f32_16x16x32_bf16 v[92:95], v[200:203], a[108:111], v[92:95]
    s_waitcnt lgkmcnt(15)
    ds_read_b64_tr_b16 a[232:233], v230 offset:0
    ds_read_b64_tr_b16 a[234:235], v230 offset:4096
    v_mfma_f32_16x16x32_bf16 v[96:99], v[204:207], a[144:147], v[96:99]
    v_mfma_f32_16x16x32_bf16 v[96:99], v[208:211], a[160:163], v[96:99]
    v_mfma_f32_16x16x32_bf16 v[96:99], a[16:19], a[184:187], v[96:99]
    v_cvt_pk_f16_f32 v76, v76, v77
    v_cvt_pk_f16_f32 v77, v78, v79
    v_mfma_f32_16x16x32_bf16 v[96:99], a[20:23], a[200:203], v[96:99]
    ds_read_b64_tr_b16 a[236:237], v230 offset:8192
    ds_read_b64_tr_b16 a[238:239], v230 offset:12288
    v_mfma_f32_16x16x32_bf16 v[112:115], a[24:27], a[144:147], v[112:115]
    v_cvt_pk_f16_f32 v78, v92, v93
    v_cvt_pk_f16_f32 v79, v94, v95
    v_mfma_f32_16x16x32_bf16 v[112:115], a[28:31], a[160:163], v[112:115]
    s_waitcnt lgkmcnt(15)
    v_alignbit_b32 v77, 1, v77, 1
    v_alignbit_b32 v79, 1, v79, 1
    v_mfma_f32_16x16x32_bf16 v[112:115], a[176:179], a[184:187], v[112:115]
    buffer_store_dwordx4 v[76:79], v252, s[36:39], s6 offen offset:3072 sc1
    v_mfma_f32_16x16x32_bf16 v[112:115], a[180:183], a[200:203], v[112:115]
    ds_read_b64_tr_b16 a[240:241], v223 offset:16384
    ds_read_b64_tr_b16 a[242:243], v223 offset:20480
    v_mfma_f32_16x16x32_bf16 v[100:103], v[204:207], a[148:151], v[100:103]
    v_mul_f32 v96, v96, v245
    v_mul_f32 v97, v97, v245
    v_mfma_f32_16x16x32_bf16 v[100:103], v[208:211], a[164:167], v[100:103]
    v_mul_f32 v98, v98, v245
    v_mul_f32 v99, v99, v245
    v_mfma_f32_16x16x32_bf16 v[100:103], a[16:19], a[188:191], v[100:103]
    v_mfma_f32_16x16x32_bf16 v[100:103], a[20:23], a[204:207], v[100:103]
    ds_read_b64_tr_b16 a[244:245], v223 offset:24576
    ds_read_b64_tr_b16 a[246:247], v223 offset:28672
    v_mfma_f32_16x16x32_bf16 v[116:119], a[24:27], a[148:151], v[116:119]
    v_mul_f32 v112, v112, v245
    v_mul_f32 v113, v113, v245
    v_mfma_f32_16x16x32_bf16 v[116:119], a[28:31], a[164:167], v[116:119]
    v_mul_f32 v114, v114, v245
    v_mul_f32 v115, v115, v245
    v_mfma_f32_16x16x32_bf16 v[116:119], a[176:179], a[188:191], v[116:119]
    v_mfma_f32_16x16x32_bf16 v[116:119], a[180:183], a[204:207], v[116:119]
    ds_read_b64_tr_b16 a[248:249], v223 offset:32768
    ds_read_b64_tr_b16 a[250:251], v223 offset:36864
    v_mfma_f32_16x16x32_bf16 v[104:107], v[204:207], a[152:155], v[104:107]
    s_add_u32 s5, s51, 3
    s_and_b32 s5, s5, 3
    v_mfma_f32_16x16x32_bf16 v[104:107], v[208:211], a[168:171], v[104:107]
    s_mul_i32 s5, s5, 0x70000
    s_add_u32 s5, s5, s67
    v_mfma_f32_16x16x32_bf16 v[104:107], a[16:19], a[192:195], v[104:107]
    s_add_u32 s100, s51, 2
    s_and_b32 s100, s100, 3
    v_mfma_f32_16x16x32_bf16 v[104:107], a[20:23], a[208:211], v[104:107]
    ds_read_b64_tr_b16 a[252:253], v223 offset:40960
    ds_read_b64_tr_b16 a[254:255], v223 offset:45056
    v_mfma_f32_16x16x32_bf16 v[120:123], a[24:27], a[152:155], v[120:123]
    s_mul_i32 s100, s100, 0x70000
    s_add_u32 s100, s100, s67
    v_mfma_f32_16x16x32_bf16 v[120:123], a[28:31], a[168:171], v[120:123]
    s_add_u32 s100, s100, 0x4000
    v_mul_f32 v100, v100, v247
    v_mfma_f32_16x16x32_bf16 v[120:123], a[176:179], a[192:195], v[120:123]
    buffer_load_dwordx4 v[48:51], v252, s[36:39], s5 offen offset:0 sc1
    v_mfma_f32_16x16x32_bf16 v[120:123], a[180:183], a[208:211], v[120:123]
    ds_read_b64_tr_b16 v[176:177], v223 offset:49152
    ds_read_b64_tr_b16 v[178:179], v223 offset:53248
    v_mfma_f32_16x16x32_bf16 v[108:111], v[204:207], a[156:159], v[108:111]
    v_mul_f32 v101, v101, v247
    v_mul_f32 v102, v102, v247
    v_mfma_f32_16x16x32_bf16 v[108:111], v[208:211], a[172:175], v[108:111]
    v_mul_f32 v103, v103, v247
    v_mul_f32 v116, v116, v247
    v_mfma_f32_16x16x32_bf16 v[108:111], a[16:19], a[196:199], v[108:111]
    v_mul_f32 v117, v117, v247
    v_mul_f32 v118, v118, v247
    v_mfma_f32_16x16x32_bf16 v[108:111], a[20:23], a[212:215], v[108:111]
    ds_read_b64_tr_b16 v[180:181], v223 offset:57344
    ds_read_b64_tr_b16 v[182:183], v223 offset:61440
    v_mfma_f32_16x16x32_bf16 v[124:127], a[24:27], a[156:159], v[124:127]
    buffer_load_dwordx4 v[80:83], v252, s[36:39], s100 offen offset:0 sc1
    v_mfma_f32_16x16x32_bf16 v[124:127], a[28:31], a[172:175], v[124:127]
    v_mul_f32 v119, v119, v247
    v_mul_f32 v104, v104, v249
    v_mfma_f32_16x16x32_bf16 v[124:127], a[176:179], a[196:199], v[124:127]
    v_mul_f32 v105, v105, v249
    v_mul_f32 v106, v106, v249
    v_mfma_f32_16x16x32_bf16 v[124:127], a[180:183], a[212:215], v[124:127]
    s_waitcnt lgkmcnt(15)
    ds_read_b64_tr_b16 v[184:185], v231 offset:0
    ds_read_b64_tr_b16 v[186:187], v231 offset:4096
    v_mfma_f32_16x16x32_bf16 v[96:99], a[0:3], v[144:147], v[96:99]
    v_mul_f32 v107, v107, v249
    v_mul_f32 v120, v120, v249
    v_mfma_f32_16x16x32_bf16 v[96:99], a[4:7], v[128:131], v[96:99]
    v_mul_f32 v121, v121, v249
    v_mul_f32 v122, v122, v249
    v_mfma_f32_16x16x32_bf16 v[96:99], a[216:219], v[160:163], v[96:99]
    v_mul_f32 v123, v123, v249
    v_mul_f32 v108, v108, v251
    v_mfma_f32_16x16x32_bf16 v[96:99], a[220:223], a[32:35], v[96:99]
    ds_read_b64_tr_b16 v[188:189], v231 offset:8192
    ds_read_b64_tr_b16 v[190:191], v231 offset:12288
    v_mfma_f32_16x16x32_bf16 v[96:99], a[224:227], a[48:51], v[96:99]
    v_mul_f32 v109, v109, v251
    v_mul_f32 v110, v110, v251
    v_mfma_f32_16x16x32_bf16 v[96:99], a[228:231], a[64:67], v[96:99]
    s_waitcnt lgkmcnt(15)
    buffer_load_dwordx4 v[52:55], v252, s[36:39], s5 offen offset:1024 sc1
    v_mfma_f32_16x16x32_bf16 v[96:99], a[232:235], a[80:83], v[96:99]
    v_mul_f32 v111, v111, v251
    v_mul_f32 v124, v124, v251
    v_mfma_f32_16x16x32_bf16 v[96:99], a[236:239], a[96:99], v[96:99]
    s_waitcnt lgkmcnt(14)
    ds_read_b64_tr_b16 a[8:9], v224 offset:16384
    ds_read_b64_tr_b16 a[10:11], v224 offset:20480
    v_mfma_f32_16x16x32_bf16 v[112:115], a[240:243], v[144:147], v[112:115]
    s_waitcnt lgkmcnt(14)
    v_mul_f32 v125, v125, v251
    v_mul_f32 v126, v126, v251
    v_mfma_f32_16x16x32_bf16 v[112:115], a[244:247], v[128:131], v[112:115]
    s_waitcnt lgkmcnt(12)
    v_mul_f32 v127, v127, v251
    v_mfma_f32_16x16x32_bf16 v[112:115], a[248:251], v[160:163], v[112:115]
    s_waitcnt lgkmcnt(10)
    v_mfma_f32_16x16x32_bf16 v[112:115], a[252:255], a[32:35], v[112:115]
    s_waitcnt lgkmcnt(8)
    ds_read_b64_tr_b16 a[12:13], v224 offset:24576
    ds_read_b64_tr_b16 a[14:15], v224 offset:28672
    v_mfma_f32_16x16x32_bf16 v[112:115], v[176:179], a[48:51], v[112:115]
    s_waitcnt lgkmcnt(8)
    buffer_load_dwordx4 v[84:87], v252, s[36:39], s100 offen offset:1024 sc1
    v_mfma_f32_16x16x32_bf16 v[112:115], v[180:183], a[64:67], v[112:115]
    s_waitcnt lgkmcnt(6)
    v_mfma_f32_16x16x32_bf16 v[112:115], v[184:187], a[80:83], v[112:115]
    s_waitcnt lgkmcnt(4)
    v_mfma_f32_16x16x32_bf16 v[112:115], v[188:191], a[96:99], v[112:115]
    ds_read_b64_tr_b16 v[192:193], v224 offset:32768
    ds_read_b64_tr_b16 v[194:195], v224 offset:36864
    v_mfma_f32_16x16x32_bf16 v[100:103], a[0:3], v[148:151], v[100:103]
    v_mfma_f32_16x16x32_bf16 v[100:103], a[4:7], v[132:135], v[100:103]
    v_mfma_f32_16x16x32_bf16 v[100:103], a[216:219], v[164:167], v[100:103]
    s_add_u32 s6, s85, 0x8000
    v_cvt_pk_f16_f32 v96, v96, v97
    v_mfma_f32_16x16x32_bf16 v[100:103], a[220:223], a[36:39], v[100:103]
    ds_read_b64_tr_b16 v[196:197], v224 offset:40960
    ds_read_b64_tr_b16 v[198:199], v224 offset:45056
    v_mfma_f32_16x16x32_bf16 v[100:103], a[224:227], a[52:55], v[100:103]
    v_cvt_pk_f16_f32 v97, v98, v99
    v_cvt_pk_f16_f32 v98, v112, v113
    v_mfma_f32_16x16x32_bf16 v[100:103], a[228:231], a[68:71], v[100:103]
    v_cvt_pk_f16_f32 v99, v114, v115
    v_alignbit_b32 v97, 1, v97, 1
    v_mfma_f32_16x16x32_bf16 v[100:103], a[232:235], a[84:87], v[100:103]
    v_alignbit_b32 v99, 1, v99, 1
    v_mfma_f32_16x16x32_bf16 v[100:103], a[236:239], a[100:103], v[100:103]
    ds_read_b64_tr_b16 v[200:201], v216 offset:0
    ds_read_b64_tr_b16 v[202:203], v216 offset:4096
    v_mfma_f32_16x16x32_bf16 v[116:119], a[240:243], v[148:151], v[116:119]
    buffer_store_dwordx4 v[96:99], v252, s[36:39], s6 offen offset:0 sc1
    v_mfma_f32_16x16x32_bf16 v[116:119], a[244:247], v[132:135], v[116:119]
    buffer_load_dwordx4 v[56:59], v252, s[36:39], s5 offen offset:2048 sc1
    v_mfma_f32_16x16x32_bf16 v[116:119], a[248:251], v[164:167], v[116:119]
    v_mfma_f32_16x16x32_bf16 v[116:119], a[252:255], a[36:39], v[116:119]
    ds_read_b64_tr_b16 v[204:205], v216 offset:8192
    ds_read_b64_tr_b16 v[206:207], v216 offset:12288
    v_mfma_f32_16x16x32_bf16 v[116:119], v[176:179], a[52:55], v[116:119]
    buffer_load_dwordx4 v[88:91], v252, s[36:39], s100 offen offset:2048 sc1
    v_mfma_f32_16x16x32_bf16 v[116:119], v[180:183], a[68:71], v[116:119]
    v_mfma_f32_16x16x32_bf16 v[116:119], v[184:187], a[84:87], v[116:119]
    v_mfma_f32_16x16x32_bf16 v[116:119], v[188:191], a[100:103], v[116:119]
    ds_read_b64_tr_b16 v[208:209], v225 offset:16384
    ds_read_b64_tr_b16 v[210:211], v225 offset:20480
    v_mfma_f32_16x16x32_bf16 v[104:107], a[0:3], v[152:155], v[104:107]
    v_mfma_f32_16x16x32_bf16 v[104:107], a[4:7], v[136:139], v[104:107]
    v_mfma_f32_16x16x32_bf16 v[104:107], a[216:219], v[168:171], v[104:107]
    v_cvt_pk_f16_f32 v100, v100, v101
    v_cvt_pk_f16_f32 v101, v102, v103
    v_mfma_f32_16x16x32_bf16 v[104:107], a[220:223], a[40:43], v[104:107]
    ds_read_b64_tr_b16 a[16:17], v225 offset:24576
    ds_read_b64_tr_b16 a[18:19], v225 offset:28672
    v_mfma_f32_16x16x32_bf16 v[104:107], a[224:227], a[56:59], v[104:107]
    v_cvt_pk_f16_f32 v102, v116, v117
    v_cvt_pk_f16_f32 v103, v118, v119
    v_mfma_f32_16x16x32_bf16 v[104:107], a[228:231], a[72:75], v[104:107]
    v_alignbit_b32 v101, 1, v101, 1
    v_alignbit_b32 v103, 1, v103, 1
    v_mfma_f32_16x16x32_bf16 v[104:107], a[232:235], a[88:91], v[104:107]
    buffer_store_dwordx4 v[100:103], v252, s[36:39], s6 offen offset:1024 sc1
    v_mfma_f32_16x16x32_bf16 v[104:107], a[236:239], a[104:107], v[104:107]
    ds_read_b64_tr_b16 a[20:21], v225 offset:32768
    ds_read_b64_tr_b16 a[22:23], v225 offset:36864
    v_mfma_f32_16x16x32_bf16 v[120:123], a[240:243], v[152:155], v[120:123]
    buffer_load_dwordx4 v[60:63], v252, s[36:39], s5 offen offset:3072 sc1
    v_mfma_f32_16x16x32_bf16 v[120:123], a[244:247], v[136:139], v[120:123]
    v_mfma_f32_16x16x32_bf16 v[120:123], a[248:251], v[168:171], v[120:123]
    v_mfma_f32_16x16x32_bf16 v[120:123], a[252:255], a[40:43], v[120:123]
    ds_read_b64_tr_b16 a[24:25], v225 offset:40960
    ds_read_b64_tr_b16 a[26:27], v225 offset:45056
    v_mfma_f32_16x16x32_bf16 v[120:123], v[176:179], a[56:59], v[120:123]
    buffer_load_dwordx4 v[92:95], v252, s[36:39], s100 offen offset:3072 sc1
    v_mfma_f32_16x16x32_bf16 v[120:123], v[180:183], a[72:75], v[120:123]
    s_add_u32 s5, s51, 1
    s_and_b32 s5, s5, 3
    v_mfma_f32_16x16x32_bf16 v[120:123], v[184:187], a[88:91], v[120:123]
    s_mul_i32 s5, s5, 0x70000
    s_add_u32 s5, s5, s67
    v_mfma_f32_16x16x32_bf16 v[120:123], v[188:191], a[104:107], v[120:123]
    ds_read_b64_tr_b16 a[28:29], v217 offset:0
    ds_read_b64_tr_b16 a[30:31], v217 offset:4096
    v_mfma_f32_16x16x32_bf16 v[108:111], a[0:3], v[156:159], v[108:111]
    s_add_u32 s5, s5, 0x8000
    v_mfma_f32_16x16x32_bf16 v[108:111], a[4:7], v[140:143], v[108:111]
    v_mfma_f32_16x16x32_bf16 v[108:111], a[216:219], v[172:175], v[108:111]
    v_cvt_pk_f16_f32 v104, v104, v105
    v_cvt_pk_f16_f32 v105, v106, v107
    v_mfma_f32_16x16x32_bf16 v[108:111], a[220:223], a[44:47], v[108:111]
    ds_read_b64_tr_b16 a[176:177], v217 offset:8192
    ds_read_b64_tr_b16 a[178:179], v217 offset:12288
    v_mfma_f32_16x16x32_bf16 v[108:111], a[224:227], a[60:63], v[108:111]
    v_cvt_pk_f16_f32 v106, v120, v121
    v_cvt_pk_f16_f32 v107, v122, v123
    v_mfma_f32_16x16x32_bf16 v[108:111], a[228:231], a[76:79], v[108:111]
    v_alignbit_b32 v105, 1, v105, 1
    v_alignbit_b32 v107, 1, v107, 1
    v_mfma_f32_16x16x32_bf16 v[108:111], a[232:235], a[92:95], v[108:111]
    buffer_store_dwordx4 v[104:107], v252, s[36:39], s6 offen offset:2048 sc1
    v_mfma_f32_16x16x32_bf16 v[108:111], a[236:239], a[108:111], v[108:111]
    ds_read_b64_tr_b16 a[180:181], v216 offset:16384
    ds_read_b64_tr_b16 a[182:183], v216 offset:20480
    v_mfma_f32_16x16x32_bf16 v[124:127], a[240:243], v[156:159], v[124:127]
    v_mfma_f32_16x16x32_bf16 v[124:127], a[244:247], v[140:143], v[124:127]
    v_mfma_f32_16x16x32_bf16 v[124:127], a[248:251], v[172:175], v[124:127]
    v_mfma_f32_16x16x32_bf16 v[124:127], a[252:255], a[44:47], v[124:127]
    ds_read_b64_tr_b16 a[0:1], v216 offset:24576
    ds_read_b64_tr_b16 a[2:3], v216 offset:28672
    v_mfma_f32_16x16x32_bf16 v[124:127], v[176:179], a[60:63], v[124:127]
    v_mfma_f32_16x16x32_bf16 v[124:127], v[180:183], a[76:79], v[124:127]
    v_mfma_f32_16x16x32_bf16 v[124:127], v[184:187], a[92:95], v[124:127]
    v_mfma_f32_16x16x32_bf16 v[124:127], v[188:191], a[108:111], v[124:127]
    s_waitcnt lgkmcnt(15)
    ds_read_b64_tr_b16 a[4:5], v216 offset:32768
    ds_read_b64_tr_b16 a[6:7], v216 offset:36864
    v_mfma_f32_16x16x32_bf16 v[0:3], a[8:11], a[112:115], v[0:3]
    v_mfma_f32_16x16x32_bf16 v[0:3], a[12:15], a[128:131], v[0:3]
    v_mfma_f32_16x16x32_bf16 v[0:3], v[192:195], a[144:147], v[0:3]
    v_cvt_pk_f16_f32 v108, v108, v109
    v_cvt_pk_f16_f32 v109, v110, v111
    v_mfma_f32_16x16x32_bf16 v[0:3], v[196:199], a[160:163], v[0:3]
    ds_read_b64_tr_b16 a[216:217], v216 offset:40960
    ds_read_b64_tr_b16 a[218:219], v216 offset:45056
    v_mfma_f32_16x16x32_bf16 v[0:3], v[200:203], a[184:187], v[0:3]
    v_cvt_pk_f16_f32 v110, v124, v125
    v_cvt_pk_f16_f32 v111, v126, v127
    v_mfma_f32_16x16x32_bf16 v[0:3], v[204:207], a[200:203], v[0:3]
    s_waitcnt lgkmcnt(15)
    v_alignbit_b32 v109, 1, v109, 1
    v_alignbit_b32 v111, 1, v111, 1
    v_mfma_f32_16x16x32_bf16 v[16:19], v[208:211], a[112:115], v[16:19]
    buffer_store_dwordx4 v[108:111], v252, s[36:39], s6 offen offset:3072 sc1
    v_mfma_f32_16x16x32_bf16 v[16:19], a[16:19], a[128:131], v[16:19]
    s_waitcnt lgkmcnt(14)
    ds_read_b64_tr_b16 a[220:221], v216 offset:49152
    ds_read_b64_tr_b16 a[222:223], v216 offset:53248
    v_mfma_f32_16x16x32_bf16 v[16:19], a[20:23], a[144:147], v[16:19]
    s_waitcnt lgkmcnt(14)
    s_waitcnt vmcnt(10)
    v_min_u32 v255, v49, v51
    v_min3_u32 v255, v255, v81, v83
    v_mfma_f32_16x16x32_bf16 v[16:19], a[24:27], a[160:163], v[16:19]
    s_waitcnt lgkmcnt(12)
    v_cmp_le_i32 vcc, 0, v255
    v_mfma_f32_16x16x32_bf16 v[16:19], a[28:31], a[184:187], v[16:19]
    s_waitcnt lgkmcnt(10)
    s_cbranch_vccnz L_xr20
L_xb20:
    v_lshlrev_b32 v49, 1, v49
    v_mfma_f32_16x16x32_bf16 v[16:19], a[176:179], a[200:203], v[16:19]
    ds_read_b64_tr_b16 a[224:225], v216 offset:57344
    ds_read_b64_tr_b16 a[226:227], v216 offset:61440
    v_mfma_f32_16x16x32_bf16 v[4:7], a[8:11], a[116:119], v[4:7]
    v_lshlrev_b32 v51, 1, v51
    v_lshlrev_b32 v81, 1, v81
    v_mfma_f32_16x16x32_bf16 v[4:7], a[12:15], a[132:135], v[4:7]
    v_lshlrev_b32 v83, 1, v83
    v_fma_mix_f32 v32, v48, 1.0, v80 op_sel:[0,0,0] op_sel_hi:[1,0,1]
    v_mfma_f32_16x16x32_bf16 v[4:7], v[192:195], a[148:151], v[4:7]
    v_fma_mix_f32 v33, v48, 1.0, v80 op_sel:[1,0,1] op_sel_hi:[1,0,1]
    v_fma_mix_f32 v34, v49, 1.0, v81 op_sel:[0,0,0] op_sel_hi:[1,0,1]
    v_mfma_f32_16x16x32_bf16 v[4:7], v[196:199], a[164:167], v[4:7]
    ds_read_b64_tr_b16 a[228:229], v224 offset:0
    ds_read_b64_tr_b16 a[230:231], v224 offset:4096
    v_mfma_f32_16x16x32_bf16 v[4:7], v[200:203], a[188:191], v[4:7]
    v_fma_mix_f32 v35, v49, 1.0, v81 op_sel:[1,0,1] op_sel_hi:[1,0,1]
    v_pk_fma_f32 v[0:1], v[0:1], v[244:245], v[32:33]
    v_mfma_f32_16x16x32_bf16 v[4:7], v[204:207], a[204:207], v[4:7]
    v_pk_fma_f32 v[2:3], v[2:3], v[244:245], v[34:35]
    v_fma_mix_f32 v64, v50, 1.0, v82 op_sel:[0,0,0] op_sel_hi:[1,0,1]
    v_mfma_f32_16x16x32_bf16 v[20:23], v[208:211], a[116:119], v[20:23]
    v_fma_mix_f32 v65, v50, 1.0, v82 op_sel:[1,0,1] op_sel_hi:[1,0,1]
    v_fma_mix_f32 v66, v51, 1.0, v83 op_sel:[0,0,0] op_sel_hi:[1,0,1]
    v_mfma_f32_16x16x32_bf16 v[20:23], a[16:19], a[132:135], v[20:23]
    ds_read_b64_tr_b16 a[232:233], v224 offset:8192
    ds_read_b64_tr_b16 a[234:235], v224 offset:12288
    v_mfma_f32_16x16x32_bf16 v[20:23], a[20:23], a[148:151], v[20:23]
    v_fma_mix_f32 v67, v51, 1.0, v83 op_sel:[1,0,1] op_sel_hi:[1,0,1]
    v_pk_fma_f32 v[16:17], v[16:17], v[244:245], v[64:65]
    v_mfma_f32_16x16x32_bf16 v[20:23], a[24:27], a[164:167], v[20:23]
    v_pk_fma_f32 v[18:19], v[18:19], v[244:245], v[66:67]
    v_mfma_f32_16x16x32_bf16 v[20:23], a[28:31], a[188:191], v[20:23]
    v_mfma_f32_16x16x32_bf16 v[20:23], a[176:179], a[204:207], v[20:23]
    ds_read_b64_tr_b16 a[236:237], v217 offset:16384
    ds_read_b64_tr_b16 a[238:239], v217 offset:20480
    v_mfma_f32_16x16x32_bf16 v[8:11], a[8:11], a[120:123], v[8:11]
    buffer_load_dwordx4 v[112:115], v252, s[36:39], s5 offen offset:0 sc1
    v_mfma_f32_16x16x32_bf16 v[8:11], a[12:15], a[136:139], v[8:11]
    s_waitcnt vmcnt(9)
    v_min_u32 v255, v53, v55
    v_min3_u32 v255, v255, v85, v87
    v_mfma_f32_16x16x32_bf16 v[8:11], v[192:195], a[152:155], v[8:11]
    v_cmp_le_i32 vcc, 0, v255
    v_mfma_f32_16x16x32_bf16 v[8:11], v[196:199], a[168:171], v[8:11]
    ds_read_b64_tr_b16 a[240:241], v217 offset:24576
    ds_read_b64_tr_b16 a[242:243], v217 offset:28672
    v_mfma_f32_16x16x32_bf16 v[8:11], v[200:203], a[192:195], v[8:11]
    s_cbranch_vccnz L_xr21
L_xb21:
    v_lshlrev_b32 v53, 1, v53
    v_mfma_f32_16x16x32_bf16 v[8:11], v[204:207], a[208:211], v[8:11]
    v_lshlrev_b32 v55, 1, v55
    v_lshlrev_b32 v85, 1, v85
    v_mfma_f32_16x16x32_bf16 v[24:27], v[208:211], a[120:123], v[24:27]
    v_lshlrev_b32 v87, 1, v87
    v_fma_mix_f32 v36, v52, 1.0, v84 op_sel:[0,0,0] op_sel_hi:[1,0,1]
    v_mfma_f32_16x16x32_bf16 v[24:27], a[16:19], a[136:139], v[24:27]
    ds_read_b64_tr_b16 a[244:245], v217 offset:32768
    ds_read_b64_tr_b16 a[246:247], v217 offset:36864
    v_mfma_f32_16x16x32_bf16 v[24:27], a[20:23], a[152:155], v[24:27]
    v_fma_mix_f32 v37, v52, 1.0, v84 op_sel:[1,0,1] op_sel_hi:[1,0,1]
    v_fma_mix_f32 v38, v53, 1.0, v85 op_sel:[0,0,0] op_sel_hi:[1,0,1]
    v_mfma_f32_16x16x32_bf16 v[24:27], a[24:27], a[168:171], v[24:27]
    v_fma_mix_f32 v39, v53, 1.0, v85 op_sel:[1,0,1] op_sel_hi:[1,0,1]
    v_pk_fma_f32 v[4:5], v[4:5], v[246:247], v[36:37]
    v_mfma_f32_16x16x32_bf16 v[24:27], a[28:31], a[192:195], v[24:27]
    v_pk_fma_f32 v[6:7], v[6:7], v[246:247], v[38:39]
    v_fma_mix_f32 v68, v54, 1.0, v86 op_sel:[0,0,0] op_sel_hi:[1,0,1]
    v_mfma_f32_16x16x32_bf16 v[24:27], a[176:179], a[208:211], v[24:27]
    ds_read_b64_tr_b16 a[248:249], v217 offset:40960
    ds_read_b64_tr_b16 a[250:251], v217 offset:45056
    v_mfma_f32_16x16x32_bf16 v[12:15], a[8:11], a[124:127], v[12:15]
    v_fma_mix_f32 v69, v54, 1.0, v86 op_sel:[1,0,1] op_sel_hi:[1,0,1]
    v_fma_mix_f32 v70, v55, 1.0, v87 op_sel:[0,0,0] op_sel_hi:[1,0,1]
    v_mfma_f32_16x16x32_bf16 v[12:15], a[12:15], a[140:143], v[12:15]
    v_fma_mix_f32 v71, v55, 1.0, v87 op_sel:[1,0,1] op_sel_hi:[1,0,1]
    v_pk_fma_f32 v[20:21], v[20:21], v[246:247], v[68:69]
    v_mfma_f32_16x16x32_bf16 v[12:15], v[192:195], a[156:159], v[12:15]
    v_pk_fma_f32 v[22:23], v[22:23], v[246:247], v[70:71]
    v_mfma_f32_16x16x32_bf16 v[12:15], v[196:199], a[172:175], v[12:15]
    ds_read_b64_tr_b16 a[252:253], v217 offset:49152
    ds_read_b64_tr_b16 a[254:255], v217 offset:53248
    v_mfma_f32_16x16x32_bf16 v[12:15], v[200:203], a[196:199], v[12:15]
    buffer_load_dwordx4 v[116:119], v252, s[36:39], s5 offen offset:1024 sc1
    v_mfma_f32_16x16x32_bf16 v[12:15], v[204:207], a[212:215], v[12:15]
    s_waitcnt vmcnt(7)
    v_min_u32 v255, v57, v59
    v_min3_u32 v255, v255, v89, v91
    v_mfma_f32_16x16x32_bf16 v[28:31], v[208:211], a[124:127], v[28:31]
    v_cmp_le_i32 vcc, 0, v255
    v_mfma_f32_16x16x32_bf16 v[28:31], a[16:19], a[140:143], v[28:31]
    ds_read_b64_tr_b16 v[176:177], v217 offset:57344
    ds_read_b64_tr_b16 v[178:179], v217 offset:61440
    v_mfma_f32_16x16x32_bf16 v[28:31], a[20:23], a[156:159], v[28:31]
    s_cbranch_vccnz L_xr22
L_xb22:
    v_lshlrev_b32 v57, 1, v57
    v_mfma_f32_16x16x32_bf16 v[28:31], a[24:27], a[172:175], v[28:31]
    v_lshlrev_b32 v59, 1, v59
    v_lshlrev_b32 v89, 1, v89
    v_mfma_f32_16x16x32_bf16 v[28:31], a[28:31], a[196:199], v[28:31]
    v_lshlrev_b32 v91, 1, v91
    v_fma_mix_f32 v40, v56, 1.0, v88 op_sel:[0,0,0] op_sel_hi:[1,0,1]
    v_mfma_f32_16x16x32_bf16 v[28:31], a[176:179], a[212:215], v[28:31]
    s_waitcnt lgkmcnt(15)
    ds_read_b64_tr_b16 v[180:181], v225 offset:0
    ds_read_b64_tr_b16 v[182:183], v225 offset:4096
    v_mfma_f32_16x16x32_bf16 v[0:3], a[180:183], v[144:147], v[0:3]
    v_fma_mix_f32 v41, v56, 1.0, v88 op_sel:[1,0,1] op_sel_hi:[1,0,1]
    v_fma_mix_f32 v42, v57, 1.0, v89 op_sel:[0,0,0] op_sel_hi:[1,0,1]
    v_mfma_f32_16x16x32_bf16 v[0:3], a[0:3], v[128:131], v[0:3]
    v_fma_mix_f32 v43, v57, 1.0, v89 op_sel:[1,0,1] op_sel_hi:[1,0,1]
    v_pk_fma_f32 v[8:9], v[8:9], v[248:249], v[40:41]
    v_mfma_f32_16x16x32_bf16 v[0:3], a[4:7], v[160:163], v[0:3]
    v_pk_fma_f32 v[10:11], v[10:11], v[248:249], v[42:43]
    v_fma_mix_f32 v72, v58, 1.0, v90 op_sel:[0,0,0] op_sel_hi:[1,0,1]
    v_mfma_f32_16x16x32_bf16 v[0:3], a[216:219], a[32:35], v[0:3]
    ds_read_b64_tr_b16 v[184:185], v225 offset:8192
    ds_read_b64_tr_b16 v[186:187], v225 offset:12288
    v_mfma_f32_16x16x32_bf16 v[0:3], a[220:223], a[48:51], v[0:3]
    v_fma_mix_f32 v73, v58, 1.0, v90 op_sel:[1,0,1] op_sel_hi:[1,0,1]
    v_fma_mix_f32 v74, v59, 1.0, v91 op_sel:[0,0,0] op_sel_hi:[1,0,1]
    v_mfma_f32_16x16x32_bf16 v[0:3], a[224:227], a[64:67], v[0:3]
    s_waitcnt lgkmcnt(15)
    v_fma_mix_f32 v75, v59, 1.0, v91 op_sel:[1,0,1] op_sel_hi:[1,0,1]
    v_pk_fma_f32 v[24:25], v[24:25], v[248:249], v[72:73]
    v_mfma_f32_16x16x32_bf16 v[0:3], a[228:231], a[80:83], v[0:3]
    v_pk_fma_f32 v[26:27], v[26:27], v[248:249], v[74:75]
    v_mfma_f32_16x16x32_bf16 v[0:3], a[232:235], a[96:99], v[0:3]
    s_waitcnt lgkmcnt(14)
    buffer_load_dwordx4 v[120:123], v252, s[36:39], s5 offen offset:2048 sc1
    v_mfma_f32_16x16x32_bf16 v[16:19], a[236:239], v[144:147], v[16:19]
    s_waitcnt lgkmcnt(12)
    s_waitcnt vmcnt(5)
    v_min_u32 v255, v61, v63
    v_min3_u32 v255, v255, v93, v95
    v_mfma_f32_16x16x32_bf16 v[16:19], a[240:243], v[128:131], v[16:19]
    s_waitcnt lgkmcnt(10)
    v_cmp_le_i32 vcc, 0, v255
    v_mfma_f32_16x16x32_bf16 v[16:19], a[244:247], v[160:163], v[16:19]
    s_waitcnt lgkmcnt(8)
    s_cbranch_vccnz L_xr23
L_xb23:
    v_lshlrev_b32 v61, 1, v61
    v_mfma_f32_16x16x32_bf16 v[16:19], a[248:251], a[32:35], v[16:19]
    s_waitcnt lgkmcnt(6)
    v_lshlrev_b32 v63, 1, v63
    v_lshlrev_b32 v93, 1, v93
    v_mfma_f32_16x16x32_bf16 v[16:19], a[252:255], a[48:51], v[16:19]
    s_waitcnt lgkmcnt(4)
    v_lshlrev_b32 v95, 1, v95
    v_fma_mix_f32 v44, v60, 1.0, v92 op_sel:[0,0,0] op_sel_hi:[1,0,1]
    v_mfma_f32_16x16x32_bf16 v[16:19], v[176:179], a[64:67], v[16:19]
    s_waitcnt lgkmcnt(2)
    v_fma_mix_f32 v45, v60, 1.0, v92 op_sel:[1,0,1] op_sel_hi:[1,0,1]
    v_fma_mix_f32 v46, v61, 1.0, v93 op_sel:[0,0,0] op_sel_hi:[1,0,1]
    v_mfma_f32_16x16x32_bf16 v[16:19], v[180:183], a[80:83], v[16:19]
    s_waitcnt lgkmcnt(0)
    v_fma_mix_f32 v47, v61, 1.0, v93 op_sel:[1,0,1] op_sel_hi:[1,0,1]
    v_pk_fma_f32 v[12:13], v[12:13], v[250:251], v[44:45]
    v_mfma_f32_16x16x32_bf16 v[16:19], v[184:187], a[96:99], v[16:19]
    s_waitcnt vmcnt(2)
    v_min_u32 v255, v113, v115
    v_cmp_le_i32 vcc, 0, v255
    v_mfma_f32_16x16x32_bf16 v[4:7], a[180:183], v[148:151], v[4:7]
    s_cbranch_vccnz L_xr30
L_xb30:
    v_lshlrev_b32 v113, 1, v113
    v_mfma_f32_16x16x32_bf16 v[4:7], a[0:3], v[132:135], v[4:7]
    v_lshlrev_b32 v115, 1, v115
    v_fma_mix_f32 v0, v112, 1.0, v0 op_sel:[0,0,0] op_sel_hi:[1,0,0]
    v_mfma_f32_16x16x32_bf16 v[4:7], a[4:7], v[164:167], v[4:7]
    v_fma_mix_f32 v1, v112, 1.0, v1 op_sel:[1,0,0] op_sel_hi:[1,0,0]
    v_fma_mix_f32 v2, v113, 1.0, v2 op_sel:[0,0,0] op_sel_hi:[1,0,0]
    v_mfma_f32_16x16x32_bf16 v[4:7], a[216:219], a[36:39], v[4:7]
    v_fma_mix_f32 v3, v113, 1.0, v3 op_sel:[1,0,0] op_sel_hi:[1,0,0]
    v_cvt_pk_bf16_f32 v0, v0, v1
    v_mfma_f32_16x16x32_bf16 v[4:7], a[220:223], a[52:55], v[4:7]
    v_cvt_pk_bf16_f32 v1, v2, v3
    v_fma_mix_f32 v16, v114, 1.0, v16 op_sel:[0,0,0] op_sel_hi:[1,0,0]
    v_mfma_f32_16x16x32_bf16 v[4:7], a[224:227], a[68:71], v[4:7]
    v_fma_mix_f32 v17, v114, 1.0, v17 op_sel:[1,0,0] op_sel_hi:[1,0,0]
    v_fma_mix_f32 v18, v115, 1.0, v18 op_sel:[0,0,0] op_sel_hi:[1,0,0]
    v_mfma_f32_16x16x32_bf16 v[4:7], a[228:231], a[84:87], v[4:7]
    v_fma_mix_f32 v19, v115, 1.0, v19 op_sel:[1,0,0] op_sel_hi:[1,0,0]
    v_cvt_pk_bf16_f32 v2, v16, v17
    v_mfma_f32_16x16x32_bf16 v[4:7], a[232:235], a[100:103], v[4:7]
    buffer_load_dwordx4 v[124:127], v252, s[36:39], s5 offen offset:3072 sc1
    v_mfma_f32_16x16x32_bf16 v[20:23], a[236:239], v[148:151], v[20:23]
    v_cvt_pk_bf16_f32 v3, v18, v19
    v_pk_fma_f32 v[14:15], v[14:15], v[250:251], v[46:47]
    v_mfma_f32_16x16x32_bf16 v[20:23], a[240:243], v[132:135], v[20:23]
    v_permlane16_swap_b32 v0, v2
    v_mfma_f32_16x16x32_bf16 v[20:23], a[244:247], v[164:167], v[20:23]
    v_permlane16_swap_b32 v1, v3
    v_mfma_f32_16x16x32_bf16 v[20:23], a[248:251], a[36:39], v[20:23]
    buffer_store_dwordx4 v[0:3], v234, s[40:43], s7 offen sc0 sc1
    v_mfma_f32_16x16x32_bf16 v[20:23], a[252:255], a[52:55], v[20:23]
    s_add_u32 s7, s7, 0x20000
    v_fma_mix_f32 v76, v62, 1.0, v94 op_sel:[0,0,0] op_sel_hi:[1,0,1]
    v_mfma_f32_16x16x32_bf16 v[20:23], v[176:179], a[68:71], v[20:23]
    v_fma_mix_f32 v77, v62, 1.0, v94 op_sel:[1,0,1] op_sel_hi:[1,0,1]
    v_fma_mix_f32 v78, v63, 1.0, v95 op_sel:[0,0,0] op_sel_hi:[1,0,1]
    v_mfma_f32_16x16x32_bf16 v[20:23], v[180:183], a[84:87], v[20:23]
    v_fma_mix_f32 v79, v63, 1.0, v95 op_sel:[1,0,1] op_sel_hi:[1,0,1]
    v_pk_fma_f32 v[28:29], v[28:29], v[250:251], v[76:77]
    v_mfma_f32_16x16x32_bf16 v[20:23], v[184:187], a[100:103], v[20:23]
    s_waitcnt vmcnt(3)
    v_min_u32 v255, v117, v119
    v_cmp_le_i32 vcc, 0, v255
    v_mfma_f32_16x16x32_bf16 v[8:11], a[180:183], v[152:155], v[8:11]
    s_cbranch_vccnz L_xr31
L_xb31:
    v_lshlrev_b32 v117, 1, v117
    v_mfma_f32_16x16x32_bf16 v[8:11], a[0:3], v[136:139], v[8:11]
    v_lshlrev_b32 v119, 1, v119
    v_fma_mix_f32 v4, v116, 1.0, v4 op_sel:[0,0,0] op_sel_hi:[1,0,0]
    v_mfma_f32_16x16x32_bf16 v[8:11], a[4:7], v[168:171], v[8:11]
    v_fma_mix_f32 v5, v116, 1.0, v5 op_sel:[1,0,0] op_sel_hi:[1,0,0]
    v_fma_mix_f32 v6, v117, 1.0, v6 op_sel:[0,0,0] op_sel_hi:[1,0,0]
    v_mfma_f32_16x16x32_bf16 v[8:11], a[216:219], a[40:43], v[8:11]
    v_fma_mix_f32 v7, v117, 1.0, v7 op_sel:[1,0,0] op_sel_hi:[1,0,0]
    v_cvt_pk_bf16_f32 v4, v4, v5
    v_mfma_f32_16x16x32_bf16 v[8:11], a[220:223], a[56:59], v[8:11]
    v_cvt_pk_bf16_f32 v5, v6, v7
    v_fma_mix_f32 v20, v118, 1.0, v20 op_sel:[0,0,0] op_sel_hi:[1,0,0]
    v_mfma_f32_16x16x32_bf16 v[8:11], a[224:227], a[72:75], v[8:11]
    v_fma_mix_f32 v21, v118, 1.0, v21 op_sel:[1,0,0] op_sel_hi:[1,0,0]
    v_fma_mix_f32 v22, v119, 1.0, v22 op_sel:[0,0,0] op_sel_hi:[1,0,0]
    v_mfma_f32_16x16x32_bf16 v[8:11], a[228:231], a[88:91], v[8:11]
    v_fma_mix_f32 v23, v119, 1.0, v23 op_sel:[1,0,0] op_sel_hi:[1,0,0]
    v_cvt_pk_bf16_f32 v6, v20, v21
    v_mfma_f32_16x16x32_bf16 v[8:11], a[232:235], a[104:107], v[8:11]
    v_cvt_pk_bf16_f32 v7, v22, v23
    v_pk_fma_f32 v[30:31], v[30:31], v[250:251], v[78:79]
    v_mfma_f32_16x16x32_bf16 v[24:27], a[236:239], v[152:155], v[24:27]
    v_permlane16_swap_b32 v4, v6
    v_mfma_f32_16x16x32_bf16 v[24:27], a[240:243], v[136:139], v[24:27]
    v_permlane16_swap_b32 v5, v7
    v_mfma_f32_16x16x32_bf16 v[24:27], a[244:247], v[168:171], v[24:27]
    buffer_store_dwordx4 v[4:7], v234, s[40:43], s7 offen sc0 sc1
    v_mfma_f32_16x16x32_bf16 v[24:27], a[248:251], a[40:43], v[24:27]
    s_add_u32 s7, s7, 0x20000
    v_mfma_f32_16x16x32_bf16 v[24:27], a[252:255], a[56:59], v[24:27]
    v_mfma_f32_16x16x32_bf16 v[24:27], v[176:179], a[72:75], v[24:27]
    v_mfma_f32_16x16x32_bf16 v[24:27], v[180:183], a[88:91], v[24:27]
    v_mfma_f32_16x16x32_bf16 v[24:27], v[184:187], a[104:107], v[24:27]
    s_waitcnt vmcnt(3)
    v_min_u32 v255, v121, v123
    v_cmp_le_i32 vcc, 0, v255
    v_mfma_f32_16x16x32_bf16 v[12:15], a[180:183], v[156:159], v[12:15]
    s_cbranch_vccnz L_xr32
L_xb32:
    v_lshlrev_b32 v121, 1, v121
    v_mfma_f32_16x16x32_bf16 v[12:15], a[0:3], v[140:143], v[12:15]
    v_lshlrev_b32 v123, 1, v123
    v_fma_mix_f32 v8, v120, 1.0, v8 op_sel:[0,0,0] op_sel_hi:[1,0,0]
    v_mfma_f32_16x16x32_bf16 v[12:15], a[4:7], v[172:175], v[12:15]
    v_fma_mix_f32 v9, v120, 1.0, v9 op_sel:[1,0,0] op_sel_hi:[1,0,0]
    v_fma_mix_f32 v10, v121, 1.0, v10 op_sel:[0,0,0] op_sel_hi:[1,0,0]
    v_mfma_f32_16x16x32_bf16 v[12:15], a[216:219], a[44:47], v[12:15]
    v_fma_mix_f32 v11, v121, 1.0, v11 op_sel:[1,0,0] op_sel_hi:[1,0,0]
    v_cvt_pk_bf16_f32 v8, v8, v9
    v_mfma_f32_16x16x32_bf16 v[12:15], a[220:223], a[60:63], v[12:15]
    v_cvt_pk_bf16_f32 v9, v10, v11
    v_fma_mix_f32 v24, v122, 1.0, v24 op_sel:[0,0,0] op_sel_hi:[1,0,0]
    v_mfma_f32_16x16x32_bf16 v[12:15], a[224:227], a[76:79], v[12:15]
    v_fma_mix_f32 v25, v122, 1.0, v25 op_sel:[1,0,0] op_sel_hi:[1,0,0]
    v_fma_mix_f32 v26, v123, 1.0, v26 op_sel:[0,0,0] op_sel_hi:[1,0,0]
    v_mfma_f32_16x16x32_bf16 v[12:15], a[228:231], a[92:95], v[12:15]
    v_fma_mix_f32 v27, v123, 1.0, v27 op_sel:[1,0,0] op_sel_hi:[1,0,0]
    v_cvt_pk_bf16_f32 v10, v24, v25
    v_mfma_f32_16x16x32_bf16 v[12:15], a[232:235], a[108:111], v[12:15]
    v_cvt_pk_bf16_f32 v11, v26, v27
    v_mfma_f32_16x16x32_bf16 v[28:31], a[236:239], v[156:159], v[28:31]
    v_permlane16_swap_b32 v8, v10
    v_mfma_f32_16x16x32_bf16 v[28:31], a[240:243], v[140:143], v[28:31]
    v_permlane16_swap_b32 v9, v11
    v_mfma_f32_16x16x32_bf16 v[28:31], a[244:247], v[172:175], v[28:31]
    buffer_store_dwordx4 v[8:11], v234, s[40:43], s7 offen sc0 sc1
    v_mfma_f32_16x16x32_bf16 v[28:31], a[248:251], a[44:47], v[28:31]
    s_add_u32 s7, s7, 0x20000
    v_mfma_f32_16x16x32_bf16 v[28:31], a[252:255], a[60:63], v[28:31]
    v_mfma_f32_16x16x32_bf16 v[28:31], v[176:179], a[76:79], v[28:31]
    v_mfma_f32_16x16x32_bf16 v[28:31], v[180:183], a[92:95], v[28:31]
    v_mfma_f32_16x16x32_bf16 v[28:31], v[184:187], a[108:111], v[28:31]
    s_waitcnt vmcnt(3)
    v_min_u32 v255, v125, v127
    v_cmp_le_i32 vcc, 0, v255
    s_nop 1
    s_cbranch_vccnz L_xr33
L_xb33:
    v_lshlrev_b32 v125, 1, v125
    v_lshlrev_b32 v127, 1, v127
    v_fma_mix_f32 v12, v124, 1.0, v12 op_sel:[0,0,0] op_sel_hi:[1,0,0]
    v_fma_mix_f32 v13, v124, 1.0, v13 op_sel:[1,0,0] op_sel_hi:[1,0,0]
    v_fma_mix_f32 v14, v125, 1.0, v14 op_sel:[0,0,0] op_sel_hi:[1,0,0]
    v_fma_mix_f32 v15, v125, 1.0, v15 op_sel:[1,0,0] op_sel_hi:[1,0,0]
    v_cvt_pk_bf16_f32 v12, v12, v13
    v_cvt_pk_bf16_f32 v13, v14, v15
    v_fma_mix_f32 v28, v126, 1.0, v28 op_sel:[0,0,0] op_sel_hi:[1,0,0]
    v_fma_mix_f32 v29, v126, 1.0, v29 op_sel:[1,0,0] op_sel_hi:[1,0,0]
    v_fma_mix_f32 v30, v127, 1.0, v30 op_sel:[0,0,0] op_sel_hi:[1,0,0]
    v_fma_mix_f32 v31, v127, 1.0, v31 op_sel:[1,0,0] op_sel_hi:[1,0,0]
    v_cvt_pk_bf16_f32 v14, v28, v29
    v_cvt_pk_bf16_f32 v15, v30, v31
    s_nop 0
    v_permlane16_swap_b32 v12, v14
    v_permlane16_swap_b32 v13, v15
    buffer_store_dwordx4 v[12:15], v234, s[40:43], s7 offen sc0 sc1
L_exit:
    s_endpgm
L_att_z:
    ds_read_b128 a[236:239], v234 offset:15360
    ds_read_b128 a[232:235], v234 offset:14336
    ds_read_b128 a[228:231], v234 offset:13312
    s_cmp_ge_u32 s50, 3
    s_cselect_b64 s[100:101], -1, 0
    v_cndmask_b32 v64, v12, 0, s[100:101]
    v_cndmask_b32 v65, v12, 0, s[100:101]
    v_cndmask_b32 v66, v12, 0, s[100:101]
    v_cndmask_b32 v67, v12, 0, s[100:101]
    s_cmp_ge_u32 s50, 2
    s_cselect_b64 s[90:91], -1, 0
    v_cndmask_b32 v68, v12, 0, s[90:91]
    v_cndmask_b32 v69, v12, 0, s[90:91]
    v_cndmask_b32 v70, v12, 0, s[90:91]
    v_cndmask_b32 v71, v12, 0, s[90:91]
    s_cmp_ge_u32 s50, 1
    s_cselect_b64 s[94:95], -1, 0
    v_cndmask_b32 v72, v12, 0, s[94:95]
    v_cndmask_b32 v73, v12, 0, s[94:95]
    v_cndmask_b32 v74, v12, 0, s[94:95]
    v_cndmask_b32 v75, v12, 0, s[94:95]
    v_mov_b32 v20, v16
    v_mov_b32 v21, v17
    v_mov_b32 v22, v18
    v_mov_b32 v23, v19
    s_waitcnt lgkmcnt(2)
    v_mfma_f32_16x16x32_bf16 v[32:35], a[236:239], v[188:191], v[72:75]
    s_waitcnt lgkmcnt(1)
    v_mfma_f32_16x16x32_bf16 v[36:39], a[232:235], v[188:191], v[68:71]
    v_mfma_f32_16x16x32_bf16 v[40:43], a[236:239], v[184:187], v[72:75]
    v_mfma_f32_16x16x32_bf16 v[44:47], a[232:235], v[184:187], v[68:71]
    s_nop 3
    v_max3_f32 v19, v19, v32, v33
    v_max3_f32 v19, v19, v34, v35
    v_mfma_f32_16x16x32_bf16 v[48:51], a[236:239], v[180:183], v[72:75]
    v_max3_f32 v19, v19, v36, v37
    v_max3_f32 v19, v19, v38, v39
    v_mfma_f32_16x16x32_bf16 v[52:55], a[232:235], v[180:183], v[68:71]
    v_max3_f32 v18, v18, v40, v41
    v_max3_f32 v18, v18, v42, v43
    v_mfma_f32_16x16x32_bf16 v[32:35], a[236:239], v[176:179], v[72:75]
    v_max3_f32 v18, v18, v44, v45
    v_max3_f32 v18, v18, v46, v47
    v_mfma_f32_16x16x32_bf16 v[36:39], a[232:235], v[176:179], v[68:71]
    v_max3_f32 v17, v17, v48, v49
    v_max3_f32 v17, v17, v50, v51
    s_waitcnt lgkmcnt(0)
    v_mfma_f32_16x16x32_bf16 v[40:43], a[228:231], v[188:191], v[64:67]
    v_max3_f32 v17, v17, v52, v53
    v_max3_f32 v17, v17, v54, v55
    v_mfma_f32_16x16x32_bf16 v[44:47], a[228:231], v[184:187], v[64:67]
    v_max3_f32 v16, v16, v32, v33
    v_max3_f32 v16, v16, v34, v35
    v_mfma_f32_16x16x32_bf16 v[48:51], a[228:231], v[180:183], v[64:67]
    v_max3_f32 v16, v16, v36, v37
    v_max3_f32 v16, v16, v38, v39
    v_mfma_f32_16x16x32_bf16 v[52:55], a[228:231], v[176:179], v[64:67]
    v_max3_f32 v19, v19, v40, v41
    v_max3_f32 v19, v19, v42, v43
    v_max3_f32 v18, v18, v44, v45
    v_max3_f32 v18, v18, v46, v47
    s_nop 0
    v_max3_f32 v17, v17, v48, v49
    v_max3_f32 v17, v17, v50, v51
    s_nop 0
    v_max3_f32 v16, v16, v52, v53
    v_max3_f32 v16, v16, v54, v55
    ds_read2st64_b64 a[144:147], v235 offset0:92 offset1:94
    ds_read2st64_b64 a[148:151], v235 offset0:93 offset1:95
    ds_read2st64_b64 a[152:155], v235 offset0:88 offset1:90
    ds_read2st64_b64 a[156:159], v235 offset0:89 offset1:91
    v_mov_b32 v24, v16
    v_mov_b32 v25, v17
    v_mov_b32 v26, v18
    v_mov_b32 v27, v19
    v_permlane32_swap_b32 v16, v24
    v_permlane32_swap_b32 v17, v25
    v_permlane32_swap_b32 v18, v26
    v_permlane32_swap_b32 v19, v27
    v_max_f32 v16, v16, v24
    v_max_f32 v17, v17, v25
    v_max_f32 v18, v18, v26
    v_max_f32 v19, v19, v27
    v_mov_b32 v24, v16
    v_mov_b32 v25, v17
    v_mov_b32 v26, v18
    v_mov_b32 v27, v19
    v_permlane16_swap_b32 v16, v24
    v_permlane16_swap_b32 v17, v25
    v_permlane16_swap_b32 v18, v26
    v_permlane16_swap_b32 v19, v27
    v_max_f32 v16, v16, v24
    v_max_f32 v17, v17, v25
    v_max_f32 v18, v18, v26
    v_max_f32 v19, v19, v27
    v_sub_f32 v64, 0, v16
    v_sub_f32 v65, 0, v16
    v_sub_f32 v68, 0, v17
    v_sub_f32 v69, 0, v17
    v_sub_f32 v72, 0, v18
    v_sub_f32 v73, 0, v18
    v_sub_f32 v76, 0, v19
    v_sub_f32 v77, 0, v19
    v_mov_b64 v[66:67], v[64:65]
    v_mov_b64 v[70:71], v[68:69]
    v_mov_b64 v[74:75], v[72:73]
    v_mov_b64 v[78:79], v[76:77]
    v_cndmask_b32 v36, v12, v76, s[94:95]
    v_cndmask_b32 v37, v12, v76, s[94:95]
    v_cndmask_b32 v38, v12, v76, s[94:95]
    v_cndmask_b32 v39, v12, v76, s[94:95]
    v_cndmask_b32 v32, v12, v76, s[90:91]
    v_cndmask_b32 v33, v12, v76, s[90:91]
    v_cndmask_b32 v34, v12, v76, s[90:91]
    v_cndmask_b32 v35, v12, v76, s[90:91]
    v_mfma_f32_16x16x32_bf16 v[36:39], a[236:239], v[188:191], v[36:39]
    s_nop 0
    v_mfma_f32_16x16x32_bf16 v[32:35], a[232:235], v[188:191], v[32:35]
    v_cndmask_b32 v44, v12, v72, s[94:95]
    v_cndmask_b32 v45, v12, v72, s[94:95]
    v_cndmask_b32 v46, v12, v72, s[94:95]
    v_cndmask_b32 v47, v12, v72, s[94:95]
    v_cndmask_b32 v40, v12, v72, s[90:91]
    v_cndmask_b32 v41, v12, v72, s[90:91]
    v_cndmask_b32 v42, v12, v72, s[90:91]
    v_cndmask_b32 v43, v12, v72, s[90:91]
    v_mfma_f32_16x16x32_bf16 v[44:47], a[236:239], v[184:187], v[44:47]
    v_sub_f32 v27, v23, v19
    v_exp_f32 v27, v27
    s_nop 0
    v_mul_f32 v104, v104, v27
    v_mul_f32 v105, v105, v27
    v_mul_f32 v106, v106, v27
    v_mul_f32 v107, v107, v27
    v_mul_f32 v108, v108, v27
    v_mul_f32 v109, v109, v27
    v_mul_f32 v110, v110, v27
    v_mul_f32 v111, v111, v27
    v_mul_f32 v124, v124, v27
    v_mfma_f32_16x16x32_bf16 v[40:43], a[232:235], v[184:187], v[40:43]
    v_exp_f32 v36, v36
    v_exp_f32 v37, v37
    v_exp_f32 v38, v38
    v_exp_f32 v39, v39
    v_exp_f32 v32, v32
    v_exp_f32 v33, v33
    v_cvt_pk_bf16_f32 v58, v36, v37
    v_cvt_pk_bf16_f32 v59, v38, v39
    v_exp_f32 v34, v34
    v_exp_f32 v35, v35
    v_cvt_pk_bf16_f32 v56, v32, v33
    v_cvt_pk_bf16_f32 v57, v34, v35
    s_add_u32 m0, s61, 0x18000
    s_nop 0
    buffer_load_dwordx4 v232, s[40:43], s59 offen lds
    buffer_load_dwordx4 v233, s[40:43], s59 offen offset:1024 lds
    s_add_u32 s59, s59, 0x20000
    s_add_u32 s59, s59, s9
    s_sub_u32 s3, s59, 0x1c0000
    s_cmp_ge_u32 s59, s66
    s_cselect_b32 s59, s3, s59
    v_cndmask_b32 v36, v12, v68, s[94:95]
    v_cndmask_b32 v37, v12, v68, s[94:95]
    v_cndmask_b32 v38, v12, v68, s[94:95]
    v_cndmask_b32 v39, v12, v68, s[94:95]
    v_cndmask_b32 v32, v12, v68, s[90:91]
    v_cndmask_b32 v33, v12, v68, s[90:91]
    v_cndmask_b32 v34, v12, v68, s[90:91]
    v_cndmask_b32 v35, v12, v68, s[90:91]
    v_mfma_f32_16x16x32_bf16 v[36:39], a[236:239], v[180:183], v[36:39]
    v_sub_f32 v26, v22, v18
    v_exp_f32 v26, v26
    s_nop 0
    v_mul_f32 v96, v96, v26
    v_mul_f32 v97, v97, v26
    v_mfma_f32_16x16x32_bf16 v[32:35], a[232:235], v[180:183], v[32:35]
    v_mul_f32 v98, v98, v26
    v_mul_f32 v99, v99, v26
    v_mul_f32 v100, v100, v26
    v_mul_f32 v101, v101, v26
    v_mul_f32 v102, v102, v26
    s_waitcnt lgkmcnt(3)
    v_mfma_f32_16x16x32_bf16 v[104:107], a[144:147], v[56:59], v[104:107]
    v_mul_f32 v103, v103, v26
    v_mul_f32 v120, v120, v26
    v_exp_f32 v44, v44
    v_exp_f32 v45, v45
    s_waitcnt lgkmcnt(2)
    v_mfma_f32_16x16x32_bf16 v[108:111], a[148:151], v[56:59], v[108:111]
    v_exp_f32 v46, v46
    v_exp_f32 v47, v47
    v_exp_f32 v40, v40
    v_exp_f32 v41, v41
    v_cvt_pk_bf16_f32 v62, v44, v45
    v_mfma_f32_16x16x32_bf16 v[124:127], v[0:3], v[56:59], v[124:127]
    v_cvt_pk_bf16_f32 v63, v46, v47
    v_exp_f32 v42, v42
    v_exp_f32 v43, v43
    v_cvt_pk_bf16_f32 v60, v40, v41
    v_cvt_pk_bf16_f32 v61, v42, v43
    s_add_u32 m0, s61, 0x1a000
    s_nop 0
    buffer_load_dwordx4 v232, s[40:43], s59 offen lds
    buffer_load_dwordx4 v233, s[40:43], s59 offen offset:1024 lds
    s_add_u32 s59, s59, 0x10000
    buffer_load_dword v254, v253, s[44:47], s87 offen offset:4 sc1
    v_cndmask_b32 v44, v12, v64, s[94:95]
    v_cndmask_b32 v45, v12, v64, s[94:95]
    v_cndmask_b32 v46, v12, v64, s[94:95]
    v_cndmask_b32 v47, v12, v64, s[94:95]
    v_cndmask_b32 v40, v12, v64, s[90:91]
    v_cndmask_b32 v41, v12, v64, s[90:91]
    v_cndmask_b32 v42, v12, v64, s[90:91]
    v_cndmask_b32 v43, v12, v64, s[90:91]
    v_mfma_f32_16x16x32_bf16 v[44:47], a[236:239], v[176:179], v[44:47]
    v_sub_f32 v25, v21, v17
    v_exp_f32 v25, v25
    s_nop 0
    v_mul_f32 v88, v88, v25
    v_mul_f32 v89, v89, v25
    v_mfma_f32_16x16x32_bf16 v[40:43], a[232:235], v[176:179], v[40:43]
    v_mul_f32 v90, v90, v25
    v_mul_f32 v91, v91, v25
    v_mul_f32 v92, v92, v25
    v_mul_f32 v93, v93, v25
    v_mul_f32 v94, v94, v25
    v_mfma_f32_16x16x32_bf16 v[96:99], a[144:147], v[60:63], v[96:99]
    v_mul_f32 v95, v95, v25
    v_mul_f32 v116, v116, v25
    v_exp_f32 v36, v36
    v_exp_f32 v37, v37
    v_mfma_f32_16x16x32_bf16 v[100:103], a[148:151], v[60:63], v[100:103]
    v_exp_f32 v38, v38
    v_exp_f32 v39, v39
    v_exp_f32 v32, v32
    v_exp_f32 v33, v33
    v_cvt_pk_bf16_f32 v58, v36, v37
    v_mfma_f32_16x16x32_bf16 v[120:123], v[0:3], v[60:63], v[120:123]
    v_cvt_pk_bf16_f32 v59, v38, v39
    v_exp_f32 v34, v34
    v_exp_f32 v35, v35
    v_cvt_pk_bf16_f32 v56, v32, v33
    v_cvt_pk_bf16_f32 v57, v34, v35
    s_add_u32 m0, s61, 0x1c000
    s_nop 0
    buffer_load_dwordx4 v232, s[40:43], s59 offen lds
    buffer_load_dwordx4 v233, s[40:43], s59 offen offset:1024 lds
    s_add_u32 s59, s59, 0x30000
    v_cndmask_b32 v36, v12, v76, s[100:101]
    v_cndmask_b32 v37, v12, v76, s[100:101]
    v_cndmask_b32 v38, v12, v76, s[100:101]
    v_cndmask_b32 v39, v12, v76, s[100:101]
    s_nop 1
    v_mfma_f32_16x16x32_bf16 v[36:39], a[228:231], v[188:191], v[36:39]
    v_sub_f32 v24, v20, v16
    v_exp_f32 v24, v24
    s_nop 0
    v_mul_f32 v80, v80, v24
    v_mul_f32 v81, v81, v24
    v_mul_f32 v82, v82, v24
    v_mfma_f32_16x16x32_bf16 v[88:91], a[144:147], v[56:59], v[88:91]
    v_mul_f32 v83, v83, v24
    v_mul_f32 v84, v84, v24
    v_mul_f32 v85, v85, v24
    v_mul_f32 v86, v86, v24
    v_mul_f32 v87, v87, v24
    v_mul_f32 v112, v112, v24
    v_mfma_f32_16x16x32_bf16 v[92:95], a[148:151], v[56:59], v[92:95]
    v_exp_f32 v44, v44
    v_exp_f32 v45, v45
    v_exp_f32 v46, v46
    v_exp_f32 v47, v47
    v_exp_f32 v40, v40
    v_exp_f32 v41, v41
    v_mfma_f32_16x16x32_bf16 v[116:119], v[0:3], v[56:59], v[116:119]
    v_cvt_pk_bf16_f32 v62, v44, v45
    v_cvt_pk_bf16_f32 v63, v46, v47
    v_exp_f32 v42, v42
    v_exp_f32 v43, v43
    v_cvt_pk_bf16_f32 v60, v40, v41
    v_cvt_pk_bf16_f32 v61, v42, v43
    s_add_u32 m0, s61, 0x1e000
    s_nop 0
    buffer_load_dwordx4 v232, s[40:43], s59 offen lds
    buffer_load_dwordx4 v233, s[40:43], s59 offen offset:1024 lds
    s_add_u32 s59, s59, 0x10000
    v_cndmask_b32 v44, v12, v72, s[100:101]
    v_cndmask_b32 v45, v12, v72, s[100:101]
    v_cndmask_b32 v46, v12, v72, s[100:101]
    v_cndmask_b32 v47, v12, v72, s[100:101]
    s_nop 1
    v_mfma_f32_16x16x32_bf16 v[44:47], a[228:231], v[184:187], v[44:47]
    v_exp_f32 v36, v36
    v_mfma_f32_16x16x32_bf16 v[80:83], a[144:147], v[60:63], v[80:83]
    v_exp_f32 v37, v37
    v_exp_f32 v38, v38
    v_mfma_f32_16x16x32_bf16 v[84:87], a[148:151], v[60:63], v[84:87]
    v_exp_f32 v39, v39
    v_mov_b64 v[56:57], 0
    v_mfma_f32_16x16x32_bf16 v[112:115], v[0:3], v[60:63], v[112:115]
    v_cvt_pk_bf16_f32 v58, v36, v37
    v_cvt_pk_bf16_f32 v59, v38, v39
    s_add_u32 m0, s61, 0x20000
    s_nop 0
    buffer_load_dwordx4 v232, s[40:43], s59 offen lds
    buffer_load_dwordx4 v233, s[40:43], s59 offen offset:1024 lds
    s_add_u32 s59, s59, 0x20000
    s_sub_u32 s3, s59, 0x1c0000
    s_cmp_ge_u32 s59, s66
    s_cselect_b32 s59, s3, s59
    s_add_u32 s93, s87, 4
    s_mov_b32 s64, 0x8000
    s_waitcnt vmcnt(6)
L_sp_hz:
    v_cmp_ne_u32 vcc, s88, v254
    s_sub_u32 s64, s64, 1
    s_cmp_eq_u32 s64, 0
    s_cbranch_scc1 L_sg_hz
    s_nop 1
    s_cbranch_vccz L_sg_hz
    buffer_load_dword v254, v253, s[44:47], s93 offen sc1
    s_waitcnt vmcnt(0)
    s_branch L_sp_hz
L_sg_hz:
    v_cndmask_b32 v36, v12, v68, s[100:101]
    v_cndmask_b32 v37, v12, v68, s[100:101]
    v_cndmask_b32 v38, v12, v68, s[100:101]
    v_cndmask_b32 v39, v12, v68, s[100:101]
    s_nop 1
    v_mfma_f32_16x16x32_bf16 v[36:39], a[228:231], v[180:183], v[36:39]
    v_exp_f32 v44, v44
    s_waitcnt lgkmcnt(1)
    v_mfma_f32_16x16x32_bf16 v[104:107], a[152:155], v[56:59], v[104:107]
    v_exp_f32 v45, v45
    v_exp_f32 v46, v46
    s_waitcnt lgkmcnt(0)
    v_mfma_f32_16x16x32_bf16 v[108:111], a[156:159], v[56:59], v[108:111]
    v_exp_f32 v47, v47
    v_mov_b64 v[60:61], 0
    v_mfma_f32_16x16x32_bf16 v[124:127], v[0:3], v[56:59], v[124:127]
    v_cvt_pk_bf16_f32 v62, v44, v45
    v_cvt_pk_bf16_f32 v63, v46, v47
    buffer_load_dwordx4 a[32:35], v252, s[36:39], s58 offen offset:0 sc1
    buffer_load_dwordx4 a[36:39], v252, s[36:39], s58 offen offset:1024 sc1
    v_cndmask_b32 v44, v12, v64, s[100:101]
    v_cndmask_b32 v45, v12, v64, s[100:101]
    v_cndmask_b32 v46, v12, v64, s[100:101]
    v_cndmask_b32 v47, v12, v64, s[100:101]
    s_nop 1
    v_mfma_f32_16x16x32_bf16 v[44:47], a[228:231], v[176:179], v[44:47]
    v_exp_f32 v36, v36
    v_exp_f32 v37, v37
    v_exp_f32 v38, v38
    v_exp_f32 v39, v39
    v_mov_b64 v[56:57], 0
    v_mfma_f32_16x16x32_bf16 v[96:99], a[152:155], v[60:63], v[96:99]
    v_cvt_pk_bf16_f32 v58, v36, v37
    v_cvt_pk_bf16_f32 v59, v38, v39
    v_rcp_f32 v31, v124
    s_nop 0
    v_mul_f32 v31, v31, v250
    v_mul_f32 v104, v104, v31
    v_mfma_f32_16x16x32_bf16 v[100:103], a[156:159], v[60:63], v[100:103]
    v_mul_f32 v105, v105, v31
    v_mul_f32 v106, v106, v31
    v_mul_f32 v107, v107, v31
    v_mul_f32 v108, v108, v31
    v_mul_f32 v109, v109, v31
    v_mfma_f32_16x16x32_bf16 v[120:123], v[0:3], v[60:63], v[120:123]
    v_mul_f32 v110, v110, v31
    v_mul_f32 v111, v111, v31
    v_cvt_pk_bf16_f32 v188, v104, v105
    v_cvt_pk_bf16_f32 v189, v106, v107
    v_cvt_pk_bf16_f32 v190, v108, v109
    v_cvt_pk_bf16_f32 v191, v110, v111
    buffer_load_dwordx4 a[40:43], v252, s[36:39], s58 offen offset:2048 sc1
    buffer_load_dwordx4 a[44:47], v252, s[36:39], s58 offen offset:3072 sc1
    s_add_u32 s58, s58, 0x4000
    v_mfma_f32_16x16x32_bf16 v[88:91], a[152:155], v[56:59], v[88:91]
    v_exp_f32 v44, v44
    v_exp_f32 v45, v45
    v_exp_f32 v46, v46
    v_exp_f32 v47, v47
    v_mov_b64 v[60:61], 0
    v_cvt_pk_bf16_f32 v62, v44, v45
    v_cvt_pk_bf16_f32 v63, v46, v47
    v_mfma_f32_16x16x32_bf16 v[92:95], a[156:159], v[56:59], v[92:95]
    v_rcp_f32 v30, v120
    s_nop 0
    v_mul_f32 v30, v30, v248
    v_mul_f32 v96, v96, v30
    v_mul_f32 v97, v97, v30
    v_mul_f32 v98, v98, v30
    v_mul_f32 v99, v99, v30
    v_mul_f32 v100, v100, v30
    v_mfma_f32_16x16x32_bf16 v[116:119], v[0:3], v[56:59], v[116:119]
    v_mul_f32 v101, v101, v30
    v_mul_f32 v102, v102, v30
    v_mul_f32 v103, v103, v30
    v_cvt_pk_bf16_f32 v184, v96, v97
    v_cvt_pk_bf16_f32 v185, v98, v99
    v_cvt_pk_bf16_f32 v186, v100, v101
    v_cvt_pk_bf16_f32 v187, v102, v103
    buffer_load_dwordx4 a[48:51], v252, s[36:39], s58 offen offset:0 sc1
    buffer_load_dwordx4 a[52:55], v252, s[36:39], s58 offen offset:1024 sc1
    v_mfma_f32_16x16x32_bf16 v[80:83], a[152:155], v[60:63], v[80:83]
    v_rcp_f32 v29, v116
    s_nop 0
    v_mul_f32 v29, v29, v246
    v_mul_f32 v88, v88, v29
    v_mul_f32 v89, v89, v29
    v_mfma_f32_16x16x32_bf16 v[84:87], a[156:159], v[60:63], v[84:87]
    v_mul_f32 v90, v90, v29
    v_mul_f32 v91, v91, v29
    v_mul_f32 v92, v92, v29
    v_mul_f32 v93, v93, v29
    v_mul_f32 v94, v94, v29
    v_mfma_f32_16x16x32_bf16 v[112:115], v[0:3], v[60:63], v[112:115]
    v_mul_f32 v95, v95, v29
    v_cvt_pk_bf16_f32 v180, v88, v89
    v_cvt_pk_bf16_f32 v181, v90, v91
    v_cvt_pk_bf16_f32 v182, v92, v93
    v_cvt_pk_bf16_f32 v183, v94, v95
    buffer_load_dwordx4 a[56:59], v252, s[36:39], s58 offen offset:2048 sc1
    buffer_load_dwordx4 a[60:63], v252, s[36:39], s58 offen offset:3072 sc1
    s_add_u32 s58, s58, 0x8000
    s_add_u32 s58, s58, s8
    s_sub_u32 s3, s58, 0x70000
    s_cmp_ge_u32 s58, s55
    s_cselect_b32 s58, s3, s58
    buffer_load_dwordx4 a[64:67], v252, s[36:39], s58 offen offset:0 sc1
    buffer_load_dwordx4 a[68:71], v252, s[36:39], s58 offen offset:1024 sc1
    buffer_load_dwordx4 a[72:75], v252, s[36:39], s58 offen offset:2048 sc1
    buffer_load_dwordx4 a[76:79], v252, s[36:39], s58 offen offset:3072 sc1
    s_add_u32 s58, s58, 0x4000
    buffer_load_dwordx4 a[80:83], v252, s[36:39], s58 offen offset:0 sc1
    buffer_load_dwordx4 a[84:87], v252, s[36:39], s58 offen offset:1024 sc1
    buffer_load_dwordx4 a[88:91], v252, s[36:39], s58 offen offset:2048 sc1
    buffer_load_dwordx4 a[92:95], v252, s[36:39], s58 offen offset:3072 sc1
    s_add_u32 s58, s58, 0xc000
    buffer_load_dwordx4 a[96:99], v252, s[36:39], s58 offen offset:0 sc1
    buffer_load_dwordx4 a[100:103], v252, s[36:39], s58 offen offset:1024 sc1
    buffer_load_dwordx4 a[104:107], v252, s[36:39], s58 offen offset:2048 sc1
    buffer_load_dwordx4 a[108:111], v252, s[36:39], s58 offen offset:3072 sc1
    s_add_u32 s58, s58, 0x4000
    s_add_u32 s92, s85, 0x8000
    buffer_store_dwordx4 v[160:163], v252, s[36:39], s92 offen offset:0 sc1
    buffer_store_dwordx4 v[164:167], v252, s[36:39], s92 offen offset:1024 sc1
    buffer_store_dwordx4 v[168:171], v252, s[36:39], s92 offen offset:2048 sc1
    buffer_store_dwordx4 v[172:175], v252, s[36:39], s92 offen offset:3072 sc1
    buffer_store_dwordx4 v[192:195], v236, s[36:39], s86 offen offset:0 sc1
    buffer_store_dwordx4 v[200:203], v236, s[36:39], s86 offen offset:2048 sc1
    s_waitcnt vmcnt(22) lgkmcnt(0)
    ds_read_b64_tr_b16 a[0:1], v223 offset:16384
    ds_read_b64_tr_b16 a[2:3], v223 offset:20480
    ds_read_b64_tr_b16 a[4:5], v223 offset:24576
    ds_read_b64_tr_b16 a[6:7], v223 offset:28672
    ds_read_b64_tr_b16 a[8:9], v223 offset:32768
    ds_read_b64_tr_b16 a[10:11], v223 offset:36864
    ds_read_b64_tr_b16 a[12:13], v220 offset:40960
    ds_read_b64_tr_b16 a[14:15], v220 offset:45056
    ds_read_b64_tr_b16 a[16:17], v221 offset:40960
    ds_read_b64_tr_b16 a[18:19], v221 offset:45056
    ds_read_b64_tr_b16 a[20:21], v222 offset:40960
    ds_read_b64_tr_b16 a[22:23], v222 offset:45056
    ds_read_b64_tr_b16 a[24:25], v223 offset:40960
    ds_read_b64_tr_b16 a[26:27], v223 offset:45056
    s_waitcnt lgkmcnt(0)
    v_mfma_f32_16x16x32_bf16 a[224:227], a[0:3], v[144:147], 0
    v_mfma_f32_16x16x32_bf16 a[228:231], a[0:3], v[148:151], 0
    v_mfma_f32_16x16x32_bf16 a[232:235], a[0:3], v[152:155], 0
    v_mfma_f32_16x16x32_bf16 a[236:239], a[0:3], v[156:159], 0
    v_mfma_f32_16x16x32_bf16 a[224:227], a[4:7], v[128:131], a[224:227]
    v_mfma_f32_16x16x32_bf16 a[228:231], a[4:7], v[132:135], a[228:231]
    v_mfma_f32_16x16x32_bf16 a[232:235], a[4:7], v[136:139], a[232:235]
    v_mfma_f32_16x16x32_bf16 a[236:239], a[4:7], v[140:143], a[236:239]
    v_mfma_f32_16x16x32_bf16 a[224:227], a[8:11], v[160:163], a[224:227]
    v_mfma_f32_16x16x32_bf16 a[228:231], a[8:11], v[164:167], a[228:231]
    v_mfma_f32_16x16x32_bf16 a[232:235], a[8:11], v[168:171], a[232:235]
    v_mfma_f32_16x16x32_bf16 a[236:239], a[8:11], v[172:175], a[236:239]
    v_mfma_f32_16x16x32_bf16 a[112:115], a[12:15], a[32:35], a[112:115]
    v_mfma_f32_16x16x32_bf16 a[116:119], a[12:15], a[36:39], a[116:119]
    v_mfma_f32_16x16x32_bf16 a[120:123], a[12:15], a[40:43], a[120:123]
    v_mfma_f32_16x16x32_bf16 a[124:127], a[12:15], a[44:47], a[124:127]
    v_mfma_f32_16x16x32_bf16 a[128:131], a[16:19], a[32:35], a[128:131]
    v_mfma_f32_16x16x32_bf16 a[132:135], a[16:19], a[36:39], a[132:135]
    v_mfma_f32_16x16x32_bf16 a[136:139], a[16:19], a[40:43], a[136:139]
    v_mfma_f32_16x16x32_bf16 a[140:143], a[16:19], a[44:47], a[140:143]
    v_mfma_f32_16x16x32_bf16 a[240:243], a[20:23], a[32:35], a[240:243]
    v_mfma_f32_16x16x32_bf16 a[244:247], a[20:23], a[36:39], a[244:247]
    v_mfma_f32_16x16x32_bf16 a[248:251], a[20:23], a[40:43], a[248:251]
    v_mfma_f32_16x16x32_bf16 a[252:255], a[20:23], a[44:47], a[252:255]
    v_mfma_f32_16x16x32_bf16 a[224:227], a[24:27], a[32:35], a[224:227]
    v_mfma_f32_16x16x32_bf16 a[228:231], a[24:27], a[36:39], a[228:231]
    v_mfma_f32_16x16x32_bf16 a[232:235], a[24:27], a[40:43], a[232:235]
    v_mfma_f32_16x16x32_bf16 a[236:239], a[24:27], a[44:47], a[236:239]
    ds_read_b64_tr_b16 a[0:1], v216 offset:16384
    ds_read_b64_tr_b16 a[2:3], v216 offset:20480
    ds_read_b64_tr_b16 a[4:5], v216 offset:24576
    ds_read_b64_tr_b16 a[6:7], v216 offset:28672
    ds_read_b64_tr_b16 a[8:9], v217 offset:16384
    ds_read_b64_tr_b16 a[10:11], v217 offset:20480
    ds_read_b64_tr_b16 a[12:13], v217 offset:24576
    ds_read_b64_tr_b16 a[14:15], v217 offset:28672
    s_nop 7
    s_branch L_att_join
L_xr20:
    s_mov_b32 s64, 0x8000
    s_add_u32 s4, s51, 3
    s_and_b32 s4, s4, 3
    s_mul_i32 s4, s4, 0x70000
    s_add_u32 s4, s4, s67
    s_add_u32 s3, s51, 2
    s_and_b32 s3, s3, 3
    s_mul_i32 s3, s3, 0x70000
    s_add_u32 s3, s3, s67
    s_add_u32 s3, s3, 0x4000
L_xs20:
    buffer_load_dwordx4 v[48:51], v252, s[36:39], s4 offen offset:0 sc1
    buffer_load_dwordx4 v[80:83], v252, s[36:39], s3 offen offset:0 sc1
    buffer_load_dwordx4 v[52:55], v252, s[36:39], s4 offen offset:1024 sc1
    buffer_load_dwordx4 v[84:87], v252, s[36:39], s3 offen offset:1024 sc1
    buffer_load_dwordx4 v[56:59], v252, s[36:39], s4 offen offset:2048 sc1
    buffer_load_dwordx4 v[88:91], v252, s[36:39], s3 offen offset:2048 sc1
    buffer_load_dwordx4 v[60:63], v252, s[36:39], s4 offen offset:3072 sc1
    buffer_load_dwordx4 v[92:95], v252, s[36:39], s3 offen offset:3072 sc1
    s_mov_b32 s101, 2
L_xd20:
    s_nop 15
    s_nop 15
    s_nop 15
    buffer_load_dword v218, off, s[36:39], s4 offset:1020 sc1
    buffer_load_dword v219, off, s[36:39], s3 offset:1020 sc1
    s_sub_u32 s101, s101, 1
    s_cbranch_scc0 L_xd20
    s_waitcnt vmcnt(6)
    v_min_u32 v255, v49, v51
    v_min3_u32 v255, v255, v81, v83
    v_cmp_le_i32 vcc, 0, v255
    s_sub_u32 s64, s64, 1
    s_cbranch_scc1 L_xb20
    s_nop 1
    s_cbranch_vccz L_xb20
L_xh20:
    s_waitcnt vmcnt(4)
    v_min_u32 v255, v218, v219
    buffer_load_dword v218, off, s[36:39], s4 offset:1020 sc1
    buffer_load_dword v219, off, s[36:39], s3 offset:1020 sc1
    v_cmp_le_i32 vcc, 0, v255
    s_sub_u32 s64, s64, 1
    s_cbranch_scc1 L_xb20
    s_nop 1
    s_cbranch_vccnz L_xh20
    buffer_load_dwordx4 v[48:51], v252, s[36:39], s4 offen offset:0 sc1
    buffer_load_dwordx4 v[80:83], v252, s[36:39], s3 offen offset:0 sc1
    buffer_load_dwordx4 v[52:55], v252, s[36:39], s4 offen offset:1024 sc1
    buffer_load_dwordx4 v[84:87], v252, s[36:39], s3 offen offset:1024 sc1
    buffer_load_dwordx4 v[56:59], v252, s[36:39], s4 offen offset:2048 sc1
    buffer_load_dwordx4 v[88:91], v252, s[36:39], s3 offen offset:2048 sc1
    buffer_load_dwordx4 v[60:63], v252, s[36:39], s4 offen offset:3072 sc1
    buffer_load_dwordx4 v[92:95], v252, s[36:39], s3 offen offset:3072 sc1
    s_waitcnt vmcnt(0)
    v_min_u32 v255, v49, v51
    v_min3_u32 v255, v255, v81, v83
    v_cmp_le_i32 vcc, 0, v255
    s_nop 3
    s_cbranch_vccnz L_xs20
    s_branch L_xb20
L_xr21:
    s_mov_b32 s64, 0x8000
    s_add_u32 s4, s51, 3
    s_and_b32 s4, s4, 3
    s_mul_i32 s4, s4, 0x70000
    s_add_u32 s4, s4, s67
    s_add_u32 s3, s51, 2
    s_and_b32 s3, s3, 3
    s_mul_i32 s3, s3, 0x70000
    s_add_u32 s3, s3, s67
    s_add_u32 s3, s3, 0x4000
L_xs21:
    buffer_load_dwordx4 v[52:55], v252, s[36:39], s4 offen offset:1024 sc1
    buffer_load_dwordx4 v[84:87], v252, s[36:39], s3 offen offset:1024 sc1
    buffer_load_dwordx4 v[56:59], v252, s[36:39], s4 offen offset:2048 sc1
    buffer_load_dwordx4 v[88:91], v252, s[36:39], s3 offen offset:2048 sc1
    buffer_load_dwordx4 v[60:63], v252, s[36:39], s4 offen offset:3072 sc1
    buffer_load_dwordx4 v[92:95], v252, s[36:39], s3 offen offset:3072 sc1
    s_mov_b32 s101, 2
L_xd21:
    s_nop 15
    s_nop 15
    s_nop 15
    buffer_load_dword v218, off, s[36:39], s4 offset:2044 sc1
    buffer_load_dword v219, off, s[36:39], s3 offset:2044 sc1
    s_sub_u32 s101, s101, 1
    s_cbranch_scc0 L_xd21
    s_waitcnt vmcnt(6)
    v_min_u32 v255, v53, v55
    v_min3_u32 v255, v255, v85, v87
    v_cmp_le_i32 vcc, 0, v255
    s_sub_u32 s64, s64, 1
    s_cbranch_scc1 L_xb21
    s_nop 1
    s_cbranch_vccz L_xb21
L_xh21:
    s_waitcnt vmcnt(4)
    v_min_u32 v255, v218, v219
    buffer_load_dword v218, off, s[36:39], s4 offset:2044 sc1
    buffer_load_dword v219, off, s[36:39], s3 offset:2044 sc1
    v_cmp_le_i32 vcc, 0, v255
    s_sub_u32 s64, s64, 1
    s_cbranch_scc1 L_xb21
    s_nop 1
    s_cbranch_vccnz L_xh21
    buffer_load_dwordx4 v[52:55], v252, s[36:39], s4 offen offset:1024 sc1
    buffer_load_dwordx4 v[84:87], v252, s[36:39], s3 offen offset:1024 sc1
    buffer_load_dwordx4 v[56:59], v252, s[36:39], s4 offen offset:2048 sc1
    buffer_load_dwordx4 v[88:91], v252, s[36:39], s3 offen offset:2048 sc1
    buffer_load_dwordx4 v[60:63], v252, s[36:39], s4 offen offset:3072 sc1
    buffer_load_dwordx4 v[92:95], v252, s[36:39], s3 offen offset:3072 sc1
    s_waitcnt vmcnt(0)
    v_min_u32 v255, v53, v55
    v_min3_u32 v255, v255, v85, v87
    v_cmp_le_i32 vcc, 0, v255
    s_nop 3
    s_cbranch_vccnz L_xs21
    s_branch L_xb21
L_xr22:
    s_mov_b32 s64, 0x8000
    s_add_u32 s4, s51, 3
    s_and_b32 s4, s4, 3
    s_mul_i32 s4, s4, 0x70000
    s_add_u32 s4, s4, s67
    s_add_u32 s3, s51, 2
    s_and_b32 s3, s3, 3
    s_mul_i32 s3, s3, 0x70000
    s_add_u32 s3, s3, s67
    s_add_u32 s3, s3, 0x4000
L_xs22:
    buffer_load_dwordx4 v[56:59], v252, s[36:39], s4 offen offset:2048 sc1
    buffer_load_dwordx4 v[88:91], v252, s[36:39], s3 offen offset:2048 sc1
    buffer_load_dwordx4 v[60:63], v252, s[36:39], s4 offen offset:3072 sc1
    buffer_load_dwordx4 v[92:95], v252, s[36:39], s3 offen offset:3072 sc1
    s_mov_b32 s101, 2
L_xd22:
    s_nop 15
    s_nop 15
    s_nop 15
    buffer_load_dword v218, off, s[36:39], s4 offset:3068 sc1
    buffer_load_dword v219, off, s[36:39], s3 offset:3068 sc1
    s_sub_u32 s101, s101, 1
    s_cbranch_scc0 L_xd22
    s_waitcnt vmcnt(6)
    v_min_u32 v255, v57, v59
    v_min3_u32 v255, v255, v89, v91
    v_cmp_le_i32 vcc, 0, v255
    s_sub_u32 s64, s64, 1
    s_cbranch_scc1 L_xb22
    s_nop 1
    s_cbranch_vccz L_xb22
L_xh22:
    s_waitcnt vmcnt(4)
    v_min_u32 v255, v218, v219
    buffer_load_dword v218, off, s[36:39], s4 offset:3068 sc1
    buffer_load_dword v219, off, s[36:39], s3 offset:3068 sc1
    v_cmp_le_i32 vcc, 0, v255
    s_sub_u32 s64, s64, 1
    s_cbranch_scc1 L_xb22
    s_nop 1
    s_cbranch_vccnz L_xh22
    buffer_load_dwordx4 v[56:59], v252, s[36:39], s4 offen offset:2048 sc1
    buffer_load_dwordx4 v[88:91], v252, s[36:39], s3 offen offset:2048 sc1
    buffer_load_dwordx4 v[60:63], v252, s[36:39], s4 offen offset:3072 sc1
    buffer_load_dwordx4 v[92:95], v252, s[36:39], s3 offen offset:3072 sc1
    s_waitcnt vmcnt(0)
    v_min_u32 v255, v57, v59
    v_min3_u32 v255, v255, v89, v91
    v_cmp_le_i32 vcc, 0, v255
    s_nop 3
    s_cbranch_vccnz L_xs22
    s_branch L_xb22
L_xr23:
    s_mov_b32 s64, 0x8000
    s_add_u32 s4, s51, 3
    s_and_b32 s4, s4, 3
    s_mul_i32 s4, s4, 0x70000
    s_add_u32 s4, s4, s67
    s_add_u32 s3, s51, 2
    s_and_b32 s3, s3, 3
    s_mul_i32 s3, s3, 0x70000
    s_add_u32 s3, s3, s67
    s_add_u32 s3, s3, 0x4000
L_xs23:
    buffer_load_dwordx4 v[60:63], v252, s[36:39], s4 offen offset:3072 sc1
    buffer_load_dwordx4 v[92:95], v252, s[36:39], s3 offen offset:3072 sc1
    s_mov_b32 s101, 2
L_xd23:
    s_nop 15
    s_nop 15
    s_nop 15
    buffer_load_dword v218, off, s[36:39], s4 offset:4092 sc1
    buffer_load_dword v219, off, s[36:39], s3 offset:4092 sc1
    s_sub_u32 s101, s101, 1
    s_cbranch_scc0 L_xd23
    s_waitcnt vmcnt(6)
    v_min_u32 v255, v61, v63
    v_min3_u32 v255, v255, v93, v95
    v_cmp_le_i32 vcc, 0, v255
    s_sub_u32 s64, s64, 1
    s_cbranch_scc1 L_xb23
    s_nop 1
    s_cbranch_vccz L_xb23
L_xh23:
    s_waitcnt vmcnt(4)
    v_min_u32 v255, v218, v219
    buffer_load_dword v218, off, s[36:39], s4 offset:4092 sc1
    buffer_load_dword v219, off, s[36:39], s3 offset:4092 sc1
    v_cmp_le_i32 vcc, 0, v255
    s_sub_u32 s64, s64, 1
    s_cbranch_scc1 L_xb23
    s_nop 1
    s_cbranch_vccnz L_xh23
    buffer_load_dwordx4 v[60:63], v252, s[36:39], s4 offen offset:3072 sc1
    buffer_load_dwordx4 v[92:95], v252, s[36:39], s3 offen offset:3072 sc1
    s_waitcnt vmcnt(0)
    v_min_u32 v255, v61, v63
    v_min3_u32 v255, v255, v93, v95
    v_cmp_le_i32 vcc, 0, v255
    s_nop 3
    s_cbranch_vccnz L_xs23
    s_branch L_xb23
L_xr30:
    s_mov_b32 s64, 0x8000
    s_add_u32 s4, s51, 1
    s_and_b32 s4, s4, 3
    s_mul_i32 s4, s4, 0x70000
    s_add_u32 s4, s4, s67
    s_add_u32 s4, s4, 0x8000
L_xs30:
    buffer_load_dwordx4 v[112:115], v252, s[36:39], s4 offen offset:0 sc1
    buffer_load_dwordx4 v[116:119], v252, s[36:39], s4 offen offset:1024 sc1
    buffer_load_dwordx4 v[120:123], v252, s[36:39], s4 offen offset:2048 sc1
    s_mov_b32 s101, 2
L_xd30:
    s_nop 15
    s_nop 15
    s_nop 15
    buffer_load_dword v218, off, s[36:39], s4 offset:1020 sc1
    s_sub_u32 s101, s101, 1
    s_cbranch_scc0 L_xd30
    s_waitcnt vmcnt(3)
    v_min_u32 v255, v113, v115
    v_cmp_le_i32 vcc, 0, v255
    s_sub_u32 s64, s64, 1
    s_cbranch_scc1 L_xb30
    s_nop 1
    s_cbranch_vccz L_xb30
L_xh30:
    s_waitcnt vmcnt(2)
    v_min_u32 v255, v218, v218
    buffer_load_dword v218, off, s[36:39], s4 offset:1020 sc1
    v_cmp_le_i32 vcc, 0, v255
    s_sub_u32 s64, s64, 1
    s_cbranch_scc1 L_xb30
    s_nop 1
    s_cbranch_vccnz L_xh30
    buffer_load_dwordx4 v[112:115], v252, s[36:39], s4 offen offset:0 sc1
    buffer_load_dwordx4 v[116:119], v252, s[36:39], s4 offen offset:1024 sc1
    buffer_load_dwordx4 v[120:123], v252, s[36:39], s4 offen offset:2048 sc1
    s_waitcnt vmcnt(0)
    v_min_u32 v255, v113, v115
    v_cmp_le_i32 vcc, 0, v255
    s_nop 3
    s_cbranch_vccnz L_xs30
    s_branch L_xb30
L_xr31:
    s_mov_b32 s64, 0x8000
    s_add_u32 s4, s51, 1
    s_and_b32 s4, s4, 3
    s_mul_i32 s4, s4, 0x70000
    s_add_u32 s4, s4, s67
    s_add_u32 s4, s4, 0x8000
L_xs31:
    buffer_load_dwordx4 v[116:119], v252, s[36:39], s4 offen offset:1024 sc1
    buffer_load_dwordx4 v[120:123], v252, s[36:39], s4 offen offset:2048 sc1
    buffer_load_dwordx4 v[124:127], v252, s[36:39], s4 offen offset:3072 sc1
    s_mov_b32 s101, 2
L_xd31:
    s_nop 15
    s_nop 15
    s_nop 15
    buffer_load_dword v218, off, s[36:39], s4 offset:2044 sc1
    s_sub_u32 s101, s101, 1
    s_cbranch_scc0 L_xd31
    s_waitcnt vmcnt(3)
    v_min_u32 v255, v117, v119
    v_cmp_le_i32 vcc, 0, v255
    s_sub_u32 s64, s64, 1
    s_cbranch_scc1 L_xb31
    s_nop 1
    s_cbranch_vccz L_xb31
L_xh31:
    s_waitcnt vmcnt(2)
    v_min_u32 v255, v218, v218
    buffer_load_dword v218, off, s[36:39], s4 offset:2044 sc1
    v_cmp_le_i32 vcc, 0, v255
    s_sub_u32 s64, s64, 1
    s_cbranch_scc1 L_xb31
    s_nop 1
    s_cbranch_vccnz L_xh31
    buffer_load_dwordx4 v[116:119], v252, s[36:39], s4 offen offset:1024 sc1
    buffer_load_dwordx4 v[120:123], v252, s[36:39], s4 offen offset:2048 sc1
    buffer_load_dwordx4 v[124:127], v252, s[36:39], s4 offen offset:3072 sc1
    s_waitcnt vmcnt(0)
    v_min_u32 v255, v117, v119
    v_cmp_le_i32 vcc, 0, v255
    s_nop 3
    s_cbranch_vccnz L_xs31
    s_branch L_xb31
L_xr32:
    s_mov_b32 s64, 0x8000
    s_add_u32 s4, s51, 1
    s_and_b32 s4, s4, 3
    s_mul_i32 s4, s4, 0x70000
    s_add_u32 s4, s4, s67
    s_add_u32 s4, s4, 0x8000
L_xs32:
    buffer_load_dwordx4 v[120:123], v252, s[36:39], s4 offen offset:2048 sc1
    buffer_load_dwordx4 v[124:127], v252, s[36:39], s4 offen offset:3072 sc1
    s_mov_b32 s101, 2
L_xd32:
    s_nop 15
    s_nop 15
    s_nop 15
    buffer_load_dword v218, off, s[36:39], s4 offset:3068 sc1
    s_sub_u32 s101, s101, 1
    s_cbranch_scc0 L_xd32
    s_waitcnt vmcnt(3)
    v_min_u32 v255, v121, v123
    v_cmp_le_i32 vcc, 0, v255
    s_sub_u32 s64, s64, 1
    s_cbranch_scc1 L_xb32
    s_nop 1
    s_cbranch_vccz L_xb32
L_xh32:
    s_waitcnt vmcnt(2)
    v_min_u32 v255, v218, v218
    buffer_load_dword v218, off, s[36:39], s4 offset:3068 sc1
    v_cmp_le_i32 vcc, 0, v255
    s_sub_u32 s64, s64, 1
    s_cbranch_scc1 L_xb32
    s_nop 1
    s_cbranch_vccnz L_xh32
    buffer_load_dwordx4 v[120:123], v252, s[36:39], s4 offen offset:2048 sc1
    buffer_load_dwordx4 v[124:127], v252, s[36:39], s4 offen offset:3072 sc1
    s_waitcnt vmcnt(0)
    v_min_u32 v255, v121, v123
    v_cmp_le_i32 vcc, 0, v255
    s_nop 3
    s_cbranch_vccnz L_xs32
    s_branch L_xb32
L_xr33:
    s_mov_b32 s64, 0x8000
    s_add_u32 s4, s51, 1
    s_and_b32 s4, s4, 3
    s_mul_i32 s4, s4, 0x70000
    s_add_u32 s4, s4, s67
    s_add_u32 s4, s4, 0x8000
L_xs33:
    buffer_load_dwordx4 v[124:127], v252, s[36:39], s4 offen offset:3072 sc1
    s_mov_b32 s101, 2
L_xd33:
    s_nop 15
    s_nop 15
    s_nop 15
    buffer_load_dword v218, off, s[36:39], s4 offset:4092 sc1
    s_sub_u32 s101, s101, 1
    s_cbranch_scc0 L_xd33
    s_waitcnt vmcnt(3)
    v_min_u32 v255, v125, v127
    v_cmp_le_i32 vcc, 0, v255
    s_sub_u32 s64, s64, 1
    s_cbranch_scc1 L_xb33
    s_nop 1
    s_cbranch_vccz L_xb33
L_xh33:
    s_waitcnt vmcnt(2)
    v_min_u32 v255, v218, v218
    buffer_load_dword v218, off, s[36:39], s4 offset:4092 sc1
    v_cmp_le_i32 vcc, 0, v255
    s_sub_u32 s64, s64, 1
    s_cbranch_scc1 L_xb33
    s_nop 1
    s_cbranch_vccnz L_xh33
    buffer_load_dwordx4 v[124:127], v252, s[36:39], s4 offen offset:3072 sc1
    s_waitcnt vmcnt(0)
    v_min_u32 v255, v125, v127
    v_cmp_le_i32 vcc, 0, v255
    s_nop 3
    s_cbranch_vccnz L_xs33
    s_branch L_xb33
L_exit0:
    s_endpgm
L_end:

.section .rodata,"a"
.p2align 6
.amdhsa_kernel mk_kernel
  .amdhsa_next_free_vgpr 512
  .amdhsa_next_free_sgpr 102
  .amdhsa_accum_offset 256
  .amdhsa_group_segment_fixed_size 0
  .amdhsa_kernarg_size 80
  .amdhsa_user_sgpr_count 2
  .amdhsa_user_sgpr_kernarg_segment_ptr 1
  .amdhsa_system_sgpr_workgroup_id_x 1
.end_amdhsa_kernel
```
